```python
import torch

def _softmax(x, axis=-1):
    return torch.softmax(x, dim=axis)
def _gelu(x):
    return torch.nn.functional.gelu(x, approximate="tanh")
def _silu(x):
    return torch.nn.functional.silu(x)
def _sigmoid(x):
    return torch.sigmoid(x)
def _layernorm(x, axis=-1, eps=1e-5):
    m = x.mean(dim=axis, keepdim=True)
    v = x.var(dim=axis, keepdim=True, unbiased=False)
    return (x - m) / torch.sqrt(v + eps)
def _scatter_add(tgt, idx, src, axis=0):
    return tgt.clone().index_add_(axis, idx, src)
def _segment_sum(src, seg, n):
    out = torch.zeros((n,) + src.shape[1:], dtype=src.dtype)
    return out.index_add_(0, seg, src)
def _pad(x, pw):
    flat = tuple(v for pair in reversed(pw) for v in pair)
    return torch.nn.functional.pad(x, flat)

kernel_name = 'gated_mix__ssm_conv_s4__swiglu_ffn__prompt'

def setup_inputs():

    _w = (lambda a: (lambda t: t.to(torch.bfloat16) if t.is_floating_point() else t)(torch.as_tensor(a)))
    def _A_setup():
        B, L, D, N = 1, 2048, 1024, 128
        A_re = -(lambda _x: torch.exp(torch.as_tensor(_x)))((lambda *s: torch.randn(*s, dtype=torch.bfloat16) * 6.4)(D, N))
        A_im = torch.pi * (lambda *s: torch.randn(*s, dtype=torch.bfloat16) * 0.05)(D, N)
        B_re = (lambda *s: torch.randn(*s, dtype=torch.bfloat16) * 0.1)(D, N)
        B_im = (lambda *s: torch.randn(*s, dtype=torch.bfloat16) * 0.1)(D, N)
        C_re = (lambda *s: torch.randn(*s, dtype=torch.bfloat16) * 0.1)(D, N)
        C_im = (lambda *s: torch.randn(*s, dtype=torch.bfloat16) * 0.1)(D, N)
        log_dt = (lambda *s: torch.randn(*s, dtype=torch.bfloat16) * 0.05)(D) * 0.5 - 4.0
        Dskip = (lambda *s: torch.randn(*s, dtype=torch.bfloat16) * 0.05)(D)
        return {
            "u": _w((lambda *s: torch.randn(*s, dtype=torch.bfloat16) * 0.05)(B, L, D)),
            "A_re": _w(A_re),
            "A_im": _w(A_im),
            "B_re": _w(B_re),
            "B_im": _w(B_im),
            "C_re": _w(C_re),
            "C_im": _w(C_im),
            "log_dt": _w(log_dt),
            "Dskip": _w(Dskip),
        }
    _A_in = _A_setup()

    def _B_setup():
        B, S, D, F = 1, 2048, 1024, 3584
        return {
            "x": _w((lambda *s: torch.randn(*s, dtype=torch.bfloat16) * 0.05)(B, S, D)),
            "w_gate": _w((lambda *s: torch.randn(*s, dtype=torch.bfloat16) * 0.05)(D, F)),
            "w_up": _w((lambda *s: torch.randn(*s, dtype=torch.bfloat16) * 0.05)(D, F)),
            "w_down": _w((lambda *s: torch.randn(*s, dtype=torch.bfloat16) * 0.05)(F, D)),
        }
    _B_in = _B_setup()

    return {
        "A_u": _A_in["u"],
        "A_A_re": _A_in["A_re"],
        "A_A_im": _A_in["A_im"],
        "A_B_re": _A_in["B_re"],
        "A_B_im": _A_in["B_im"],
        "A_C_re": _A_in["C_re"],
        "A_C_im": _A_in["C_im"],
        "A_log_dt": _A_in["log_dt"],
        "A_Dskip": _A_in["Dskip"],
        "B_x": _B_in["x"],
        "B_w_gate": _B_in["w_gate"],
        "B_w_up": _B_in["w_up"],
        "B_w_down": _B_in["w_down"],
        "gate_w": _w((lambda *s: torch.randn(*s, dtype=torch.bfloat16) * 0.05)(1024) * 16.0),
    }

def reference(A_u, A_A_re, A_A_im, A_B_re, A_B_im, A_C_re, A_C_im, A_log_dt, A_Dskip, B_x, B_w_gate, B_w_up, B_w_down, gate_w):
    def _A_ref(u, A_re, A_im, B_re, B_im, C_re, C_im, log_dt, Dskip):
        Bsz, L, D = u.shape
        dt = torch.exp(log_dt)[:, None]
        A = A_re + 1j * A_im
        Bc = B_re + 1j * B_im
        Cc = C_re + 1j * C_im
        logdA = dt * A
        dB = dt * Bc
        l = (lambda x, dt: x.to(dt))(torch.arange(L), A_re.dtype)
        P = torch.exp(logdA[:, :, None] * l[None, None, :])
        K = torch.einsum("dn,dnl,dn->dl", Cc, P, dB).real
        L2 = 2 * L
        Kp = _pad(K, ((0, 0), (0, L)))
        up = (lambda x, *d: x.permute(*d))(u, 0, 2, 1)
        up = _pad(up, ((0, 0), (0, 0), (0, L)))
        Kf = (lambda x, axes=(-2,-1): torch.fft.rfft2(x.float(), dim=axes))(Kp[:, None, :], axes=(-2, -1))
        Uf = (lambda x, axes=(-2,-1): torch.fft.rfft2(x.float(), dim=axes))(up[:, :, None, :], axes=(-2, -1))
        Yf = Uf * Kf[None, :, :, :]
        y = (lambda x, s, axes=(-2,-1): torch.fft.irfft2(x, s=s, dim=axes).to(torch.bfloat16))(Yf, (1, L2), axes=(-2, -1))[:, :, 0, :L]
        y = (lambda x, *d: x.permute(*d))(y, 0, 2, 1) + u * Dskip[None, None, :]
        return y

    def _B_ref(x, w_gate, w_up, w_down):
        g = _silu(x @ w_gate)
        u = x @ w_up
        return (g * u) @ w_down

    x = A_u
    g = _sigmoid((x * gate_w).sum(-1, keepdims=True))
    a = _A_ref(x, A_A_re, A_A_im, A_B_re, A_B_im, A_C_re, A_C_im, A_log_dt, A_Dskip)
    b = _B_ref(x, B_w_gate, B_w_up, B_w_down)
    return g * a + (1 - g) * b
```

```asm
; @launch kernel=fused_kernel grid=(256,1,1) block=(256,1,1) lds=163840
.amdgcn_target "amdgcn-amd-amdhsa--gfx950"
.text
.globl fused_kernel
.p2align 8
.type fused_kernel,@function
fused_kernel:
    s_cmp_ge_u32 s2, 256
    s_cbranch_scc1 fused_kernel_end
    s_sub_u32 s2, s2, 32
    s_and_b32 s2, s2, 255
    s_cmp_ge_u32 s2, 224
    s_cbranch_scc1 fused_kernel_aux
    s_load_dwordx2 s[4:5], s[0:1], 0
    s_load_dwordx4 s[40:43], s[0:1], 80
    s_load_dwordx2 s[6:7], s[0:1], 128

    s_getpc_b64 s[80:81]
    fused_kernel_pc1:
    v_lshlrev_b32 v30, 6, v0
    v_min_u32 v30, fused_kernel_lend-fused_kernel_pc1, v30
    v_mov_b32 v31, s81
    v_add_co_u32 v30, vcc, s80, v30
    v_addc_co_u32 v31, vcc, 0, v31, vcc
    global_load_dword v16, v[30:31], off

    s_load_dwordx2 s[92:93], s[0:1], 96
    s_load_dwordx4 s[96:99], s[0:1], 112
    v_lshrrev_b32 v1, 6, v0
    v_and_b32 v0, 63, v0
    s_and_b32 s3, s2, 7
    v_readfirstlane_b32 s24, v1
    s_lshr_b32 s36, s2, 3
    s_and_b32 s37, s3, 1
    s_lshl_b32 s37, s37, 2
    s_and_b32 s38, s36, 3
    s_add_u32 s25, s37, s38
    s_lshr_b32 s37, s3, 1
    s_mul_i32 s37, s37, 7
    s_lshr_b32 s38, s36, 2
    s_add_u32 s26, s37, s38
    v_lshlrev_b32 v1, 4, v0

    v_lshrrev_b32 v17, 4, v0
    v_and_b32 v18, 15, v0
    v_lshlrev_b32 v19, 2, v17
    v_xor_b32 v18, v18, v19
    v_lshlrev_b32 v18, 4, v18
    s_nop 0
    v_mul_u32_u24 v19, 7168, v17
    v_add_u32 v18, v18, v19
    s_and_b32 s36, s24, 1
    s_mul_i32 s37, s36, 114688
    s_lshl_b32 s38, s26, 8
    s_add_u32 s37, s37, s38
    v_add_u32 v8, s37, v18
    v_xor_b32 v18, 32, v8
    v_add_u32 v9, 27648, v8
    v_add_u32 v10, 55296, v18
    v_add_u32 v11, 82944, v18

    v_lshrrev_b32 v18, 3, v0
    v_lshlrev_b32 v18, 11, v18
    v_and_b32 v19, 7, v0
    v_xor_b32 v19, v19, v17
    v_lshlrev_b32 v19, 4, v19
    v_add_u32 v18, v18, v19
    s_lshl_b32 s37, s25, 8
    s_lshl_b32 s38, s24, 6
    s_add_u32 s37, s37, s38
    s_lshl_b32 s37, s37, 11
    v_add_u32 v12, s37, v18
    v_xor_b32 v18, 64, v12
    v_add_u32 v13, 15360, v18
    v_add_u32 v14, 30720, v12
    v_add_u32 v15, 46080, v18

    v_lshlrev_b32 v18, 11, v17
    v_bfe_u32 v19, v0, 2, 2
    v_lshlrev_b32 v20, 8, v19
    v_add_u32 v18, v18, v20
    v_lshlrev_b32 v19, 1, v19
    v_and_b32 v20, 1, v17
    v_xor_b32 v19, v19, v20
    s_lshl_b32 s37, s36, 2
    v_xor_b32 v19, s37, v19
    v_lshlrev_b32 v19, 5, v19
    v_add_u32 v18, v18, v19
    v_and_b32 v19, 3, v0
    v_lshlrev_b32 v19, 3, v19
    v_add_u32 v2, v18, v19

    v_xor_b32 v3, 32, v2
    v_xor_b32 v4, 64, v2
    v_xor_b32 v5, 96, v2
    s_lshr_b32 s37, s24, 1
    s_lshl_b32 s37, s37, 14
    s_add_u32 s37, s37, 65536
    v_and_b32 v18, 15, v0
    v_lshlrev_b32 v18, 7, v18
    v_add_u32 v18, s37, v18
    v_bfe_u32 v20, v0, 1, 3
    v_xor_b32 v19, v17, v20
    v_lshlrev_b32 v19, 4, v19
    v_add_u32 v6, v18, v19
    v_xor_b32 v7, 64, v6

    s_waitcnt lgkmcnt(0)
    s_mov_b32 s8, s4
    s_and_b32 s9, s5, 0xffff
    s_mov_b32 s10, 0x400000
    s_mov_b32 s11, 0x20000
    s_cmp_lt_u32 s24, 2
    s_cselect_b32 s40, s40, s42
    s_cselect_b32 s41, s41, s43

    s_mov_b32 s12, s40
    s_and_b32 s13, s41, 0xffff
    s_mov_b32 s14, 0x700000
    s_mov_b32 s15, 0x20000
    s_mov_b32 s20, s6
    s_and_b32 s21, s7, 0xffff
    s_mov_b32 s22, 0xe00000
    s_mov_b32 s23, 0x20000
    s_add_u32 s47, s25, s26
    s_and_b32 s47, s47, 1
    s_mov_b32 s48, 0
    s_mov_b32 s49, 0
    s_lshl_b32 s28, s48, 7
    s_mul_i32 s27, s48, 458752
    s_lshl_b32 s30, s24, 12
    s_lshl_b32 s31, s24, 13
    s_add_u32 s31, s31, 65536

    s_add_u32 m0, s31, 0
    s_add_u32 s29, s28, 65536
    buffer_load_dwordx4 v12, s[8:11], s28 offen offset:0 lds
    buffer_load_dwordx4 v13, s[8:11], s28 offen offset:1024 lds
    buffer_load_dwordx4 v14, s[8:11], s28 offen offset:2048 lds
    buffer_load_dwordx4 v15, s[8:11], s28 offen offset:3072 lds
    s_add_u32 m0, s30, 0
    s_nop 0
    buffer_load_dwordx4 v8, s[12:15], s27 offen offset:0 lds
    buffer_load_dwordx4 v9, s[12:15], s27 offen offset:1024 lds
    buffer_load_dwordx4 v10, s[12:15], s27 offen offset:2048 lds
    buffer_load_dwordx4 v11, s[12:15], s27 offen offset:3072 lds
    s_add_u32 s27, s27, 229376
    s_add_u32 m0, s31, 4096
    s_add_u32 s29, s28, 65536
    buffer_load_dwordx4 v12, s[8:11], s29 offen offset:0 lds
    buffer_load_dwordx4 v13, s[8:11], s29 offen offset:1024 lds
    buffer_load_dwordx4 v14, s[8:11], s29 offen offset:2048 lds
    buffer_load_dwordx4 v15, s[8:11], s29 offen offset:3072 lds
    s_add_u32 s48, s48, 1
    s_xor_b32 s50, s48, 0
    s_lshl_b32 s28, s50, 7
    s_add_u32 m0, s30, 16384
    s_nop 0
    buffer_load_dwordx4 v8, s[12:15], s27 offen offset:0 lds
    buffer_load_dwordx4 v9, s[12:15], s27 offen offset:1024 lds
    buffer_load_dwordx4 v10, s[12:15], s27 offen offset:2048 lds
    buffer_load_dwordx4 v11, s[12:15], s27 offen offset:3072 lds
    s_add_u32 s49, s49, 1
    s_xor_b32 s50, s49, 0
    s_mul_i32 s27, s50, 458752
    s_add_u32 m0, s31, 32768
    s_add_u32 s29, s28, 65536
    buffer_load_dwordx4 v12, s[8:11], s28 offen offset:0 lds
    buffer_load_dwordx4 v13, s[8:11], s28 offen offset:1024 lds
    buffer_load_dwordx4 v14, s[8:11], s28 offen offset:2048 lds
    buffer_load_dwordx4 v15, s[8:11], s28 offen offset:3072 lds
    s_add_u32 m0, s30, 32768
    s_nop 0
    buffer_load_dwordx4 v8, s[12:15], s27 offen offset:0 lds
    buffer_load_dwordx4 v9, s[12:15], s27 offen offset:1024 lds
    buffer_load_dwordx4 v10, s[12:15], s27 offen offset:2048 lds
    buffer_load_dwordx4 v11, s[12:15], s27 offen offset:3072 lds
    s_add_u32 s27, s27, 229376
    s_lshl_b32 s36, s2, 2
    s_add_u32 s36, s36, s24
    s_lshl_b32 s36, s36, 13
    v_lshrrev_b32 v18, 3, v0
    v_lshlrev_b32 v18, 7, v18
    s_add_u32 s84, s92, s36
    s_addc_u32 s85, s93, 0
    s_and_b32 s85, s85, 0xffff
    s_movk_i32 s86, 0x2000
    s_mov_b32 s87, 0x20000

    s_mov_b32 s32, 0
    s_add_u32 s34, s31, 65536
    s_add_u32 s44, s31, 98304
    s_mov_b32 s45, 4294901760
    s_mov_b32 s46, 32768
    s_mov_b32 s35, 0

    s_waitcnt vmcnt(12)
    s_barrier
    ds_read_b64_tr_b16 a[0:1], v2 offset:0
    ds_read_b64_tr_b16 a[2:3], v2 offset:1024
    ds_read_b128 a[32:35], v6 offset:0
    ds_read_b64_tr_b16 a[4:5], v3 offset:0
    ds_read_b64_tr_b16 a[6:7], v3 offset:1024
    ds_read_b128 a[36:39], v6 offset:2048
    ds_read_b64_tr_b16 a[8:9], v4 offset:0
    ds_read_b64_tr_b16 a[10:11], v4 offset:1024
    ds_read_b128 a[40:43], v6 offset:4096
    ds_read_b64_tr_b16 a[12:13], v5 offset:0
    ds_read_b64_tr_b16 a[14:15], v5 offset:1024
    ds_read_b128 a[44:47], v6 offset:6144
    ds_read_b64_tr_b16 a[16:17], v2 offset:8192
    ds_read_b64_tr_b16 a[18:19], v2 offset:9216
    ds_read_b128 a[48:51], v6 offset:8192
    ds_read_b64_tr_b16 a[20:21], v3 offset:8192
    ds_read_b64_tr_b16 a[22:23], v3 offset:9216
    ds_read_b128 a[52:55], v6 offset:10240
    ds_read_b64_tr_b16 a[24:25], v4 offset:8192
    ds_read_b64_tr_b16 a[26:27], v4 offset:9216
    ds_read_b128 a[56:59], v6 offset:12288
    ds_read_b64_tr_b16 a[28:29], v5 offset:8192
    ds_read_b64_tr_b16 a[30:31], v5 offset:9216
    ds_read_b128 a[60:63], v6 offset:14336
    s_waitcnt lgkmcnt(0)
    v_mfma_f32_16x16x32_bf16 v[32:35], a[0:3], a[32:35], 0
    v_mfma_f32_16x16x32_bf16 v[36:39], a[4:7], a[32:35], 0
    s_add_u32 m0, s31, 36864
    s_add_u32 s29, s28, 65536
    buffer_load_dwordx4 v12, s[8:11], s29 offen offset:0 lds
    v_mfma_f32_16x16x32_bf16 v[40:43], a[8:11], a[32:35], 0
    v_mfma_f32_16x16x32_bf16 v[44:47], a[12:15], a[32:35], 0
    buffer_load_dwordx4 v13, s[8:11], s29 offen offset:1024 lds
    v_mfma_f32_16x16x32_bf16 v[48:51], a[16:19], a[32:35], 0
    v_mfma_f32_16x16x32_bf16 v[52:55], a[20:23], a[32:35], 0
    buffer_load_dwordx4 v14, s[8:11], s29 offen offset:2048 lds
    v_mfma_f32_16x16x32_bf16 v[56:59], a[24:27], a[32:35], 0
    v_mfma_f32_16x16x32_bf16 v[60:63], a[28:31], a[32:35], 0
    buffer_load_dwordx4 v15, s[8:11], s29 offen offset:3072 lds
    v_mfma_f32_16x16x32_bf16 v[64:67], a[0:3], a[36:39], 0
    s_waitcnt vmcnt(12)
    s_barrier
    v_mfma_f32_16x16x32_bf16 v[68:71], a[4:7], a[36:39], 0
    s_add_u32 s48, s48, 1
    s_xor_b32 s50, s48, s47
    s_lshl_b32 s28, s50, 7
    s_add_u32 m0, s30, 49152
    s_nop 0
    buffer_load_dwordx4 v8, s[12:15], s27 offen offset:0 lds
    v_mfma_f32_16x16x32_bf16 v[72:75], a[8:11], a[36:39], 0
    ds_read_b64_tr_b16 a[64:65], v2 offset:16384
    v_mfma_f32_16x16x32_bf16 v[76:79], a[12:15], a[36:39], 0
    buffer_load_dwordx4 v9, s[12:15], s27 offen offset:1024 lds
    ds_read_b64_tr_b16 a[66:67], v2 offset:17408
    v_mfma_f32_16x16x32_bf16 v[80:83], a[16:19], a[36:39], 0
    v_mfma_f32_16x16x32_bf16 v[84:87], a[20:23], a[36:39], 0
    buffer_load_dwordx4 v10, s[12:15], s27 offen offset:2048 lds
    ds_read_b128 a[96:99], v7 offset:0
    v_mfma_f32_16x16x32_bf16 v[88:91], a[24:27], a[36:39], 0
    v_mfma_f32_16x16x32_bf16 v[92:95], a[28:31], a[36:39], 0
    buffer_load_dwordx4 v11, s[12:15], s27 offen offset:3072 lds
    ds_read_b64_tr_b16 a[68:69], v3 offset:16384
    v_mfma_f32_16x16x32_bf16 v[96:99], a[0:3], a[40:43], 0
    v_mfma_f32_16x16x32_bf16 v[100:103], a[4:7], a[40:43], 0
    s_add_u32 s49, s49, 1
    s_xor_b32 s50, s49, s47
    s_mul_i32 s27, s50, 458752
    s_add_u32 m0, s31, 65536
    s_add_u32 s29, s28, 65536
    buffer_load_dwordx4 v12, s[8:11], s28 offen offset:0 lds
    ds_read_b64_tr_b16 a[70:71], v3 offset:17408
    v_mfma_f32_16x16x32_bf16 v[104:107], a[8:11], a[40:43], 0
    v_mfma_f32_16x16x32_bf16 v[108:111], a[12:15], a[40:43], 0
    buffer_load_dwordx4 v13, s[8:11], s28 offen offset:1024 lds
    ds_read_b128 a[100:103], v7 offset:2048
    v_mfma_f32_16x16x32_bf16 v[112:115], a[16:19], a[40:43], 0
    ds_read_b64_tr_b16 a[72:73], v4 offset:16384
    v_mfma_f32_16x16x32_bf16 v[116:119], a[20:23], a[40:43], 0
    buffer_load_dwordx4 v14, s[8:11], s28 offen offset:2048 lds
    v_mfma_f32_16x16x32_bf16 v[120:123], a[24:27], a[40:43], 0
    ds_read_b64_tr_b16 a[74:75], v4 offset:17408
    v_mfma_f32_16x16x32_bf16 v[124:127], a[28:31], a[40:43], 0
    buffer_load_dwordx4 v15, s[8:11], s28 offen offset:3072 lds
    v_mfma_f32_16x16x32_bf16 v[128:131], a[0:3], a[44:47], 0
    ds_read_b128 a[104:107], v7 offset:4096
    v_mfma_f32_16x16x32_bf16 v[132:135], a[4:7], a[44:47], 0
    v_mfma_f32_16x16x32_bf16 v[136:139], a[8:11], a[44:47], 0
    ds_read_b64_tr_b16 a[76:77], v5 offset:16384
    v_mfma_f32_16x16x32_bf16 v[140:143], a[12:15], a[44:47], 0
    s_add_u32 m0, s30, 0
    v_mfma_f32_16x16x32_bf16 v[144:147], a[16:19], a[44:47], 0
    buffer_load_dwordx4 v8, s[12:15], s27 offen offset:0 lds
    ds_read_b64_tr_b16 a[78:79], v5 offset:17408
    v_mfma_f32_16x16x32_bf16 v[148:151], a[20:23], a[44:47], 0
    ds_read_b128 a[108:111], v7 offset:6144
    v_mfma_f32_16x16x32_bf16 v[152:155], a[24:27], a[44:47], 0
    buffer_load_dwordx4 v9, s[12:15], s27 offen offset:1024 lds
    v_mfma_f32_16x16x32_bf16 v[156:159], a[28:31], a[44:47], 0
    ds_read_b64_tr_b16 a[80:81], v2 offset:24576
    v_mfma_f32_16x16x32_bf16 v[160:163], a[0:3], a[48:51], 0
    buffer_load_dwordx4 v10, s[12:15], s27 offen offset:2048 lds
    v_mfma_f32_16x16x32_bf16 v[164:167], a[4:7], a[48:51], 0
    ds_read_b64_tr_b16 a[82:83], v2 offset:25600
    v_mfma_f32_16x16x32_bf16 v[168:171], a[8:11], a[48:51], 0
    buffer_load_dwordx4 v11, s[12:15], s27 offen offset:3072 lds
    v_mfma_f32_16x16x32_bf16 v[172:175], a[12:15], a[48:51], 0
    ds_read_b128 a[112:115], v7 offset:8192
    v_mfma_f32_16x16x32_bf16 v[176:179], a[16:19], a[48:51], 0
    s_add_u32 s29, s28, 65536
    s_add_u32 s27, s27, 229376
    v_mfma_f32_16x16x32_bf16 v[180:183], a[20:23], a[48:51], 0
    s_add_u32 m0, s34, 4096
    ds_read_b64_tr_b16 a[84:85], v3 offset:24576
    v_mfma_f32_16x16x32_bf16 v[184:187], a[24:27], a[48:51], 0
    buffer_load_dwordx4 v12, s[8:11], s29 offen offset:0 lds
    ds_read_b64_tr_b16 a[86:87], v3 offset:25600
    v_mfma_f32_16x16x32_bf16 v[188:191], a[28:31], a[48:51], 0
    v_mfma_f32_16x16x32_bf16 v[192:195], a[0:3], a[52:55], 0
    ds_read_b128 a[116:119], v7 offset:10240
    v_mfma_f32_16x16x32_bf16 v[196:199], a[4:7], a[52:55], 0
    v_mfma_f32_16x16x32_bf16 v[200:203], a[8:11], a[52:55], 0
    ds_read_b64_tr_b16 a[88:89], v4 offset:24576
    v_mfma_f32_16x16x32_bf16 v[204:207], a[12:15], a[52:55], 0
    v_mfma_f32_16x16x32_bf16 v[208:211], a[16:19], a[52:55], 0
    ds_read_b64_tr_b16 a[90:91], v4 offset:25600
    buffer_load_dwordx4 v13, s[8:11], s29 offen offset:1024 lds
    v_mfma_f32_16x16x32_bf16 v[212:215], a[20:23], a[52:55], 0
    v_mfma_f32_16x16x32_bf16 v[216:219], a[24:27], a[52:55], 0
    ds_read_b128 a[120:123], v7 offset:12288
    v_mfma_f32_16x16x32_bf16 v[220:223], a[28:31], a[52:55], 0
    ds_read_b64_tr_b16 a[92:93], v5 offset:24576
    v_mfma_f32_16x16x32_bf16 v[224:227], a[0:3], a[56:59], 0
    v_mfma_f32_16x16x32_bf16 v[228:231], a[4:7], a[56:59], 0
    ds_read_b64_tr_b16 a[94:95], v5 offset:25600
    v_mfma_f32_16x16x32_bf16 v[232:235], a[8:11], a[56:59], 0
    buffer_load_dwordx4 v14, s[8:11], s29 offen offset:2048 lds
    v_mfma_f32_16x16x32_bf16 v[236:239], a[12:15], a[56:59], 0
    ds_read_b128 a[124:127], v7 offset:14336
    v_mfma_f32_16x16x32_bf16 v[240:243], a[16:19], a[56:59], 0
    s_add_u32 s34, s34, 32768
    v_mfma_f32_16x16x32_bf16 v[244:247], a[20:23], a[56:59], 0
    s_add_u32 s35, s35, 1
    s_cmp_eq_u32 s35, 3
    v_mfma_f32_16x16x32_bf16 v[248:251], a[24:27], a[56:59], 0
    s_cselect_b32 s33, s45, s46
    s_cselect_b32 s35, 0, s35
    v_mfma_f32_16x16x32_bf16 v[252:255], a[28:31], a[56:59], 0
    v_xor_b32 v2, 0x8000, v2
    v_mfma_f32_16x16x32_bf16 a[128:131], a[0:3], a[60:63], 0
    v_xor_b32 v3, 0x8000, v3
    v_mfma_f32_16x16x32_bf16 a[132:135], a[4:7], a[60:63], 0
    v_xor_b32 v4, 0x8000, v4
    v_mfma_f32_16x16x32_bf16 a[136:139], a[8:11], a[60:63], 0
    v_xor_b32 v5, 0x8000, v5
    v_mfma_f32_16x16x32_bf16 a[140:143], a[12:15], a[60:63], 0
    buffer_load_dwordx4 v15, s[8:11], s29 offen offset:3072 lds
    v_mfma_f32_16x16x32_bf16 a[144:147], a[16:19], a[60:63], 0
    s_add_u32 s48, s48, 1
    s_xor_b32 s50, s48, s47
    v_mfma_f32_16x16x32_bf16 a[148:151], a[20:23], a[60:63], 0
    s_lshl_b32 s28, s50, 7
    s_cmp_eq_u32 s34, s44
    s_cselect_b32 s34, s31, s34
    v_mfma_f32_16x16x32_bf16 a[152:155], a[24:27], a[60:63], 0
    v_add_u32 v6, s33, v6
    s_cmp_ge_u32 s32, 13
    v_mfma_f32_16x16x32_bf16 a[156:159], a[28:31], a[60:63], 0
    v_add_u32 v7, s33, v7
    s_cselect_b32 s10, 0, s10
    s_waitcnt lgkmcnt(0)
    v_mfma_f32_16x16x32_bf16 v[32:35], a[64:67], a[96:99], v[32:35]
    v_mfma_f32_16x16x32_bf16 v[36:39], a[68:71], a[96:99], v[36:39]
    v_mfma_f32_16x16x32_bf16 v[40:43], a[72:75], a[96:99], v[40:43]
    v_mfma_f32_16x16x32_bf16 v[44:47], a[76:79], a[96:99], v[44:47]
    s_add_u32 m0, s30, 16384
    v_mfma_f32_16x16x32_bf16 v[48:51], a[80:83], a[96:99], v[48:51]
    v_mfma_f32_16x16x32_bf16 v[52:55], a[84:87], a[96:99], v[52:55]
    v_mfma_f32_16x16x32_bf16 v[56:59], a[88:91], a[96:99], v[56:59]
    s_waitcnt vmcnt(16)
    s_barrier
    v_mfma_f32_16x16x32_bf16 v[60:63], a[92:95], a[96:99], v[60:63]
    buffer_load_dwordx4 v8, s[12:15], s27 offen offset:0 lds
    v_mfma_f32_16x16x32_bf16 v[64:67], a[64:67], a[100:103], v[64:67]
    ds_read_b64_tr_b16 a[0:1], v2 offset:0
    v_mfma_f32_16x16x32_bf16 v[68:71], a[68:71], a[100:103], v[68:71]
    ds_read_b64_tr_b16 a[2:3], v2 offset:1024
    v_mfma_f32_16x16x32_bf16 v[72:75], a[72:75], a[100:103], v[72:75]
    v_mfma_f32_16x16x32_bf16 v[76:79], a[76:79], a[100:103], v[76:79]
    ds_read_b128 a[32:35], v6 offset:0
    v_mfma_f32_16x16x32_bf16 v[80:83], a[80:83], a[100:103], v[80:83]
    v_mfma_f32_16x16x32_bf16 v[84:87], a[84:87], a[100:103], v[84:87]
    ds_read_b64_tr_b16 a[4:5], v3 offset:0
    buffer_load_dwordx4 v9, s[12:15], s27 offen offset:1024 lds
    v_mfma_f32_16x16x32_bf16 v[88:91], a[88:91], a[100:103], v[88:91]
    v_mfma_f32_16x16x32_bf16 v[92:95], a[92:95], a[100:103], v[92:95]
    ds_read_b64_tr_b16 a[6:7], v3 offset:1024
    v_mfma_f32_16x16x32_bf16 v[96:99], a[64:67], a[104:107], v[96:99]
    v_mfma_f32_16x16x32_bf16 v[100:103], a[68:71], a[104:107], v[100:103]
    ds_read_b128 a[36:39], v6 offset:2048
    v_mfma_f32_16x16x32_bf16 v[104:107], a[72:75], a[104:107], v[104:107]
    ds_read_b64_tr_b16 a[8:9], v4 offset:0
    v_mfma_f32_16x16x32_bf16 v[108:111], a[76:79], a[104:107], v[108:111]
    v_mfma_f32_16x16x32_bf16 v[112:115], a[80:83], a[104:107], v[112:115]
    ds_read_b64_tr_b16 a[10:11], v4 offset:1024
    v_mfma_f32_16x16x32_bf16 v[116:119], a[84:87], a[104:107], v[116:119]
    buffer_load_dwordx4 v10, s[12:15], s27 offen offset:2048 lds
    v_mfma_f32_16x16x32_bf16 v[120:123], a[88:91], a[104:107], v[120:123]
    ds_read_b128 a[40:43], v6 offset:4096
    v_mfma_f32_16x16x32_bf16 v[124:127], a[92:95], a[104:107], v[124:127]
    v_mfma_f32_16x16x32_bf16 v[128:131], a[64:67], a[108:111], v[128:131]
    ds_read_b64_tr_b16 a[12:13], v5 offset:0
    v_mfma_f32_16x16x32_bf16 v[132:135], a[68:71], a[108:111], v[132:135]
    v_mfma_f32_16x16x32_bf16 v[136:139], a[72:75], a[108:111], v[136:139]
    ds_read_b64_tr_b16 a[14:15], v5 offset:1024
    v_mfma_f32_16x16x32_bf16 v[140:143], a[76:79], a[108:111], v[140:143]
    ds_read_b128 a[44:47], v6 offset:6144
    v_mfma_f32_16x16x32_bf16 v[144:147], a[80:83], a[108:111], v[144:147]
    v_mfma_f32_16x16x32_bf16 v[148:151], a[84:87], a[108:111], v[148:151]
    ds_read_b64_tr_b16 a[16:17], v2 offset:8192
    buffer_load_dwordx4 v11, s[12:15], s27 offen offset:3072 lds
    v_mfma_f32_16x16x32_bf16 v[152:155], a[88:91], a[108:111], v[152:155]
    v_mfma_f32_16x16x32_bf16 v[156:159], a[92:95], a[108:111], v[156:159]
    ds_read_b64_tr_b16 a[18:19], v2 offset:9216
    s_add_u32 s49, s49, 1
    s_xor_b32 s50, s49, s47
    v_mfma_f32_16x16x32_bf16 v[160:163], a[64:67], a[112:115], v[160:163]
    v_mfma_f32_16x16x32_bf16 v[164:167], a[68:71], a[112:115], v[164:167]
    ds_read_b128 a[48:51], v6 offset:8192
    s_add_u32 m0, s34, 0
    v_mfma_f32_16x16x32_bf16 v[168:171], a[72:75], a[112:115], v[168:171]
    v_mfma_f32_16x16x32_bf16 v[172:175], a[76:79], a[112:115], v[172:175]
    ds_read_b64_tr_b16 a[20:21], v3 offset:8192
    buffer_load_dwordx4 v12, s[8:11], s28 offen offset:0 lds
    v_mfma_f32_16x16x32_bf16 v[176:179], a[80:83], a[112:115], v[176:179]
    ds_read_b64_tr_b16 a[22:23], v3 offset:9216
    v_mfma_f32_16x16x32_bf16 v[180:183], a[84:87], a[112:115], v[180:183]
    s_mul_i32 s27, s50, 458752
    s_xor_b32 s30, s30, 0x8000
    v_mfma_f32_16x16x32_bf16 v[184:187], a[88:91], a[112:115], v[184:187]
    ds_read_b128 a[52:55], v6 offset:10240
    v_mfma_f32_16x16x32_bf16 v[188:191], a[92:95], a[112:115], v[188:191]
    v_mfma_f32_16x16x32_bf16 v[192:195], a[64:67], a[116:119], v[192:195]
    ds_read_b64_tr_b16 a[24:25], v4 offset:8192
    v_mfma_f32_16x16x32_bf16 v[196:199], a[68:71], a[116:119], v[196:199]
    v_mfma_f32_16x16x32_bf16 v[200:203], a[72:75], a[116:119], v[200:203]
    ds_read_b64_tr_b16 a[26:27], v4 offset:9216
    v_mfma_f32_16x16x32_bf16 v[204:207], a[76:79], a[116:119], v[204:207]
    buffer_load_dwordx4 v13, s[8:11], s28 offen offset:1024 lds
    v_mfma_f32_16x16x32_bf16 v[208:211], a[80:83], a[116:119], v[208:211]
    ds_read_b128 a[56:59], v6 offset:12288
    v_mfma_f32_16x16x32_bf16 v[212:215], a[84:87], a[116:119], v[212:215]
    ds_read_b64_tr_b16 a[28:29], v5 offset:8192
    v_mfma_f32_16x16x32_bf16 v[216:219], a[88:91], a[116:119], v[216:219]
    v_mfma_f32_16x16x32_bf16 v[220:223], a[92:95], a[116:119], v[220:223]
    ds_read_b64_tr_b16 a[30:31], v5 offset:9216
    v_mfma_f32_16x16x32_bf16 v[224:227], a[64:67], a[120:123], v[224:227]
    v_mfma_f32_16x16x32_bf16 v[228:231], a[68:71], a[120:123], v[228:231]
    ds_read_b128 a[60:63], v6 offset:14336
    v_mfma_f32_16x16x32_bf16 v[232:235], a[72:75], a[120:123], v[232:235]
    v_mfma_f32_16x16x32_bf16 v[236:239], a[76:79], a[120:123], v[236:239]
    buffer_load_dwordx4 v14, s[8:11], s28 offen offset:2048 lds
    v_mfma_f32_16x16x32_bf16 v[240:243], a[80:83], a[120:123], v[240:243]
    v_mfma_f32_16x16x32_bf16 v[244:247], a[84:87], a[120:123], v[244:247]
    v_mfma_f32_16x16x32_bf16 v[248:251], a[88:91], a[120:123], v[248:251]
    v_mfma_f32_16x16x32_bf16 v[252:255], a[92:95], a[120:123], v[252:255]
    buffer_load_dword v16, v18, s[84:87], 0 offen
    v_mfma_f32_16x16x32_bf16 a[128:131], a[64:67], a[124:127], a[128:131]
    v_mfma_f32_16x16x32_bf16 a[132:135], a[68:71], a[124:127], a[132:135]
    v_add_u32 v18, 1024, v18
    v_mfma_f32_16x16x32_bf16 a[136:139], a[72:75], a[124:127], a[136:139]
    v_mfma_f32_16x16x32_bf16 a[140:143], a[76:79], a[124:127], a[140:143]
    buffer_load_dwordx4 v15, s[8:11], s28 offen offset:3072 lds
    v_mfma_f32_16x16x32_bf16 a[144:147], a[80:83], a[124:127], a[144:147]
    v_mfma_f32_16x16x32_bf16 a[148:151], a[84:87], a[124:127], a[148:151]
    v_mfma_f32_16x16x32_bf16 a[152:155], a[88:91], a[124:127], a[152:155]
    s_add_u32 s32, s32, 1
    s_cmp_lt_u32 s32, 15
    v_mfma_f32_16x16x32_bf16 a[156:159], a[92:95], a[124:127], a[156:159]
    .p2align 3
fused_kernel_loop:
    s_waitcnt lgkmcnt(0)
    v_mfma_f32_16x16x32_bf16 v[32:35], a[0:3], a[32:35], v[32:35]
    v_mfma_f32_16x16x32_bf16 v[36:39], a[4:7], a[32:35], v[36:39]
    s_waitcnt vmcnt(16)
    s_barrier
    v_mfma_f32_16x16x32_bf16 v[40:43], a[8:11], a[32:35], v[40:43]
    v_mfma_f32_16x16x32_bf16 v[44:47], a[12:15], a[32:35], v[44:47]
    s_add_u32 m0, s30, 0
    v_mfma_f32_16x16x32_bf16 v[48:51], a[16:19], a[32:35], v[48:51]
    ds_read_b64_tr_b16 a[64:65], v2 offset:16384
    v_mfma_f32_16x16x32_bf16 v[52:55], a[20:23], a[32:35], v[52:55]
    buffer_load_dwordx4 v8, s[12:15], s27 offen offset:0 lds
    v_mfma_f32_16x16x32_bf16 v[56:59], a[24:27], a[32:35], v[56:59]
    ds_read_b64_tr_b16 a[66:67], v2 offset:17408
    v_mfma_f32_16x16x32_bf16 v[60:63], a[28:31], a[32:35], v[60:63]
    v_mfma_f32_16x16x32_bf16 v[64:67], a[0:3], a[36:39], v[64:67]
    ds_read_b128 a[96:99], v7 offset:0
    v_mfma_f32_16x16x32_bf16 v[68:71], a[4:7], a[36:39], v[68:71]
    v_mfma_f32_16x16x32_bf16 v[72:75], a[8:11], a[36:39], v[72:75]
    ds_read_b64_tr_b16 a[68:69], v3 offset:16384
    v_mfma_f32_16x16x32_bf16 v[76:79], a[12:15], a[36:39], v[76:79]
    v_mfma_f32_16x16x32_bf16 v[80:83], a[16:19], a[36:39], v[80:83]
    ds_read_b64_tr_b16 a[70:71], v3 offset:17408
    v_mfma_f32_16x16x32_bf16 v[84:87], a[20:23], a[36:39], v[84:87]
    buffer_load_dwordx4 v9, s[12:15], s27 offen offset:1024 lds
    v_mfma_f32_16x16x32_bf16 v[88:91], a[24:27], a[36:39], v[88:91]
    ds_read_b128 a[100:103], v7 offset:2048
    v_mfma_f32_16x16x32_bf16 v[92:95], a[28:31], a[36:39], v[92:95]
    v_mfma_f32_16x16x32_bf16 v[96:99], a[0:3], a[40:43], v[96:99]
    ds_read_b64_tr_b16 a[72:73], v4 offset:16384
    v_mfma_f32_16x16x32_bf16 v[100:103], a[4:7], a[40:43], v[100:103]
    v_mfma_f32_16x16x32_bf16 v[104:107], a[8:11], a[40:43], v[104:107]
    ds_read_b64_tr_b16 a[74:75], v4 offset:17408
    v_mfma_f32_16x16x32_bf16 v[108:111], a[12:15], a[40:43], v[108:111]
    v_mfma_f32_16x16x32_bf16 v[112:115], a[16:19], a[40:43], v[112:115]
    ds_read_b128 a[104:107], v7 offset:4096
    v_mfma_f32_16x16x32_bf16 v[116:119], a[20:23], a[40:43], v[116:119]
    buffer_load_dwordx4 v10, s[12:15], s27 offen offset:2048 lds
    v_mfma_f32_16x16x32_bf16 v[120:123], a[24:27], a[40:43], v[120:123]
    ds_read_b64_tr_b16 a[76:77], v5 offset:16384
    v_mfma_f32_16x16x32_bf16 v[124:127], a[28:31], a[40:43], v[124:127]
    v_mfma_f32_16x16x32_bf16 v[128:131], a[0:3], a[44:47], v[128:131]
    ds_read_b64_tr_b16 a[78:79], v5 offset:17408
    v_mfma_f32_16x16x32_bf16 v[132:135], a[4:7], a[44:47], v[132:135]
    v_mfma_f32_16x16x32_bf16 v[136:139], a[8:11], a[44:47], v[136:139]
    ds_read_b128 a[108:111], v7 offset:6144
    v_mfma_f32_16x16x32_bf16 v[140:143], a[12:15], a[44:47], v[140:143]
    v_mfma_f32_16x16x32_bf16 v[144:147], a[16:19], a[44:47], v[144:147]
    ds_read_b64_tr_b16 a[80:81], v2 offset:24576
    v_mfma_f32_16x16x32_bf16 v[148:151], a[20:23], a[44:47], v[148:151]
    buffer_load_dwordx4 v11, s[12:15], s27 offen offset:3072 lds
    v_mfma_f32_16x16x32_bf16 v[152:155], a[24:27], a[44:47], v[152:155]
    ds_read_b64_tr_b16 a[82:83], v2 offset:25600
    v_mfma_f32_16x16x32_bf16 v[156:159], a[28:31], a[44:47], v[156:159]
    s_add_u32 s29, s28, 65536
    s_add_u32 s27, s27, 229376
    v_mfma_f32_16x16x32_bf16 v[160:163], a[0:3], a[48:51], v[160:163]
    ds_read_b128 a[112:115], v7 offset:8192
    v_mfma_f32_16x16x32_bf16 v[164:167], a[4:7], a[48:51], v[164:167]
    s_add_u32 m0, s34, 4096
    v_mfma_f32_16x16x32_bf16 v[168:171], a[8:11], a[48:51], v[168:171]
    ds_read_b64_tr_b16 a[84:85], v3 offset:24576
    v_mfma_f32_16x16x32_bf16 v[172:175], a[12:15], a[48:51], v[172:175]
    buffer_load_dwordx4 v12, s[8:11], s29 offen offset:0 lds
    v_mfma_f32_16x16x32_bf16 v[176:179], a[16:19], a[48:51], v[176:179]
    ds_read_b64_tr_b16 a[86:87], v3 offset:25600
    v_mfma_f32_16x16x32_bf16 v[180:183], a[20:23], a[48:51], v[180:183]
    v_mfma_f32_16x16x32_bf16 v[184:187], a[24:27], a[48:51], v[184:187]
    ds_read_b128 a[116:119], v7 offset:10240
    v_mfma_f32_16x16x32_bf16 v[188:191], a[28:31], a[48:51], v[188:191]
    v_mfma_f32_16x16x32_bf16 v[192:195], a[0:3], a[52:55], v[192:195]
    ds_read_b64_tr_b16 a[88:89], v4 offset:24576
    v_mfma_f32_16x16x32_bf16 v[196:199], a[4:7], a[52:55], v[196:199]
    v_mfma_f32_16x16x32_bf16 v[200:203], a[8:11], a[52:55], v[200:203]
    ds_read_b64_tr_b16 a[90:91], v4 offset:25600
    v_mfma_f32_16x16x32_bf16 v[204:207], a[12:15], a[52:55], v[204:207]
    buffer_load_dwordx4 v13, s[8:11], s29 offen offset:1024 lds
    v_mfma_f32_16x16x32_bf16 v[208:211], a[16:19], a[52:55], v[208:211]
    ds_read_b128 a[120:123], v7 offset:12288
    v_mfma_f32_16x16x32_bf16 v[212:215], a[20:23], a[52:55], v[212:215]
    v_mfma_f32_16x16x32_bf16 v[216:219], a[24:27], a[52:55], v[216:219]
    ds_read_b64_tr_b16 a[92:93], v5 offset:24576
    v_mfma_f32_16x16x32_bf16 v[220:223], a[28:31], a[52:55], v[220:223]
    v_mfma_f32_16x16x32_bf16 v[224:227], a[0:3], a[56:59], v[224:227]
    ds_read_b64_tr_b16 a[94:95], v5 offset:25600
    v_mfma_f32_16x16x32_bf16 v[228:231], a[4:7], a[56:59], v[228:231]
    v_mfma_f32_16x16x32_bf16 v[232:235], a[8:11], a[56:59], v[232:235]
    ds_read_b128 a[124:127], v7 offset:14336
    v_mfma_f32_16x16x32_bf16 v[236:239], a[12:15], a[56:59], v[236:239]
    buffer_load_dwordx4 v14, s[8:11], s29 offen offset:2048 lds
    v_mfma_f32_16x16x32_bf16 v[240:243], a[16:19], a[56:59], v[240:243]
    s_add_u32 s34, s34, 32768
    v_mfma_f32_16x16x32_bf16 v[244:247], a[20:23], a[56:59], v[244:247]
    s_add_u32 s35, s35, 1
    s_cmp_eq_u32 s35, 3
    v_mfma_f32_16x16x32_bf16 v[248:251], a[24:27], a[56:59], v[248:251]
    s_cselect_b32 s33, s45, s46
    s_cselect_b32 s35, 0, s35
    v_mfma_f32_16x16x32_bf16 v[252:255], a[28:31], a[56:59], v[252:255]
    v_xor_b32 v2, 0x8000, v2
    v_mfma_f32_16x16x32_bf16 a[128:131], a[0:3], a[60:63], a[128:131]
    v_xor_b32 v3, 0x8000, v3
    v_mfma_f32_16x16x32_bf16 a[132:135], a[4:7], a[60:63], a[132:135]
    v_xor_b32 v4, 0x8000, v4
    v_mfma_f32_16x16x32_bf16 a[136:139], a[8:11], a[60:63], a[136:139]
    v_xor_b32 v5, 0x8000, v5
    v_mfma_f32_16x16x32_bf16 a[140:143], a[12:15], a[60:63], a[140:143]
    buffer_load_dwordx4 v15, s[8:11], s29 offen offset:3072 lds
    v_mfma_f32_16x16x32_bf16 a[144:147], a[16:19], a[60:63], a[144:147]
    s_add_u32 s48, s48, 1
    s_xor_b32 s50, s48, s47
    v_mfma_f32_16x16x32_bf16 a[148:151], a[20:23], a[60:63], a[148:151]
    s_lshl_b32 s28, s50, 7
    s_cmp_eq_u32 s34, s44
    s_cselect_b32 s34, s31, s34
    v_mfma_f32_16x16x32_bf16 a[152:155], a[24:27], a[60:63], a[152:155]
    v_add_u32 v6, s33, v6
    s_cmp_ge_u32 s32, 13
    v_mfma_f32_16x16x32_bf16 a[156:159], a[28:31], a[60:63], a[156:159]
    v_add_u32 v7, s33, v7
    s_cselect_b32 s10, 0, s10
    s_waitcnt lgkmcnt(0)
    v_mfma_f32_16x16x32_bf16 v[32:35], a[64:67], a[96:99], v[32:35]
    v_mfma_f32_16x16x32_bf16 v[36:39], a[68:71], a[96:99], v[36:39]
    s_waitcnt vmcnt(16)
    s_barrier
    v_mfma_f32_16x16x32_bf16 v[40:43], a[72:75], a[96:99], v[40:43]
    v_mfma_f32_16x16x32_bf16 v[44:47], a[76:79], a[96:99], v[44:47]
    s_add_u32 m0, s30, 16384
    v_mfma_f32_16x16x32_bf16 v[48:51], a[80:83], a[96:99], v[48:51]
    ds_read_b64_tr_b16 a[0:1], v2 offset:0
    v_mfma_f32_16x16x32_bf16 v[52:55], a[84:87], a[96:99], v[52:55]
    buffer_load_dwordx4 v8, s[12:15], s27 offen offset:0 lds
    v_mfma_f32_16x16x32_bf16 v[56:59], a[88:91], a[96:99], v[56:59]
    ds_read_b64_tr_b16 a[2:3], v2 offset:1024
    v_mfma_f32_16x16x32_bf16 v[60:63], a[92:95], a[96:99], v[60:63]
    v_mfma_f32_16x16x32_bf16 v[64:67], a[64:67], a[100:103], v[64:67]
    ds_read_b128 a[32:35], v6 offset:0
    v_mfma_f32_16x16x32_bf16 v[68:71], a[68:71], a[100:103], v[68:71]
    v_mfma_f32_16x16x32_bf16 v[72:75], a[72:75], a[100:103], v[72:75]
    ds_read_b64_tr_b16 a[4:5], v3 offset:0
    v_mfma_f32_16x16x32_bf16 v[76:79], a[76:79], a[100:103], v[76:79]
    v_mfma_f32_16x16x32_bf16 v[80:83], a[80:83], a[100:103], v[80:83]
    ds_read_b64_tr_b16 a[6:7], v3 offset:1024
    v_mfma_f32_16x16x32_bf16 v[84:87], a[84:87], a[100:103], v[84:87]
    buffer_load_dwordx4 v9, s[12:15], s27 offen offset:1024 lds
    v_mfma_f32_16x16x32_bf16 v[88:91], a[88:91], a[100:103], v[88:91]
    ds_read_b128 a[36:39], v6 offset:2048
    v_mfma_f32_16x16x32_bf16 v[92:95], a[92:95], a[100:103], v[92:95]
    v_mfma_f32_16x16x32_bf16 v[96:99], a[64:67], a[104:107], v[96:99]
    ds_read_b64_tr_b16 a[8:9], v4 offset:0
    v_mfma_f32_16x16x32_bf16 v[100:103], a[68:71], a[104:107], v[100:103]
    v_mfma_f32_16x16x32_bf16 v[104:107], a[72:75], a[104:107], v[104:107]
    ds_read_b64_tr_b16 a[10:11], v4 offset:1024
    v_mfma_f32_16x16x32_bf16 v[108:111], a[76:79], a[104:107], v[108:111]
    v_mfma_f32_16x16x32_bf16 v[112:115], a[80:83], a[104:107], v[112:115]
    ds_read_b128 a[40:43], v6 offset:4096
    v_mfma_f32_16x16x32_bf16 v[116:119], a[84:87], a[104:107], v[116:119]
    buffer_load_dwordx4 v10, s[12:15], s27 offen offset:2048 lds
    v_mfma_f32_16x16x32_bf16 v[120:123], a[88:91], a[104:107], v[120:123]
    ds_read_b64_tr_b16 a[12:13], v5 offset:0
    v_mfma_f32_16x16x32_bf16 v[124:127], a[92:95], a[104:107], v[124:127]
    v_mfma_f32_16x16x32_bf16 v[128:131], a[64:67], a[108:111], v[128:131]
    ds_read_b64_tr_b16 a[14:15], v5 offset:1024
    v_mfma_f32_16x16x32_bf16 v[132:135], a[68:71], a[108:111], v[132:135]
    v_mfma_f32_16x16x32_bf16 v[136:139], a[72:75], a[108:111], v[136:139]
    ds_read_b128 a[44:47], v6 offset:6144
    v_mfma_f32_16x16x32_bf16 v[140:143], a[76:79], a[108:111], v[140:143]
    v_mfma_f32_16x16x32_bf16 v[144:147], a[80:83], a[108:111], v[144:147]
    ds_read_b64_tr_b16 a[16:17], v2 offset:8192
    v_mfma_f32_16x16x32_bf16 v[148:151], a[84:87], a[108:111], v[148:151]
    buffer_load_dwordx4 v11, s[12:15], s27 offen offset:3072 lds
    v_mfma_f32_16x16x32_bf16 v[152:155], a[88:91], a[108:111], v[152:155]
    ds_read_b64_tr_b16 a[18:19], v2 offset:9216
    v_mfma_f32_16x16x32_bf16 v[156:159], a[92:95], a[108:111], v[156:159]
    s_add_u32 s49, s49, 1
    s_xor_b32 s50, s49, s47
    v_mfma_f32_16x16x32_bf16 v[160:163], a[64:67], a[112:115], v[160:163]
    ds_read_b128 a[48:51], v6 offset:8192
    v_mfma_f32_16x16x32_bf16 v[164:167], a[68:71], a[112:115], v[164:167]
    s_add_u32 m0, s34, 0
    v_mfma_f32_16x16x32_bf16 v[168:171], a[72:75], a[112:115], v[168:171]
    ds_read_b64_tr_b16 a[20:21], v3 offset:8192
    v_mfma_f32_16x16x32_bf16 v[172:175], a[76:79], a[112:115], v[172:175]
    buffer_load_dwordx4 v12, s[8:11], s28 offen offset:0 lds
    v_mfma_f32_16x16x32_bf16 v[176:179], a[80:83], a[112:115], v[176:179]
    ds_read_b64_tr_b16 a[22:23], v3 offset:9216
    v_mfma_f32_16x16x32_bf16 v[180:183], a[84:87], a[112:115], v[180:183]
    s_mul_i32 s27, s50, 458752
    s_xor_b32 s30, s30, 0x8000
    v_mfma_f32_16x16x32_bf16 v[184:187], a[88:91], a[112:115], v[184:187]
    ds_read_b128 a[52:55], v6 offset:10240
    v_mfma_f32_16x16x32_bf16 v[188:191], a[92:95], a[112:115], v[188:191]
    v_mfma_f32_16x16x32_bf16 v[192:195], a[64:67], a[116:119], v[192:195]
    ds_read_b64_tr_b16 a[24:25], v4 offset:8192
    v_mfma_f32_16x16x32_bf16 v[196:199], a[68:71], a[116:119], v[196:199]
    v_mfma_f32_16x16x32_bf16 v[200:203], a[72:75], a[116:119], v[200:203]
    ds_read_b64_tr_b16 a[26:27], v4 offset:9216
    v_mfma_f32_16x16x32_bf16 v[204:207], a[76:79], a[116:119], v[204:207]
    buffer_load_dwordx4 v13, s[8:11], s28 offen offset:1024 lds
    v_mfma_f32_16x16x32_bf16 v[208:211], a[80:83], a[116:119], v[208:211]
    ds_read_b128 a[56:59], v6 offset:12288
    v_mfma_f32_16x16x32_bf16 v[212:215], a[84:87], a[116:119], v[212:215]
    v_mfma_f32_16x16x32_bf16 v[216:219], a[88:91], a[116:119], v[216:219]
    ds_read_b64_tr_b16 a[28:29], v5 offset:8192
    v_mfma_f32_16x16x32_bf16 v[220:223], a[92:95], a[116:119], v[220:223]
    v_mfma_f32_16x16x32_bf16 v[224:227], a[64:67], a[120:123], v[224:227]
    ds_read_b64_tr_b16 a[30:31], v5 offset:9216
    v_mfma_f32_16x16x32_bf16 v[228:231], a[68:71], a[120:123], v[228:231]
    v_mfma_f32_16x16x32_bf16 v[232:235], a[72:75], a[120:123], v[232:235]
    ds_read_b128 a[60:63], v6 offset:14336
    v_mfma_f32_16x16x32_bf16 v[236:239], a[76:79], a[120:123], v[236:239]
    buffer_load_dwordx4 v14, s[8:11], s28 offen offset:2048 lds
    v_mfma_f32_16x16x32_bf16 v[240:243], a[80:83], a[120:123], v[240:243]
    v_mfma_f32_16x16x32_bf16 v[244:247], a[84:87], a[120:123], v[244:247]
    v_mfma_f32_16x16x32_bf16 v[248:251], a[88:91], a[120:123], v[248:251]
    v_mfma_f32_16x16x32_bf16 v[252:255], a[92:95], a[120:123], v[252:255]
    buffer_load_dword v16, v18, s[84:87], 0 offen
    v_mfma_f32_16x16x32_bf16 a[128:131], a[64:67], a[124:127], a[128:131]
    v_mfma_f32_16x16x32_bf16 a[132:135], a[68:71], a[124:127], a[132:135]
    v_add_u32 v18, 1024, v18
    v_mfma_f32_16x16x32_bf16 a[136:139], a[72:75], a[124:127], a[136:139]
    v_mfma_f32_16x16x32_bf16 a[140:143], a[76:79], a[124:127], a[140:143]
    buffer_load_dwordx4 v15, s[8:11], s28 offen offset:3072 lds
    v_mfma_f32_16x16x32_bf16 a[144:147], a[80:83], a[124:127], a[144:147]
    v_mfma_f32_16x16x32_bf16 a[148:151], a[84:87], a[124:127], a[148:151]
    v_mfma_f32_16x16x32_bf16 a[152:155], a[88:91], a[124:127], a[152:155]
    s_add_u32 s32, s32, 1
    s_cmp_lt_u32 s32, 15
    v_mfma_f32_16x16x32_bf16 a[156:159], a[92:95], a[124:127], a[156:159]
    s_cbranch_scc1 fused_kernel_loop
fused_kernel_lend:
    s_waitcnt lgkmcnt(0)
    v_mfma_f32_16x16x32_bf16 v[32:35], a[0:3], a[32:35], v[32:35]
    v_mfma_f32_16x16x32_bf16 v[36:39], a[4:7], a[32:35], v[36:39]
    s_waitcnt vmcnt(0)
    s_barrier
    v_mfma_f32_16x16x32_bf16 v[40:43], a[8:11], a[32:35], v[40:43]
    v_mov_b32 v23, 128
    s_and_b32 s3, s2, 7
    s_lshr_b32 s48, s2, 3
    s_and_b32 s49, s3, 1
    v_mfma_f32_16x16x32_bf16 v[44:47], a[12:15], a[32:35], v[44:47]
    ds_read_b64_tr_b16 a[64:65], v2 offset:16384
    s_lshl_b32 s49, s49, 3
    s_and_b32 s50, s48, 7
    s_add_u32 s27, s49, s50
    global_load_dword v22, v23, s[98:99] sc1
    v_mfma_f32_16x16x32_bf16 v[48:51], a[16:19], a[32:35], v[48:51]
    ds_read_b64_tr_b16 a[66:67], v2 offset:17408
    s_bfe_u32 s35, s3, 0x10001
    s_lshl_b32 s49, s35, 2
    s_lshr_b32 s50, s48, 3
    v_mfma_f32_16x16x32_bf16 v[52:55], a[20:23], a[32:35], v[52:55]
    ds_read_b128 a[96:99], v7 offset:0
    s_add_u32 s28, s49, s50
    s_lshr_b32 s29, s3, 2
    s_lshl_b32 s30, s2, 2
    v_mfma_f32_16x16x32_bf16 v[56:59], a[24:27], a[32:35], v[56:59]
    ds_read_b64_tr_b16 a[68:69], v3 offset:16384
    s_add_u32 s30, s30, s24
    s_mul_i32 s31, s24, 17728
    s_add_u32 s31, s31, 92928
    v_mfma_f32_16x16x32_bf16 v[60:63], a[28:31], a[32:35], v[60:63]
    ds_read_b64_tr_b16 a[70:71], v3 offset:17408
    s_lshl_b32 s32, s24, 12
    s_add_u32 s48, s27, s28
    s_and_b32 s48, s48, 1
    v_mfma_f32_16x16x32_bf16 v[64:67], a[0:3], a[36:39], v[64:67]
    ds_read_b128 a[100:103], v7 offset:2048
    s_and_b32 s35, s35, 1
    s_lshl_b32 s49, s48, 1
    s_sub_u32 s46, 1, s49
    v_mfma_f32_16x16x32_bf16 v[68:71], a[4:7], a[36:39], v[68:71]
    ds_read_b64_tr_b16 a[72:73], v4 offset:16384
    s_add_u32 s47, 1, s49
    s_sub_u32 s49, 27, s48
    s_cmp_eq_u32 s35, 1
    v_mfma_f32_16x16x32_bf16 v[72:75], a[8:11], a[36:39], v[72:75]
    ds_read_b64_tr_b16 a[74:75], v4 offset:17408
    s_cselect_b32 s34, s49, s48
    s_cselect_b32 s49, -1, 1
    s_mul_i32 s46, s46, s49
    v_mfma_f32_16x16x32_bf16 v[76:79], a[12:15], a[36:39], v[76:79]
    ds_read_b128 a[104:107], v7 offset:4096
    s_mul_i32 s47, s47, s49
    s_lshl_b32 s33, s34, 17
    s_lshl_b32 s34, s34, 11
    v_mfma_f32_16x16x32_bf16 v[80:83], a[16:19], a[36:39], v[80:83]
    ds_read_b64_tr_b16 a[76:77], v5 offset:16384
    s_lshl_b32 s44, s46, 17
    s_lshl_b32 s45, s47, 17
    s_lshl_b32 s46, s46, 11
    v_mfma_f32_16x16x32_bf16 v[84:87], a[20:23], a[36:39], v[84:87]
    ds_read_b64_tr_b16 a[78:79], v5 offset:17408
    s_lshl_b32 s47, s47, 11
    v_lshrrev_b32 v19, 4, v0
    v_lshlrev_b32 v18, 11, v19
    v_mfma_f32_16x16x32_bf16 v[88:91], a[24:27], a[36:39], v[88:91]
    ds_read_b128 a[108:111], v7 offset:6144
    v_bfe_u32 v20, v0, 1, 3
    v_xor_b32 v20, v20, v19
    v_lshlrev_b32 v20, 5, v20
    v_mfma_f32_16x16x32_bf16 v[92:95], a[28:31], a[36:39], v[92:95]
    ds_read_b64_tr_b16 a[80:81], v2 offset:24576
    v_and_b32 v21, 1, v0
    v_lshl_add_u32 v20, v21, 4, v20
    v_add_u32 v18, v18, v20
    v_mfma_f32_16x16x32_bf16 v[96:99], a[0:3], a[40:43], v[96:99]
    ds_read_b64_tr_b16 a[82:83], v2 offset:25600
    s_lshl_b32 s48, s24, 15
    s_lshl_b32 s49, s28, 8
    s_add_u32 s48, s48, s49
    v_mfma_f32_16x16x32_bf16 v[100:103], a[4:7], a[40:43], v[100:103]
    ds_read_b128 a[112:115], v7 offset:8192
    s_mul_i32 s49, s29, 3670016
    s_add_u32 s48, s48, s49
    v_add_u32 v18, s48, v18
    v_mfma_f32_16x16x32_bf16 v[104:107], a[8:11], a[40:43], v[104:107]
    ds_read_b64_tr_b16 a[84:85], v3 offset:24576
    v_xor_b32 v21, 128, v18
    v_add_u32 v19, 7168, v21
    v_add_u32 v20, 14336, v18
    v_mfma_f32_16x16x32_bf16 v[108:111], a[12:15], a[40:43], v[108:111]
    ds_read_b64_tr_b16 a[86:87], v3 offset:25600
    v_add_u32 v21, 21504, v21
    s_add_u32 s56, s6, 22020096
    s_addc_u32 s57, s7, 0
    v_mfma_f32_16x16x32_bf16 v[112:115], a[16:19], a[40:43], v[112:115]
    ds_read_b128 a[116:119], v7 offset:10240
    s_mov_b32 s8, s92
    s_and_b32 s9, s93, 0xffff
    s_mov_b32 s10, 0x700000
    v_mfma_f32_16x16x32_bf16 v[116:119], a[20:23], a[40:43], v[116:119]
    ds_read_b64_tr_b16 a[88:89], v4 offset:24576
    s_mov_b32 s11, 0x20000
    s_add_u32 s4, s6, 25165808
    s_addc_u32 s5, s7, 0
    v_mfma_f32_16x16x32_bf16 v[120:123], a[24:27], a[40:43], v[120:123]
    ds_read_b64_tr_b16 a[90:91], v4 offset:25600
    s_mov_b32 s16, s4
    s_and_b32 s17, s5, 0xffff
    s_mov_b32 s18, 0x400010
    v_mfma_f32_16x16x32_bf16 v[124:127], a[28:31], a[40:43], v[124:127]
    ds_read_b128 a[120:123], v7 offset:12288
    s_mov_b32 s19, 0x20000
    s_add_u32 s4, s6, 58720256
    s_addc_u32 s5, s7, 0
    v_mfma_f32_16x16x32_bf16 v[128:131], a[0:3], a[44:47], v[128:131]
    ds_read_b64_tr_b16 a[92:93], v5 offset:24576
    s_mov_b32 s12, s4
    s_and_b32 s13, s5, 0xffff
    s_mov_b32 s14, 0x800000
    v_mfma_f32_16x16x32_bf16 v[132:135], a[4:7], a[44:47], v[132:135]
    ds_read_b64_tr_b16 a[94:95], v5 offset:25600
    s_mov_b32 s15, 0x20000
    s_add_u32 s4, s6, 16777216
    s_addc_u32 s5, s7, 0
    v_mfma_f32_16x16x32_bf16 v[136:139], a[8:11], a[44:47], v[136:139]
    ds_read_b128 a[124:127], v7 offset:14336
    s_mov_b32 s84, s4
    s_and_b32 s85, s5, 0xffff
    s_mov_b32 s86, 0x400000
    v_mfma_f32_16x16x32_bf16 v[140:143], a[12:15], a[44:47], v[140:143]
    s_mov_b32 s87, 0x20000
    v_mfma_f32_16x16x32_bf16 v[144:147], a[16:19], a[44:47], v[144:147]
    s_add_u32 m0, s32, 0
    v_mfma_f32_16x16x32_bf16 v[148:151], a[20:23], a[44:47], v[148:151]
    buffer_load_dwordx4 v18, s[8:11], s33 offen offset:0 lds
    v_mfma_f32_16x16x32_bf16 v[152:155], a[24:27], a[44:47], v[152:155]
    v_mfma_f32_16x16x32_bf16 v[156:159], a[28:31], a[44:47], v[156:159]
    s_waitcnt lgkmcnt(0)
    v_mfma_f32_16x16x32_bf16 v[32:35], a[64:67], a[96:99], v[32:35]
    buffer_load_dwordx4 v19, s[8:11], s33 offen offset:1024 lds
    v_mfma_f32_16x16x32_bf16 v[36:39], a[68:71], a[96:99], v[36:39]
    s_barrier
    v_mfma_f32_16x16x32_bf16 v[40:43], a[72:75], a[96:99], v[40:43]
    v_mfma_f32_16x16x32_bf16 v[44:47], a[76:79], a[96:99], v[44:47]
    buffer_load_dwordx4 v20, s[8:11], s33 offen offset:2048 lds
    v_mfma_f32_16x16x32_bf16 v[48:51], a[80:83], a[96:99], v[48:51]
    s_lshl_b32 s51, s25, 2
    s_and_b32 s48, s24, 2
    s_add_u32 s51, s51, s48
    s_cmp_ge_u32 s26, 14
    s_addc_u32 s51, s51, 0
    s_lshl_b32 s51, s51, 8
    s_add_u32 s51, s51, 36864

    s_waitcnt vmcnt(3)
    v_readfirstlane_b32 s48, v22
    s_mov_b32 s49, 0
    s_cmp_ge_u32 s48, 128
    s_cbranch_scc1 fused_kernel_sz_go
    fused_kernel_sz:
    s_sleep 4
    global_load_dword v22, v23, s[98:99] sc1
    s_add_u32 s49, s49, 1
    s_waitcnt vmcnt(0)
    v_readfirstlane_b32 s48, v22
    s_cmp_ge_u32 s49, 0x40000
    s_cbranch_scc1 fused_kernel_sz_go
    s_cmp_lt_u32 s48, 128
    s_cbranch_scc1 fused_kernel_sz
    fused_kernel_sz_go:
    s_and_b32 s48, s30, 63
    s_lshl_b32 s48, s48, 7
    s_add_u32 s48, s48, 65536
    v_mov_b32 v23, s48
    s_lshr_b32 s36, s24, 1
    s_lshl_b32 s36, s36, 3
    s_lshl_b32 s37, s25, 4
    s_add_u32 s36, s36, s37
    s_mul_i32 s36, s36, 112
    s_and_b32 s37, s24, 1
    s_mul_i32 s37, s37, 2
    s_add_u32 s36, s36, s37
    s_lshl_b32 s38, s26, 8
    s_lshr_b32 s37, s38, 6
    s_add_u32 s36, s36, s37
    s_lshl_b32 s36, s36, 10
    s_mov_b32 s38, 0xbfb8aa3b
    s_mov_b32 s39, 0xbfb8aa3b
    s_nop 7

    v_mfma_f32_16x16x32_bf16 v[52:55], a[84:87], a[96:99], v[52:55]
    v_mfma_f32_16x16x32_bf16 v[56:59], a[88:91], a[96:99], v[56:59]
    buffer_load_dwordx4 v21, s[8:11], s33 offen offset:3072 lds
    s_add_u32 s33, s33, s44
    v_mfma_f32_16x16x32_bf16 v[60:63], a[92:95], a[96:99], v[60:63]
    v_mfma_f32_16x16x32_bf16 v[64:67], a[64:67], a[100:103], v[64:67]
    s_add_u32 m0, s32, 16384
    v_mfma_f32_16x16x32_bf16 v[68:71], a[68:71], a[100:103], v[68:71]
    buffer_load_dwordx4 v18, s[8:11], s33 offen offset:0 lds
    v_mfma_f32_16x16x32_bf16 v[72:75], a[72:75], a[100:103], v[72:75]
    v_mfma_f32_16x16x32_bf16 v[76:79], a[76:79], a[100:103], v[76:79]
    v_mfma_f32_16x16x32_bf16 v[80:83], a[80:83], a[100:103], v[80:83]
    buffer_load_dwordx4 v19, s[8:11], s33 offen offset:1024 lds
    v_pk_mul_f32 v[2:3], v[32:33], s[38:39]
    v_pk_mul_f32 v[4:5], v[34:35], s[38:39]
    v_pk_mul_f32 v[6:7], v[36:37], s[38:39]
    v_mfma_f32_16x16x32_bf16 v[84:87], a[84:87], a[100:103], v[84:87]
    v_pk_mul_f32 v[8:9], v[38:39], s[38:39]
    v_exp_f32 v2, v2
    v_exp_f32 v3, v3
    v_mfma_f32_16x16x32_bf16 v[88:91], a[88:91], a[100:103], v[88:91]
    v_exp_f32 v4, v4
    v_exp_f32 v5, v5
    v_exp_f32 v6, v6
    v_mfma_f32_16x16x32_bf16 v[92:95], a[92:95], a[100:103], v[92:95]
    buffer_load_dwordx4 v20, s[8:11], s33 offen offset:2048 lds
    v_exp_f32 v7, v7
    v_exp_f32 v8, v8
    v_exp_f32 v9, v9
    v_mfma_f32_16x16x32_bf16 v[160:163], a[0:3], a[48:51], v[160:163]
    v_pk_mul_f32 v[32:33], v[32:33], v[48:49]
    v_pk_mul_f32 v[34:35], v[34:35], v[50:51]
    v_pk_mul_f32 v[36:37], v[36:37], v[52:53]
    v_mfma_f32_16x16x32_bf16 v[164:167], a[4:7], a[48:51], v[164:167]
    v_pk_mul_f32 v[38:39], v[38:39], v[54:55]
    v_pk_add_f32 v[2:3], v[2:3], 1.0 op_sel_hi:[1,0]
    v_pk_add_f32 v[4:5], v[4:5], 1.0 op_sel_hi:[1,0]
    v_mfma_f32_16x16x32_bf16 v[168:171], a[8:11], a[48:51], v[168:171]
    buffer_load_dwordx4 v21, s[8:11], s33 offen offset:3072 lds
    s_add_u32 s33, s33, s45
    v_pk_add_f32 v[6:7], v[6:7], 1.0 op_sel_hi:[1,0]
    v_pk_add_f32 v[8:9], v[8:9], 1.0 op_sel_hi:[1,0]
    v_rcp_f32 v2, v2
    v_mfma_f32_16x16x32_bf16 v[172:175], a[12:15], a[48:51], v[172:175]
    v_rcp_f32 v3, v3
    v_rcp_f32 v4, v4
    v_rcp_f32 v5, v5
    v_mfma_f32_16x16x32_bf16 v[176:179], a[16:19], a[48:51], v[176:179]
    s_add_u32 m0, s32, 32768
    v_rcp_f32 v6, v6
    v_rcp_f32 v7, v7
    v_rcp_f32 v8, v8
    v_mfma_f32_16x16x32_bf16 v[180:183], a[20:23], a[48:51], v[180:183]
    buffer_load_dwordx4 v18, s[8:11], s33 offen offset:0 lds
    v_rcp_f32 v9, v9
    s_nop 0
    v_pk_mul_f32 v[32:33], v[32:33], v[2:3]
    v_mfma_f32_16x16x32_bf16 v[184:187], a[24:27], a[48:51], v[184:187]
    v_pk_mul_f32 v[34:35], v[34:35], v[4:5]
    v_pk_mul_f32 v[36:37], v[36:37], v[6:7]
    v_pk_mul_f32 v[38:39], v[38:39], v[8:9]
    v_mfma_f32_16x16x32_bf16 v[188:191], a[28:31], a[48:51], v[188:191]
    v_cvt_pk_bf16_f32 v24, v32, v33
    v_cvt_pk_bf16_f32 v25, v34, v35
    v_cvt_pk_bf16_f32 v26, v36, v37
    v_mfma_f32_16x16x32_bf16 v[96:99], a[64:67], a[104:107], v[96:99]
    buffer_load_dwordx4 v19, s[8:11], s33 offen offset:1024 lds
    v_cvt_pk_bf16_f32 v27, v38, v39
    buffer_store_dwordx4 v[24:27], v1, s[20:23], s36 offen offset:0 sc1
    v_pk_mul_f32 v[2:3], v[40:41], s[38:39]
    v_mfma_f32_16x16x32_bf16 v[100:103], a[68:71], a[104:107], v[100:103]
    v_pk_mul_f32 v[4:5], v[42:43], s[38:39]
    v_pk_mul_f32 v[6:7], v[44:45], s[38:39]
    v_pk_mul_f32 v[8:9], v[46:47], s[38:39]
    v_mfma_f32_16x16x32_bf16 v[104:107], a[72:75], a[104:107], v[104:107]
    v_exp_f32 v2, v2
    v_exp_f32 v3, v3
    v_exp_f32 v4, v4
    v_mfma_f32_16x16x32_bf16 v[108:111], a[76:79], a[104:107], v[108:111]
    buffer_load_dwordx4 v20, s[8:11], s33 offen offset:2048 lds
    v_exp_f32 v5, v5
    v_exp_f32 v6, v6
    v_exp_f32 v7, v7
    v_mfma_f32_16x16x32_bf16 v[112:115], a[80:83], a[104:107], v[112:115]
    v_exp_f32 v8, v8
    v_exp_f32 v9, v9
    v_pk_mul_f32 v[40:41], v[40:41], v[56:57]
    v_mfma_f32_16x16x32_bf16 v[116:119], a[84:87], a[104:107], v[116:119]
    v_pk_mul_f32 v[42:43], v[42:43], v[58:59]
    v_pk_mul_f32 v[44:45], v[44:45], v[60:61]
    v_pk_mul_f32 v[46:47], v[46:47], v[62:63]
    v_mfma_f32_16x16x32_bf16 v[120:123], a[88:91], a[104:107], v[120:123]
    buffer_load_dwordx4 v21, s[8:11], s33 offen offset:3072 lds
    s_add_u32 s33, s33, s44
    v_pk_add_f32 v[2:3], v[2:3], 1.0 op_sel_hi:[1,0]
    v_pk_add_f32 v[4:5], v[4:5], 1.0 op_sel_hi:[1,0]
    v_pk_add_f32 v[6:7], v[6:7], 1.0 op_sel_hi:[1,0]
    v_mfma_f32_16x16x32_bf16 v[124:127], a[92:95], a[104:107], v[124:127]
    v_pk_add_f32 v[8:9], v[8:9], 1.0 op_sel_hi:[1,0]
    v_rcp_f32 v2, v2
    v_rcp_f32 v3, v3
    v_mfma_f32_16x16x32_bf16 v[192:195], a[0:3], a[52:55], v[192:195]
    v_rcp_f32 v4, v4
    v_rcp_f32 v5, v5
    v_rcp_f32 v6, v6
    v_mfma_f32_16x16x32_bf16 v[196:199], a[4:7], a[52:55], v[196:199]
    v_rcp_f32 v7, v7
    v_rcp_f32 v8, v8
    v_rcp_f32 v9, v9
    v_mfma_f32_16x16x32_bf16 v[200:203], a[8:11], a[52:55], v[200:203]
    s_nop 0
    v_pk_mul_f32 v[40:41], v[40:41], v[2:3]
    v_pk_mul_f32 v[42:43], v[42:43], v[4:5]
    v_mfma_f32_16x16x32_bf16 v[204:207], a[12:15], a[52:55], v[204:207]
    s_add_u32 m0, s32, 49152
    v_pk_mul_f32 v[44:45], v[44:45], v[6:7]
    v_pk_mul_f32 v[46:47], v[46:47], v[8:9]
    v_cvt_pk_bf16_f32 v28, v40, v41
    v_mfma_f32_16x16x32_bf16 v[208:211], a[16:19], a[52:55], v[208:211]
    buffer_load_dwordx4 v18, s[8:11], s33 offen offset:0 lds
    v_cvt_pk_bf16_f32 v29, v42, v43
    v_cvt_pk_bf16_f32 v30, v44, v45
    v_cvt_pk_bf16_f32 v31, v46, v47
    v_mfma_f32_16x16x32_bf16 v[212:215], a[20:23], a[52:55], v[212:215]
    buffer_store_dwordx4 v[28:31], v1, s[20:23], s36 offen offset:1024 sc1
    s_add_u32 s36, s36, 114688
    v_pk_mul_f32 v[2:3], v[64:65], s[38:39]
    v_mfma_f32_16x16x32_bf16 v[216:219], a[24:27], a[52:55], v[216:219]
    v_pk_mul_f32 v[4:5], v[66:67], s[38:39]
    v_pk_mul_f32 v[6:7], v[68:69], s[38:39]
    v_pk_mul_f32 v[8:9], v[70:71], s[38:39]
    v_mfma_f32_16x16x32_bf16 v[220:223], a[28:31], a[52:55], v[220:223]
    v_exp_f32 v2, v2
    v_exp_f32 v3, v3
    v_exp_f32 v4, v4
    v_mfma_f32_16x16x32_bf16 v[128:131], a[64:67], a[108:111], v[128:131]
    v_exp_f32 v5, v5
    v_exp_f32 v6, v6
    v_exp_f32 v7, v7
    v_mfma_f32_16x16x32_bf16 v[132:135], a[68:71], a[108:111], v[132:135]
    v_exp_f32 v8, v8
    v_exp_f32 v9, v9
    v_pk_mul_f32 v[64:65], v[64:65], v[80:81]
    v_mfma_f32_16x16x32_bf16 v[136:139], a[72:75], a[108:111], v[136:139]
    buffer_load_dwordx4 v19, s[8:11], s33 offen offset:1024 lds
    v_pk_mul_f32 v[66:67], v[66:67], v[82:83]
    v_pk_mul_f32 v[68:69], v[68:69], v[84:85]
    v_pk_mul_f32 v[70:71], v[70:71], v[86:87]
    v_mfma_f32_16x16x32_bf16 v[140:143], a[76:79], a[108:111], v[140:143]
    v_pk_add_f32 v[2:3], v[2:3], 1.0 op_sel_hi:[1,0]
    v_pk_add_f32 v[4:5], v[4:5], 1.0 op_sel_hi:[1,0]
    v_pk_add_f32 v[6:7], v[6:7], 1.0 op_sel_hi:[1,0]
    v_mfma_f32_16x16x32_bf16 v[144:147], a[80:83], a[108:111], v[144:147]
    v_pk_add_f32 v[8:9], v[8:9], 1.0 op_sel_hi:[1,0]
    v_rcp_f32 v2, v2
    v_rcp_f32 v3, v3
    v_mfma_f32_16x16x32_bf16 v[148:151], a[84:87], a[108:111], v[148:151]
    v_rcp_f32 v4, v4
    v_rcp_f32 v5, v5
    v_rcp_f32 v6, v6
    v_mfma_f32_16x16x32_bf16 v[152:155], a[88:91], a[108:111], v[152:155]
    v_rcp_f32 v7, v7
    v_rcp_f32 v8, v8
    v_rcp_f32 v9, v9
    v_mfma_f32_16x16x32_bf16 v[156:159], a[92:95], a[108:111], v[156:159]
    s_nop 0
    v_pk_mul_f32 v[64:65], v[64:65], v[2:3]
    v_pk_mul_f32 v[66:67], v[66:67], v[4:5]
    v_mfma_f32_16x16x32_bf16 v[224:227], a[0:3], a[56:59], v[224:227]
    buffer_load_dwordx4 v20, s[8:11], s33 offen offset:2048 lds
    v_pk_mul_f32 v[68:69], v[68:69], v[6:7]
    v_pk_mul_f32 v[70:71], v[70:71], v[8:9]
    v_cvt_pk_bf16_f32 v24, v64, v65
    v_mfma_f32_16x16x32_bf16 v[228:231], a[4:7], a[56:59], v[228:231]
    v_cvt_pk_bf16_f32 v25, v66, v67
    v_cvt_pk_bf16_f32 v26, v68, v69
    v_cvt_pk_bf16_f32 v27, v70, v71
    v_mfma_f32_16x16x32_bf16 v[232:235], a[8:11], a[56:59], v[232:235]
    buffer_store_dwordx4 v[24:27], v1, s[20:23], s36 offen offset:0 sc1
    v_pk_mul_f32 v[2:3], v[72:73], s[38:39]
    v_pk_mul_f32 v[4:5], v[74:75], s[38:39]
    v_mfma_f32_16x16x32_bf16 v[236:239], a[12:15], a[56:59], v[236:239]
    v_pk_mul_f32 v[6:7], v[76:77], s[38:39]
    v_pk_mul_f32 v[8:9], v[78:79], s[38:39]
    v_exp_f32 v2, v2
    v_mfma_f32_16x16x32_bf16 v[240:243], a[16:19], a[56:59], v[240:243]
    v_exp_f32 v3, v3
    v_exp_f32 v4, v4
    v_exp_f32 v5, v5
    v_mfma_f32_16x16x32_bf16 v[244:247], a[20:23], a[56:59], v[244:247]
    v_exp_f32 v6, v6
    s_lshl_b32 s50, s30, 11
    s_add_u32 s50, s50, 16
    v_mfma_f32_16x16x32_bf16 v[248:251], a[24:27], a[56:59], v[248:251]
    buffer_load_dwordx4 v21, s[8:11], s33 offen offset:3072 lds
    s_add_u32 s33, s33, s45
    v_exp_f32 v7, v7
    v_sub_u32 v66, 575, v0
    v_lshrrev_b32 v66, 1, v66
    v_mfma_f32_16x16x32_bf16 v[252:255], a[28:31], a[56:59], v[252:255]
    v_exp_f32 v8, v8
    v_lshl_add_u32 v40, v66, 2, s50
    v_exp_f32 v9, v9
    v_mfma_f32_16x16x32_bf16 a[128:131], a[0:3], a[60:63], a[128:131]
    v_lshlrev_b32 v66, 2, v0
    v_sub_u32 v66, 1020, v66
    v_pk_mul_f32 v[72:73], v[72:73], v[88:89]
    v_mfma_f32_16x16x32_bf16 a[132:135], a[4:7], a[60:63], a[132:135]
    v_add_u32 v41, s50, v66
    v_pk_mul_f32 v[74:75], v[74:75], v[90:91]
    v_cmp_gt_u32 vcc, 32, v0
    v_mfma_f32_16x16x32_bf16 a[136:139], a[8:11], a[60:63], a[136:139]
    v_lshlrev_b32 v66, 3, v0
    v_pk_mul_f32 v[76:77], v[76:77], v[92:93]
    v_lshlrev_b32 v67, 4, v0
    v_mfma_f32_16x16x32_bf16 a[140:143], a[12:15], a[60:63], a[140:143]
    s_add_u32 m0, s32, 65536
    v_pk_mul_f32 v[78:79], v[78:79], v[94:95]
    v_sub_u32 v66, 764, v66
    v_sub_u32 v67, 1016, v67
    v_mfma_f32_16x16x32_bf16 a[144:147], a[16:19], a[60:63], a[144:147]
    buffer_load_dwordx4 v18, s[8:11], s33 offen offset:0 lds
    v_pk_add_f32 v[2:3], v[2:3], 1.0 op_sel_hi:[1,0]
    v_cndmask_b32 v66, v67, v66, vcc
    v_pk_add_f32 v[4:5], v[4:5], 1.0 op_sel_hi:[1,0]
    v_mfma_f32_16x16x32_bf16 a[148:151], a[20:23], a[60:63], a[148:151]
    v_add_u32 v42, s50, v66
    v_cndmask_b32 v67, 12, 8, vcc
    v_pk_add_f32 v[6:7], v[6:7], 1.0 op_sel_hi:[1,0]
    v_mfma_f32_16x16x32_bf16 a[152:155], a[24:27], a[60:63], a[152:155]
    v_sub_u32 v43, v42, v67
    v_pk_add_f32 v[8:9], v[8:9], 1.0 op_sel_hi:[1,0]
    v_cndmask_b32 v66, 0, -1, vcc
    v_mfma_f32_16x16x32_bf16 a[156:159], a[28:31], a[60:63], a[156:159]
    v_cmp_gt_u32 vcc, 31, v0
    v_rcp_f32 v2, v2
    v_bfe_i32 v67, v0, 0, 1
    v_mfma_f32_16x16x32_bf16 v[160:163], a[64:67], a[112:115], v[160:163]
    v_rcp_f32 v3, v3
    v_and_b32 v60, 33687046, v66
    v_xor_b32 v60, 50464004, v60
    v_mfma_f32_16x16x32_bf16 v[164:167], a[68:71], a[112:115], v[164:167]
    v_rcp_f32 v4, v4
    v_and_b32 v61, 33686532, v66
    v_rcp_f32 v5, v5
    v_mfma_f32_16x16x32_bf16 v[168:171], a[72:75], a[112:115], v[168:171]
    buffer_load_dwordx4 v19, s[8:11], s33 offen offset:1024 lds
    v_xor_b32 v61, 50464004, v61
    v_and_b32 v63, 101057026, v66
    v_rcp_f32 v6, v6
    v_mfma_f32_16x16x32_bf16 v[172:175], a[76:79], a[112:115], v[172:175]
    v_xor_b32 v63, 84150022, v63
    v_and_b32 v64, 67372550, v66
    v_rcp_f32 v7, v7
    v_mfma_f32_16x16x32_bf16 v[176:179], a[80:83], a[112:115], v[176:179]
    v_xor_b32 v64, 84150022, v64
    v_rcp_f32 v8, v8
    v_and_b32 v65, 514, v66
    v_mfma_f32_16x16x32_bf16 v[180:183], a[84:87], a[112:115], v[180:183]
    v_xor_b32 v65, 84150022, v65
    v_rcp_f32 v9, v9
    v_cndmask_b32 v66, 0, -1, vcc
    v_mfma_f32_16x16x32_bf16 v[184:187], a[88:91], a[112:115], v[184:187]
    s_nop 0
    v_and_b32 v56, 101058054, v67
    v_xor_b32 v56, 84149508, v56
    v_mfma_f32_16x16x32_bf16 v[188:191], a[92:95], a[112:115], v[188:191]
    v_pk_mul_f32 v[72:73], v[72:73], v[2:3]
    v_and_b32 v57, 33686018, v67
    v_pk_mul_f32 v[74:75], v[74:75], v[4:5]
    v_mfma_f32_16x16x32_bf16 v[192:195], a[64:67], a[116:119], v[192:195]
    buffer_load_dwordx4 v20, s[8:11], s33 offen offset:2048 lds
    v_xor_b32 v57, 50463490, v57
    v_and_b32 v58, 33686532, v67
    v_pk_mul_f32 v[76:77], v[76:77], v[6:7]
    v_mfma_f32_16x16x32_bf16 v[196:199], a[68:71], a[116:119], v[196:199]
    v_xor_b32 v58, 50464004, v58
    v_pk_mul_f32 v[78:79], v[78:79], v[8:9]
    v_and_b32 v59, 67372550, v67
    v_mfma_f32_16x16x32_bf16 v[200:203], a[72:75], a[116:119], v[200:203]
    v_xor_b32 v59, 84149508, v59
    v_cvt_pk_bf16_f32 v28, v72, v73
    v_and_b32 v62, 101056512, v66
    v_mfma_f32_16x16x32_bf16 v[204:207], a[76:79], a[116:119], v[204:207]
    v_cvt_pk_bf16_f32 v29, v74, v75
    v_xor_b32 v62, 50464004, v62
    s_mov_b32 s25, 50464004
    v_mfma_f32_16x16x32_bf16 v[208:211], a[80:83], a[116:119], v[208:211]
    v_cvt_pk_bf16_f32 v30, v76, v77
    s_mov_b32 s26, 50463490
    v_cvt_pk_bf16_f32 v31, v78, v79
    v_mfma_f32_16x16x32_bf16 v[212:215], a[84:87], a[116:119], v[212:215]
    s_mov_b32 s37, 16777472
    s_mov_b32 s58, 84149508
    buffer_store_dwordx4 v[28:31], v1, s[20:23], s36 offen offset:1024 sc1
    v_mfma_f32_16x16x32_bf16 v[216:219], a[88:91], a[116:119], v[216:219]
    buffer_load_dwordx4 v21, s[8:11], s33 offen offset:3072 lds
    s_add_u32 s33, s33, s44
    s_mov_b32 s59, 16777986
    s_add_u32 s36, s36, 114688
    v_pk_mul_f32 v[2:3], v[96:97], s[38:39]
    v_mfma_f32_16x16x32_bf16 v[220:223], a[92:95], a[116:119], v[220:223]
    v_pk_mul_f32 v[4:5], v[98:99], s[38:39]
    v_pk_mul_f32 v[6:7], v[100:101], s[38:39]
    v_pk_mul_f32 v[8:9], v[102:103], s[38:39]
    v_mfma_f32_16x16x32_bf16 v[224:227], a[64:67], a[120:123], v[224:227]
    v_exp_f32 v2, v2
    v_exp_f32 v3, v3
    v_exp_f32 v4, v4
    v_mfma_f32_16x16x32_bf16 v[228:231], a[68:71], a[120:123], v[228:231]
    v_exp_f32 v5, v5
    v_exp_f32 v6, v6
    v_exp_f32 v7, v7
    v_mfma_f32_16x16x32_bf16 v[232:235], a[72:75], a[120:123], v[232:235]
    v_exp_f32 v8, v8
    v_exp_f32 v9, v9
    v_pk_mul_f32 v[96:97], v[96:97], v[112:113]
    v_mfma_f32_16x16x32_bf16 v[236:239], a[76:79], a[120:123], v[236:239]
    v_pk_mul_f32 v[98:99], v[98:99], v[114:115]
    v_pk_mul_f32 v[100:101], v[100:101], v[116:117]
    v_pk_mul_f32 v[102:103], v[102:103], v[118:119]
    v_mfma_f32_16x16x32_bf16 v[240:243], a[80:83], a[120:123], v[240:243]
    v_pk_add_f32 v[2:3], v[2:3], 1.0 op_sel_hi:[1,0]
    v_pk_add_f32 v[4:5], v[4:5], 1.0 op_sel_hi:[1,0]
    v_pk_add_f32 v[6:7], v[6:7], 1.0 op_sel_hi:[1,0]
    v_mfma_f32_16x16x32_bf16 v[244:247], a[84:87], a[120:123], v[244:247]
    v_pk_add_f32 v[8:9], v[8:9], 1.0 op_sel_hi:[1,0]
    v_rcp_f32 v2, v2
    v_rcp_f32 v3, v3
    v_mfma_f32_16x16x32_bf16 v[248:251], a[88:91], a[120:123], v[248:251]
    v_rcp_f32 v4, v4
    v_rcp_f32 v5, v5
    v_rcp_f32 v6, v6
    v_mfma_f32_16x16x32_bf16 v[252:255], a[92:95], a[120:123], v[252:255]
    v_rcp_f32 v7, v7
    v_rcp_f32 v8, v8
    v_rcp_f32 v9, v9
    v_mfma_f32_16x16x32_bf16 a[128:131], a[64:67], a[124:127], a[128:131]
    s_nop 0
    v_pk_mul_f32 v[96:97], v[96:97], v[2:3]
    v_pk_mul_f32 v[98:99], v[98:99], v[4:5]
    v_mfma_f32_16x16x32_bf16 a[132:135], a[68:71], a[124:127], a[132:135]
    v_pk_mul_f32 v[100:101], v[100:101], v[6:7]
    v_pk_mul_f32 v[102:103], v[102:103], v[8:9]
    v_cvt_pk_bf16_f32 v24, v96, v97
    v_mfma_f32_16x16x32_bf16 a[136:139], a[72:75], a[124:127], a[136:139]
    v_cvt_pk_bf16_f32 v25, v98, v99
    v_cvt_pk_bf16_f32 v26, v100, v101
    v_cvt_pk_bf16_f32 v27, v102, v103
    v_mfma_f32_16x16x32_bf16 a[140:143], a[76:79], a[124:127], a[140:143]
    buffer_store_dwordx4 v[24:27], v1, s[20:23], s36 offen offset:0 sc1
    v_pk_mul_f32 v[2:3], v[104:105], s[38:39]
    v_pk_mul_f32 v[4:5], v[106:107], s[38:39]
    v_mfma_f32_16x16x32_bf16 a[144:147], a[80:83], a[124:127], a[144:147]
    v_pk_mul_f32 v[6:7], v[108:109], s[38:39]
    v_pk_mul_f32 v[8:9], v[110:111], s[38:39]
    v_exp_f32 v2, v2
    v_mfma_f32_16x16x32_bf16 a[148:151], a[84:87], a[124:127], a[148:151]
    v_exp_f32 v3, v3
    v_exp_f32 v4, v4
    v_exp_f32 v5, v5
    v_mfma_f32_16x16x32_bf16 a[152:155], a[88:91], a[124:127], a[152:155]
    v_exp_f32 v6, v6
    v_exp_f32 v7, v7
    v_exp_f32 v8, v8
    v_mfma_f32_16x16x32_bf16 a[156:159], a[92:95], a[124:127], a[156:159]
    v_exp_f32 v9, v9
    v_pk_mul_f32 v[104:105], v[104:105], v[120:121]
    v_pk_mul_f32 v[106:107], v[106:107], v[122:123]
    v_pk_mul_f32 v[108:109], v[108:109], v[124:125]
    v_pk_mul_f32 v[110:111], v[110:111], v[126:127]
    v_pk_add_f32 v[2:3], v[2:3], 1.0 op_sel_hi:[1,0]
    v_pk_add_f32 v[4:5], v[4:5], 1.0 op_sel_hi:[1,0]
    v_pk_add_f32 v[6:7], v[6:7], 1.0 op_sel_hi:[1,0]
    v_pk_add_f32 v[8:9], v[8:9], 1.0 op_sel_hi:[1,0]
    v_rcp_f32 v2, v2
    v_rcp_f32 v3, v3
    v_rcp_f32 v4, v4
    v_rcp_f32 v5, v5
    v_rcp_f32 v6, v6
    v_rcp_f32 v7, v7
    v_rcp_f32 v8, v8
    v_rcp_f32 v9, v9
    s_nop 0
    v_pk_mul_f32 v[104:105], v[104:105], v[2:3]
    v_pk_mul_f32 v[106:107], v[106:107], v[4:5]
    v_pk_mul_f32 v[108:109], v[108:109], v[6:7]
    v_pk_mul_f32 v[110:111], v[110:111], v[8:9]
    v_cvt_pk_bf16_f32 v28, v104, v105
    v_cvt_pk_bf16_f32 v29, v106, v107
    v_cvt_pk_bf16_f32 v30, v108, v109
    v_cvt_pk_bf16_f32 v31, v110, v111
    buffer_store_dwordx4 v[28:31], v1, s[20:23], s36 offen offset:1024 sc1
    s_add_u32 s36, s36, 114688
    global_load_dword v22, v23, s[56:57] sc1
    v_pk_mul_f32 v[2:3], v[128:129], s[38:39]
    v_pk_mul_f32 v[4:5], v[130:131], s[38:39]
    v_pk_mul_f32 v[6:7], v[132:133], s[38:39]
    v_pk_mul_f32 v[8:9], v[134:135], s[38:39]
    v_exp_f32 v2, v2
    v_exp_f32 v3, v3
    v_exp_f32 v4, v4
    v_exp_f32 v5, v5
    v_exp_f32 v6, v6
    v_exp_f32 v7, v7
    v_exp_f32 v8, v8
    v_exp_f32 v9, v9
    v_pk_mul_f32 v[128:129], v[128:129], v[144:145]
    v_pk_mul_f32 v[130:131], v[130:131], v[146:147]
    v_pk_mul_f32 v[132:133], v[132:133], v[148:149]
    v_pk_mul_f32 v[134:135], v[134:135], v[150:151]
    v_pk_add_f32 v[2:3], v[2:3], 1.0 op_sel_hi:[1,0]
    v_pk_add_f32 v[4:5], v[4:5], 1.0 op_sel_hi:[1,0]
    v_pk_add_f32 v[6:7], v[6:7], 1.0 op_sel_hi:[1,0]
    v_pk_add_f32 v[8:9], v[8:9], 1.0 op_sel_hi:[1,0]
    v_rcp_f32 v2, v2
    v_rcp_f32 v3, v3
    v_rcp_f32 v4, v4
    v_rcp_f32 v5, v5
    v_rcp_f32 v6, v6
    v_rcp_f32 v7, v7
    v_rcp_f32 v8, v8
    v_rcp_f32 v9, v9
    s_nop 0
    v_pk_mul_f32 v[128:129], v[128:129], v[2:3]
    v_pk_mul_f32 v[130:131], v[130:131], v[4:5]
    v_pk_mul_f32 v[132:133], v[132:133], v[6:7]
    v_pk_mul_f32 v[134:135], v[134:135], v[8:9]
    v_cvt_pk_bf16_f32 v24, v128, v129
    v_cvt_pk_bf16_f32 v25, v130, v131
    v_cvt_pk_bf16_f32 v26, v132, v133
    v_cvt_pk_bf16_f32 v27, v134, v135
    buffer_store_dwordx4 v[24:27], v1, s[20:23], s36 offen offset:0 sc1
    v_pk_mul_f32 v[2:3], v[136:137], s[38:39]
    v_pk_mul_f32 v[4:5], v[138:139], s[38:39]
    v_pk_mul_f32 v[6:7], v[140:141], s[38:39]
    v_pk_mul_f32 v[8:9], v[142:143], s[38:39]
    v_exp_f32 v2, v2
    v_exp_f32 v3, v3
    v_exp_f32 v4, v4
    v_exp_f32 v5, v5
    v_exp_f32 v6, v6
    v_exp_f32 v7, v7
    v_exp_f32 v8, v8
    v_exp_f32 v9, v9
    v_pk_mul_f32 v[136:137], v[136:137], v[152:153]
    v_pk_mul_f32 v[138:139], v[138:139], v[154:155]
    v_pk_mul_f32 v[140:141], v[140:141], v[156:157]
    v_pk_mul_f32 v[142:143], v[142:143], v[158:159]
    v_pk_add_f32 v[2:3], v[2:3], 1.0 op_sel_hi:[1,0]
    v_pk_add_f32 v[4:5], v[4:5], 1.0 op_sel_hi:[1,0]
    v_pk_add_f32 v[6:7], v[6:7], 1.0 op_sel_hi:[1,0]
    v_pk_add_f32 v[8:9], v[8:9], 1.0 op_sel_hi:[1,0]
    v_rcp_f32 v2, v2
    v_rcp_f32 v3, v3
    v_rcp_f32 v4, v4
    v_rcp_f32 v5, v5
    v_rcp_f32 v6, v6
    v_rcp_f32 v7, v7
    v_rcp_f32 v8, v8
    v_rcp_f32 v9, v9
    s_nop 0
    v_pk_mul_f32 v[136:137], v[136:137], v[2:3]
    v_pk_mul_f32 v[138:139], v[138:139], v[4:5]
    v_pk_mul_f32 v[140:141], v[140:141], v[6:7]
    v_pk_mul_f32 v[142:143], v[142:143], v[8:9]
    v_cvt_pk_bf16_f32 v28, v136, v137
    v_cvt_pk_bf16_f32 v29, v138, v139
    v_cvt_pk_bf16_f32 v30, v140, v141
    v_cvt_pk_bf16_f32 v31, v142, v143
    buffer_store_dwordx4 v[28:31], v1, s[20:23], s36 offen offset:1024 sc1
    s_add_u32 s36, s36, 114688
    s_waitcnt vmcnt(2)
    v_readfirstlane_b32 s48, v22
    s_nop 0
    s_cmp_ge_u32 s48, 32
    s_cselect_b32 s14, s14, 0
    s_cselect_b32 s18, s18, 0
    v_pk_mul_f32 v[2:3], v[160:161], s[38:39]
    v_pk_mul_f32 v[4:5], v[162:163], s[38:39]
    v_pk_mul_f32 v[6:7], v[164:165], s[38:39]
    v_pk_mul_f32 v[8:9], v[166:167], s[38:39]
    v_exp_f32 v2, v2
    v_exp_f32 v3, v3
    v_exp_f32 v4, v4
    v_exp_f32 v5, v5
    v_exp_f32 v6, v6
    s_lshl_b32 s50, s30, 12
    v_exp_f32 v7, v7
    v_exp_f32 v8, v8
    v_exp_f32 v9, v9
    v_pk_mul_f32 v[160:161], v[160:161], v[176:177]
    v_pk_mul_f32 v[162:163], v[162:163], v[178:179]
    v_pk_mul_f32 v[164:165], v[164:165], v[180:181]
    v_pk_mul_f32 v[166:167], v[166:167], v[182:183]
    v_pk_add_f32 v[2:3], v[2:3], 1.0 op_sel_hi:[1,0]
    v_pk_add_f32 v[4:5], v[4:5], 1.0 op_sel_hi:[1,0]
    buffer_load_dwordx2 v[44:45], v40, s[12:15], 0 offen offset:128 sc1
    v_pk_add_f32 v[6:7], v[6:7], 1.0 op_sel_hi:[1,0]
    v_pk_add_f32 v[8:9], v[8:9], 1.0 op_sel_hi:[1,0]
    v_rcp_f32 v2, v2
    v_rcp_f32 v3, v3
    v_rcp_f32 v4, v4
    v_rcp_f32 v5, v5
    v_rcp_f32 v6, v6
    v_rcp_f32 v7, v7
    v_rcp_f32 v8, v8
    buffer_load_dwordx2 v[46:47], v40, s[12:15], 0 offen sc1
    v_rcp_f32 v9, v9
    s_nop 0
    v_pk_mul_f32 v[160:161], v[160:161], v[2:3]
    v_pk_mul_f32 v[162:163], v[162:163], v[4:5]
    v_pk_mul_f32 v[164:165], v[164:165], v[6:7]
    v_pk_mul_f32 v[166:167], v[166:167], v[8:9]
    v_cvt_pk_bf16_f32 v24, v160, v161
    v_cvt_pk_bf16_f32 v25, v162, v163
    v_cvt_pk_bf16_f32 v26, v164, v165
    v_cvt_pk_bf16_f32 v27, v166, v167
    buffer_store_dwordx4 v[24:27], v1, s[20:23], s36 offen offset:0 sc1
    v_pk_mul_f32 v[2:3], v[168:169], s[38:39]
    v_pk_mul_f32 v[4:5], v[170:171], s[38:39]
    v_pk_mul_f32 v[6:7], v[172:173], s[38:39]
    v_pk_mul_f32 v[8:9], v[174:175], s[38:39]
    v_exp_f32 v2, v2
    v_exp_f32 v3, v3
    v_exp_f32 v4, v4
    v_exp_f32 v5, v5
    v_exp_f32 v6, v6
    buffer_load_dwordx2 v[48:49], v41, s[12:15], 0 offen sc1
    v_exp_f32 v7, v7
    v_exp_f32 v8, v8
    v_exp_f32 v9, v9
    v_pk_mul_f32 v[168:169], v[168:169], v[184:185]
    v_pk_mul_f32 v[170:171], v[170:171], v[186:187]
    v_pk_mul_f32 v[172:173], v[172:173], v[188:189]
    v_pk_mul_f32 v[174:175], v[174:175], v[190:191]
    v_pk_add_f32 v[2:3], v[2:3], 1.0 op_sel_hi:[1,0]
    v_pk_add_f32 v[4:5], v[4:5], 1.0 op_sel_hi:[1,0]
    buffer_load_dwordx2 v[50:51], v42, s[12:15], 0 offen sc1
    v_pk_add_f32 v[6:7], v[6:7], 1.0 op_sel_hi:[1,0]
    v_pk_add_f32 v[8:9], v[8:9], 1.0 op_sel_hi:[1,0]
    v_rcp_f32 v2, v2
    v_rcp_f32 v3, v3
    v_rcp_f32 v4, v4
    v_rcp_f32 v5, v5
    v_rcp_f32 v6, v6
    v_rcp_f32 v7, v7
    v_rcp_f32 v8, v8
    buffer_load_dwordx4 v[52:55], v43, s[12:15], 0 offen sc1
    v_rcp_f32 v9, v9
    s_nop 0
    v_pk_mul_f32 v[168:169], v[168:169], v[2:3]
    v_pk_mul_f32 v[170:171], v[170:171], v[4:5]
    v_pk_mul_f32 v[172:173], v[172:173], v[6:7]
    v_pk_mul_f32 v[174:175], v[174:175], v[8:9]
    v_cvt_pk_bf16_f32 v28, v168, v169
    v_cvt_pk_bf16_f32 v29, v170, v171
    v_cvt_pk_bf16_f32 v30, v172, v173
    v_cvt_pk_bf16_f32 v31, v174, v175
    buffer_store_dwordx4 v[28:31], v1, s[20:23], s36 offen offset:1024 sc1
    s_add_u32 s36, s36, 114688
    v_pk_mul_f32 v[2:3], v[192:193], s[38:39]
    v_pk_mul_f32 v[4:5], v[194:195], s[38:39]
    v_pk_mul_f32 v[6:7], v[196:197], s[38:39]
    v_pk_mul_f32 v[8:9], v[198:199], s[38:39]
    v_exp_f32 v2, v2
    v_exp_f32 v3, v3
    v_exp_f32 v4, v4
    v_exp_f32 v5, v5
    v_exp_f32 v6, v6
    buffer_load_dwordx4 a[224:227], v1, s[16:19], s50 offen offset:16 sc1
    v_exp_f32 v7, v7
    v_exp_f32 v8, v8
    v_exp_f32 v9, v9
    v_pk_mul_f32 v[192:193], v[192:193], v[208:209]
    v_pk_mul_f32 v[194:195], v[194:195], v[210:211]
    v_pk_mul_f32 v[196:197], v[196:197], v[212:213]
    v_pk_mul_f32 v[198:199], v[198:199], v[214:215]
    v_pk_add_f32 v[2:3], v[2:3], 1.0 op_sel_hi:[1,0]
    v_pk_add_f32 v[4:5], v[4:5], 1.0 op_sel_hi:[1,0]
    buffer_load_dwordx4 a[228:231], v1, s[16:19], s50 offen offset:1040 sc1
    v_pk_add_f32 v[6:7], v[6:7], 1.0 op_sel_hi:[1,0]
    v_pk_add_f32 v[8:9], v[8:9], 1.0 op_sel_hi:[1,0]
    v_rcp_f32 v2, v2
    v_rcp_f32 v3, v3
    v_rcp_f32 v4, v4
    v_rcp_f32 v5, v5
    v_rcp_f32 v6, v6
    v_rcp_f32 v7, v7
    v_rcp_f32 v8, v8
    buffer_load_dwordx4 a[232:235], v1, s[16:19], s50 offen offset:2064 sc1
    v_rcp_f32 v9, v9
    s_nop 0
    v_pk_mul_f32 v[192:193], v[192:193], v[2:3]
    v_pk_mul_f32 v[194:195], v[194:195], v[4:5]
    v_pk_mul_f32 v[196:197], v[196:197], v[6:7]
    v_pk_mul_f32 v[198:199], v[198:199], v[8:9]
    v_cvt_pk_bf16_f32 v24, v192, v193
    v_cvt_pk_bf16_f32 v25, v194, v195
    v_cvt_pk_bf16_f32 v26, v196, v197
    v_cvt_pk_bf16_f32 v27, v198, v199
    buffer_store_dwordx4 v[24:27], v1, s[20:23], s36 offen offset:0 sc1
    v_pk_mul_f32 v[2:3], v[200:201], s[38:39]
    v_pk_mul_f32 v[4:5], v[202:203], s[38:39]
    v_pk_mul_f32 v[6:7], v[204:205], s[38:39]
    v_pk_mul_f32 v[8:9], v[206:207], s[38:39]
    v_exp_f32 v2, v2
    v_exp_f32 v3, v3
    v_exp_f32 v4, v4
    v_exp_f32 v5, v5
    v_exp_f32 v6, v6
    buffer_load_dwordx4 a[236:239], v1, s[16:19], s50 offen offset:3088 sc1
    v_exp_f32 v7, v7
    v_exp_f32 v8, v8
    v_exp_f32 v9, v9
    v_pk_mul_f32 v[200:201], v[200:201], v[216:217]
    v_pk_mul_f32 v[202:203], v[202:203], v[218:219]
    v_pk_mul_f32 v[204:205], v[204:205], v[220:221]
    v_pk_mul_f32 v[206:207], v[206:207], v[222:223]
    v_pk_add_f32 v[2:3], v[2:3], 1.0 op_sel_hi:[1,0]
    v_pk_add_f32 v[4:5], v[4:5], 1.0 op_sel_hi:[1,0]
    buffer_load_dwordx4 a[240:243], v1, s[16:19], s50 offen offset:12 sc1
    v_pk_add_f32 v[6:7], v[6:7], 1.0 op_sel_hi:[1,0]
    v_pk_add_f32 v[8:9], v[8:9], 1.0 op_sel_hi:[1,0]
    v_rcp_f32 v2, v2
    v_rcp_f32 v3, v3
    v_rcp_f32 v4, v4
    v_rcp_f32 v5, v5
    v_rcp_f32 v6, v6
    v_rcp_f32 v7, v7
    v_rcp_f32 v8, v8
    buffer_load_dwordx4 a[244:247], v1, s[16:19], s50 offen offset:1036 sc1
    v_rcp_f32 v9, v9
    s_nop 0
    v_pk_mul_f32 v[200:201], v[200:201], v[2:3]
    v_pk_mul_f32 v[202:203], v[202:203], v[4:5]
    v_pk_mul_f32 v[204:205], v[204:205], v[6:7]
    v_pk_mul_f32 v[206:207], v[206:207], v[8:9]
    v_cvt_pk_bf16_f32 v28, v200, v201
    v_cvt_pk_bf16_f32 v29, v202, v203
    v_cvt_pk_bf16_f32 v30, v204, v205
    v_cvt_pk_bf16_f32 v31, v206, v207
    buffer_store_dwordx4 v[28:31], v1, s[20:23], s36 offen offset:1024 sc1
    s_add_u32 s36, s36, 114688
    v_pk_mul_f32 v[2:3], v[224:225], s[38:39]
    v_pk_mul_f32 v[4:5], v[226:227], s[38:39]
    v_pk_mul_f32 v[6:7], v[228:229], s[38:39]
    v_pk_mul_f32 v[8:9], v[230:231], s[38:39]
    v_exp_f32 v2, v2
    v_exp_f32 v3, v3
    v_exp_f32 v4, v4
    v_exp_f32 v5, v5
    v_exp_f32 v6, v6
    buffer_load_dwordx4 a[248:251], v1, s[16:19], s50 offen offset:2060 sc1
    v_exp_f32 v7, v7
    v_exp_f32 v8, v8
    v_exp_f32 v9, v9
    v_pk_mul_f32 v[224:225], v[224:225], v[240:241]
    v_pk_mul_f32 v[226:227], v[226:227], v[242:243]
    v_pk_mul_f32 v[228:229], v[228:229], v[244:245]
    v_pk_mul_f32 v[230:231], v[230:231], v[246:247]
    v_pk_add_f32 v[2:3], v[2:3], 1.0 op_sel_hi:[1,0]
    v_pk_add_f32 v[4:5], v[4:5], 1.0 op_sel_hi:[1,0]
    buffer_load_dwordx4 a[252:255], v1, s[16:19], s50 offen offset:3084 sc1
    v_pk_add_f32 v[6:7], v[6:7], 1.0 op_sel_hi:[1,0]
    v_pk_add_f32 v[8:9], v[8:9], 1.0 op_sel_hi:[1,0]
    v_rcp_f32 v2, v2
    v_rcp_f32 v3, v3
    v_rcp_f32 v4, v4
    v_rcp_f32 v5, v5
    v_rcp_f32 v6, v6
    v_rcp_f32 v7, v7
    v_rcp_f32 v8, v8
    v_rcp_f32 v9, v9
    s_nop 0
    v_pk_mul_f32 v[224:225], v[224:225], v[2:3]
    v_pk_mul_f32 v[226:227], v[226:227], v[4:5]
    v_pk_mul_f32 v[228:229], v[228:229], v[6:7]
    v_pk_mul_f32 v[230:231], v[230:231], v[8:9]
    v_cvt_pk_bf16_f32 v24, v224, v225
    v_cvt_pk_bf16_f32 v25, v226, v227
    v_cvt_pk_bf16_f32 v26, v228, v229
    v_cvt_pk_bf16_f32 v27, v230, v231
    buffer_store_dwordx4 v[24:27], v1, s[20:23], s36 offen offset:0 sc1
    v_pk_mul_f32 v[2:3], v[232:233], s[38:39]
    v_pk_mul_f32 v[4:5], v[234:235], s[38:39]
    v_pk_mul_f32 v[6:7], v[236:237], s[38:39]
    v_pk_mul_f32 v[8:9], v[238:239], s[38:39]
    v_exp_f32 v2, v2
    v_exp_f32 v3, v3
    v_exp_f32 v4, v4
    v_exp_f32 v5, v5
    v_exp_f32 v6, v6
    v_exp_f32 v7, v7
    v_exp_f32 v8, v8
    v_exp_f32 v9, v9
    v_pk_mul_f32 v[232:233], v[232:233], v[248:249]
    v_pk_mul_f32 v[234:235], v[234:235], v[250:251]
    v_pk_mul_f32 v[236:237], v[236:237], v[252:253]
    v_pk_mul_f32 v[238:239], v[238:239], v[254:255]
    v_pk_add_f32 v[2:3], v[2:3], 1.0 op_sel_hi:[1,0]
    v_pk_add_f32 v[4:5], v[4:5], 1.0 op_sel_hi:[1,0]
    v_pk_add_f32 v[6:7], v[6:7], 1.0 op_sel_hi:[1,0]
    v_pk_add_f32 v[8:9], v[8:9], 1.0 op_sel_hi:[1,0]
    v_rcp_f32 v2, v2
    v_rcp_f32 v3, v3
    v_rcp_f32 v4, v4
    v_rcp_f32 v5, v5
    v_rcp_f32 v6, v6
    v_rcp_f32 v7, v7
    v_rcp_f32 v8, v8
    v_rcp_f32 v9, v9
    s_nop 0
    v_pk_mul_f32 v[232:233], v[232:233], v[2:3]
    v_pk_mul_f32 v[234:235], v[234:235], v[4:5]
    v_pk_mul_f32 v[236:237], v[236:237], v[6:7]
    v_pk_mul_f32 v[238:239], v[238:239], v[8:9]
    v_cvt_pk_bf16_f32 v28, v232, v233
    v_cvt_pk_bf16_f32 v29, v234, v235
    v_cvt_pk_bf16_f32 v30, v236, v237
    v_cvt_pk_bf16_f32 v31, v238, v239
    buffer_store_dwordx4 v[28:31], v1, s[20:23], s36 offen offset:1024 sc1
    s_add_u32 s36, s36, 114688
    v_accvgpr_read_b32 v32, a128
    v_accvgpr_read_b32 v33, a129
    v_accvgpr_read_b32 v34, a130
    v_accvgpr_read_b32 v35, a131
    v_accvgpr_read_b32 v36, a132
    v_accvgpr_read_b32 v37, a133
    v_accvgpr_read_b32 v38, a134
    v_accvgpr_read_b32 v39, a135
    v_accvgpr_read_b32 v10, a144
    v_accvgpr_read_b32 v11, a145
    v_accvgpr_read_b32 v12, a146
    v_accvgpr_read_b32 v13, a147
    v_accvgpr_read_b32 v14, a148
    v_accvgpr_read_b32 v15, a149
    v_accvgpr_read_b32 v16, a150
    v_accvgpr_read_b32 v17, a151
    v_pk_mul_f32 v[2:3], v[32:33], s[38:39]
    v_pk_mul_f32 v[4:5], v[34:35], s[38:39]
    v_pk_mul_f32 v[6:7], v[36:37], s[38:39]
    v_pk_mul_f32 v[8:9], v[38:39], s[38:39]
    v_exp_f32 v2, v2
    v_exp_f32 v3, v3
    v_exp_f32 v4, v4
    v_exp_f32 v5, v5
    v_exp_f32 v6, v6
    v_exp_f32 v7, v7
    v_exp_f32 v8, v8
    v_exp_f32 v9, v9
    v_pk_mul_f32 v[32:33], v[32:33], v[10:11]
    v_pk_mul_f32 v[34:35], v[34:35], v[12:13]
    v_pk_mul_f32 v[36:37], v[36:37], v[14:15]
    v_pk_mul_f32 v[38:39], v[38:39], v[16:17]
    v_pk_add_f32 v[2:3], v[2:3], 1.0 op_sel_hi:[1,0]
    v_pk_add_f32 v[4:5], v[4:5], 1.0 op_sel_hi:[1,0]
    v_pk_add_f32 v[6:7], v[6:7], 1.0 op_sel_hi:[1,0]
    v_pk_add_f32 v[8:9], v[8:9], 1.0 op_sel_hi:[1,0]
    v_rcp_f32 v2, v2
    v_rcp_f32 v3, v3
    v_rcp_f32 v4, v4
    v_rcp_f32 v5, v5
    v_rcp_f32 v6, v6
    v_rcp_f32 v7, v7
    v_rcp_f32 v8, v8
    v_rcp_f32 v9, v9
    s_nop 0
    v_pk_mul_f32 v[32:33], v[32:33], v[2:3]
    v_pk_mul_f32 v[34:35], v[34:35], v[4:5]
    v_pk_mul_f32 v[36:37], v[36:37], v[6:7]
    v_pk_mul_f32 v[38:39], v[38:39], v[8:9]
    v_cvt_pk_bf16_f32 v24, v32, v33
    v_cvt_pk_bf16_f32 v25, v34, v35
    v_cvt_pk_bf16_f32 v26, v36, v37
    v_cvt_pk_bf16_f32 v27, v38, v39
    buffer_store_dwordx4 v[24:27], v1, s[20:23], s36 offen offset:0 sc1
    v_accvgpr_read_b32 v32, a136
    v_accvgpr_read_b32 v33, a137
    v_accvgpr_read_b32 v34, a138
    v_accvgpr_read_b32 v35, a139
    v_accvgpr_read_b32 v36, a140
    v_accvgpr_read_b32 v37, a141
    v_accvgpr_read_b32 v38, a142
    v_accvgpr_read_b32 v39, a143
    v_accvgpr_read_b32 v10, a152
    v_accvgpr_read_b32 v11, a153
    v_accvgpr_read_b32 v12, a154
    v_accvgpr_read_b32 v13, a155
    v_accvgpr_read_b32 v14, a156
    v_accvgpr_read_b32 v15, a157
    v_accvgpr_read_b32 v16, a158
    v_accvgpr_read_b32 v17, a159
    v_pk_mul_f32 v[2:3], v[32:33], s[38:39]
    v_pk_mul_f32 v[4:5], v[34:35], s[38:39]
    v_pk_mul_f32 v[6:7], v[36:37], s[38:39]
    v_pk_mul_f32 v[8:9], v[38:39], s[38:39]
    v_exp_f32 v2, v2
    v_exp_f32 v3, v3
    v_exp_f32 v4, v4
    v_exp_f32 v5, v5
    v_exp_f32 v6, v6
    v_exp_f32 v7, v7
    v_exp_f32 v8, v8
    v_exp_f32 v9, v9
    v_pk_mul_f32 v[32:33], v[32:33], v[10:11]
    v_pk_mul_f32 v[34:35], v[34:35], v[12:13]
    v_pk_mul_f32 v[36:37], v[36:37], v[14:15]
    v_pk_mul_f32 v[38:39], v[38:39], v[16:17]
    v_pk_add_f32 v[2:3], v[2:3], 1.0 op_sel_hi:[1,0]
    v_pk_add_f32 v[4:5], v[4:5], 1.0 op_sel_hi:[1,0]
    v_pk_add_f32 v[6:7], v[6:7], 1.0 op_sel_hi:[1,0]
    v_pk_add_f32 v[8:9], v[8:9], 1.0 op_sel_hi:[1,0]
    v_rcp_f32 v2, v2
    v_rcp_f32 v3, v3
    v_rcp_f32 v4, v4
    v_rcp_f32 v5, v5
    v_rcp_f32 v6, v6
    v_rcp_f32 v7, v7
    v_rcp_f32 v8, v8
    v_rcp_f32 v9, v9
    s_nop 0
    v_pk_mul_f32 v[32:33], v[32:33], v[2:3]
    v_pk_mul_f32 v[34:35], v[34:35], v[4:5]
    v_pk_mul_f32 v[36:37], v[36:37], v[6:7]
    v_pk_mul_f32 v[38:39], v[38:39], v[8:9]
    v_cvt_pk_bf16_f32 v28, v32, v33
    v_cvt_pk_bf16_f32 v29, v34, v35
    v_cvt_pk_bf16_f32 v30, v36, v37
    v_cvt_pk_bf16_f32 v31, v38, v39
    buffer_store_dwordx4 v[28:31], v1, s[20:23], s36 offen offset:1024 sc1
    s_add_u32 s36, s36, 114688
    s_cmp_eq_u32 s14, 0
    s_cbranch_scc1 fused_kernel_late
    s_waitcnt vmcnt(4)
fused_kernel_p2:
    v_add_u32 v7, s31, v1
    v_perm_b32 v68, v45, v44, v56
    ds_write_b128 v7, a[224:227] offset:9344
    v_perm_b32 v69, v45, v44, v58
    v_perm_b32 v70, v45, v44, v57
    v_perm_b32 v71, v45, v44, v57
    ds_write_b128 v7, v[68:71] offset:0
    v_perm_b32 v72, v47, v46, v56
    ds_write_b128 v7, a[228:231] offset:10368
    v_perm_b32 v73, v47, v46, v58
    v_perm_b32 v74, v47, v46, v57
    v_perm_b32 v75, v47, v46, v57
    ds_write_b128 v7, v[72:75] offset:1024
    v_perm_b32 v76, v49, v48, s25
    ds_write_b128 v7, a[232:235] offset:11392
    v_perm_b32 v77, v49, v48, s26
    v_perm_b32 v78, v49, v48, s37
    v_perm_b32 v79, v49, v48, s37
    ds_write_b128 v7, v[76:79] offset:2048
    v_perm_b32 v80, v51, v50, v60
    ds_write_b128 v7, a[236:239] offset:12416
    v_perm_b32 v81, v50, v54, v61
    v_perm_b32 v82, v54, v53, v60
    v_perm_b32 v83, v53, v52, v62
    ds_write_b128 v7, v[80:83] offset:3072
    v_perm_b32 v84, v45, v44, v56
    ds_write_b128 v7, a[240:243] offset:13568
    v_perm_b32 v85, v45, v44, v59
    v_perm_b32 v86, v45, v44, v57
    v_perm_b32 v87, v45, v44, v57
    ds_write_b128 v7, v[84:87] offset:4640
    v_perm_b32 v88, v47, v46, v56
    ds_write_b128 v7, a[244:247] offset:14592
    v_perm_b32 v89, v47, v46, v59
    v_perm_b32 v90, v47, v46, v57
    v_perm_b32 v91, v47, v46, v57
    ds_write_b128 v7, v[88:91] offset:5664
    v_perm_b32 v92, v49, v48, s58
    ds_write_b128 v7, a[248:251] offset:15616
    v_perm_b32 v93, v49, v48, s26
    v_perm_b32 v94, v49, v48, s59
    v_perm_b32 v95, v49, v48, s37
    ds_write_b128 v7, v[92:95] offset:6688
    v_perm_b32 v96, v51, v50, v63
    ds_write_b128 v7, a[252:255] offset:16640
    v_perm_b32 v97, v50, v54, v64
    v_perm_b32 v98, v54, v53, v63
    v_perm_b32 v99, v53, v52, v65
    ds_write_b128 v7, v[96:99] offset:7712
    v_lshrrev_b32 v8, 4, v0
    v_and_b32 v9, 15, v0
    s_add_u32 s48, s31, 4096
    v_lshl_add_u32 v2, v0, 3, s48
    v_and_b32 v10, 1, v0
    v_mul_u32_u24 v11, 4640, v10
    v_lshl_add_u32 v11, v8, 4, v11
    v_lshrrev_b32 v3, 1, v9
    v_lshlrev_b32 v3, 6, v3
    v_sub_u32 v3, v11, v3
    s_add_u32 s48, s31, 448
    v_add_u32 v3, s48, v3
    v_mul_u32_u24 v11, 4228, v10
    v_lshlrev_b32 v4, 2, v9
    v_lshl_add_u32 v4, v8, 4, v4
    v_sub_u32 v4, v4, v11
    s_add_u32 s48, s31, 13512
    v_add_u32 v4, s48, v4
    v_subrev_u32 v10, 16, v0
    v_min_u32 v10, 16, v10
    v_lshlrev_b32 v10, 2, v10
    v_add_u32 v10, 4224, v10
    v_lshlrev_b32 v11, 2, v0
    v_cmp_gt_u32 vcc, 16, v0
    s_add_u32 s48, s31, 9280
    s_nop 0
    v_cndmask_b32 v10, v10, v11, vcc
    v_add_u32 v5, s48, v10
    v_lshlrev_b32 v10, 7, v8
    v_lshl_add_u32 v10, v9, 2, v10
    v_add_u32 v6, s31, v10
    v_add_u32 v7, s31, v1
    v_mov_b32 v8, 0
    v_mov_b32 v9, 0

    ds_write_b64 v2, v[8:9]
    ds_write_b64 v2, v[8:9] offset:4640
    ds_write_b32 v5, v8
    v_mov_b32 v24, s51
    v_mov_b32 v25, 1
    ds_read_b128 v[76:79], v3 offset:2048
    ds_read_b64 v[108:109], v4 offset:1536
    ds_read_b64 v[110:111], v4 offset:1544
    ds_read_b128 v[80:83], v3 offset:1536
    ds_read_b64 v[112:113], v4 offset:2048
    ds_read_b64 v[114:115], v4 offset:2056
    ds_read_b128 v[72:75], v3 offset:2560
    ds_read_b64 v[104:105], v4 offset:1024
    ds_read_b64 v[106:107], v4 offset:1032
    ds_read_b128 v[84:87], v3 offset:1024
    ds_read_b64 v[116:117], v4 offset:2560
    ds_read_b64 v[118:119], v4 offset:2568
    ds_read_b128 v[68:71], v3 offset:3072
    ds_read_b64 v[100:101], v4 offset:512
    ds_read_b64 v[102:103], v4 offset:520
    ds_read_b128 v[88:91], v3 offset:512
    ds_read_b64 v[120:121], v4 offset:3072
    ds_read_b64 v[122:123], v4 offset:3080
    ds_read_b128 v[64:67], v3 offset:3584
    ds_read_b64 v[96:97], v4 offset:0
    ds_read_b64 v[98:99], v4 offset:8
    ds_read_b128 v[92:95], v3 offset:0
    ds_read_b64 v[124:125], v4 offset:3584
    ds_read_b64 v[126:127], v4 offset:3592
    s_waitcnt lgkmcnt(0)
    s_waitcnt vmcnt(0)
    s_cmp_eq_u32 s51, 0
    s_cbranch_scc1 fused_kernel_nh
    s_mov_b64 exec, 1

    global_atomic_add v24, v25, s[56:57] sc1
    s_mov_b64 exec, -1
    fused_kernel_nh:
    v_mfma_f32_16x16x32_bf16 v[60:63], v[76:79], v[112:115], 0
    v_mfma_f32_16x16x32_bf16 v[56:59], v[76:79], v[108:111], 0
    v_mfma_f32_16x16x32_bf16 v[52:55], v[72:75], v[108:111], 0
    ds_read_b128 v[140:143], v3 offset:2112
    buffer_load_dwordx4 v[208:211], v18, s[8:11], s33 offen offset:0
    v_mfma_f32_16x16x32_bf16 v[60:63], v[80:83], v[108:111], v[60:63]
    ds_read_b64 v[172:173], v4 offset:1600
    v_mfma_f32_16x16x32_bf16 v[56:59], v[72:75], v[112:115], v[56:59]
    ds_read_b64 v[174:175], v4 offset:1608
    v_mfma_f32_16x16x32_bf16 v[48:51], v[72:75], v[104:107], 0
    ds_read_b128 v[144:147], v3 offset:1600
    v_mfma_f32_16x16x32_bf16 v[60:63], v[72:75], v[116:119], v[60:63]
    ds_read_b64 v[176:177], v4 offset:2112
    buffer_load_dwordx4 v[212:215], v19, s[8:11], s33 offen offset:1024
    v_mfma_f32_16x16x32_bf16 v[52:55], v[76:79], v[104:107], v[52:55]
    ds_read_b64 v[178:179], v4 offset:2120
    v_mfma_f32_16x16x32_bf16 v[56:59], v[80:83], v[104:107], v[56:59]
    ds_read_b128 v[136:139], v3 offset:2624
    v_mfma_f32_16x16x32_bf16 v[60:63], v[84:87], v[104:107], v[60:63]
    ds_read_b64 v[168:169], v4 offset:1088
    v_mfma_f32_16x16x32_bf16 v[44:47], v[68:71], v[104:107], 0
    ds_read_b64 v[170:171], v4 offset:1096
    v_mfma_f32_16x16x32_bf16 v[48:51], v[68:71], v[108:111], v[48:51]
    ds_read_b128 v[148:151], v3 offset:1088
    buffer_load_dwordx4 v[216:219], v20, s[8:11], s33 offen offset:2048
    v_mfma_f32_16x16x32_bf16 v[52:55], v[68:71], v[112:115], v[52:55]
    ds_read_b64 v[180:181], v4 offset:2624
    v_mfma_f32_16x16x32_bf16 v[56:59], v[68:71], v[116:119], v[56:59]
    ds_read_b64 v[182:183], v4 offset:2632
    v_mfma_f32_16x16x32_bf16 v[60:63], v[68:71], v[120:123], v[60:63]
    ds_read_b128 v[132:135], v3 offset:3136
    v_mfma_f32_16x16x32_bf16 v[40:43], v[68:71], v[100:103], 0
    ds_read_b64 v[164:165], v4 offset:576
    v_mfma_f32_16x16x32_bf16 v[44:47], v[72:75], v[100:103], v[44:47]
    ds_read_b64 v[166:167], v4 offset:584
    buffer_load_dwordx4 v[220:223], v21, s[8:11], s33 offen offset:3072
    s_add_u32 s33, s33, s45
    v_mfma_f32_16x16x32_bf16 v[48:51], v[76:79], v[100:103], v[48:51]
    ds_read_b128 v[152:155], v3 offset:576
    v_mfma_f32_16x16x32_bf16 v[52:55], v[80:83], v[100:103], v[52:55]
    ds_read_b64 v[184:185], v4 offset:3136
    v_mfma_f32_16x16x32_bf16 v[56:59], v[84:87], v[100:103], v[56:59]
    ds_read_b64 v[186:187], v4 offset:3144
    v_mfma_f32_16x16x32_bf16 v[60:63], v[88:91], v[100:103], v[60:63]
    ds_read_b128 v[128:131], v3 offset:3648
    buffer_load_dwordx4 v[224:227], v18, s[8:11], s33 offen offset:0
    v_mfma_f32_16x16x32_bf16 v[36:39], v[64:67], v[100:103], 0
    ds_read_b64 v[160:161], v4 offset:64
    v_mfma_f32_16x16x32_bf16 v[40:43], v[64:67], v[104:107], v[40:43]
    ds_read_b64 v[162:163], v4 offset:72
    v_mfma_f32_16x16x32_bf16 v[44:47], v[64:67], v[108:111], v[44:47]
    ds_read_b128 v[156:159], v3 offset:64
    v_mfma_f32_16x16x32_bf16 v[48:51], v[64:67], v[112:115], v[48:51]
    ds_read_b64 v[188:189], v4 offset:3648
    v_mfma_f32_16x16x32_bf16 v[52:55], v[64:67], v[116:119], v[52:55]
    ds_read_b64 v[190:191], v4 offset:3656
    buffer_load_dwordx4 v[228:231], v19, s[8:11], s33 offen offset:1024
    v_mfma_f32_16x16x32_bf16 v[56:59], v[64:67], v[120:123], v[56:59]
    v_mfma_f32_16x16x32_bf16 v[60:63], v[64:67], v[124:127], v[60:63]
    v_mfma_f32_16x16x32_bf16 v[32:35], v[64:67], v[96:99], 0
    v_mfma_f32_16x16x32_bf16 v[36:39], v[68:71], v[96:99], v[36:39]
    v_mfma_f32_16x16x32_bf16 v[40:43], v[72:75], v[96:99], v[40:43]
    buffer_load_dwordx4 v[232:235], v20, s[8:11], s33 offen offset:2048
    v_mfma_f32_16x16x32_bf16 v[44:47], v[76:79], v[96:99], v[44:47]
    v_mfma_f32_16x16x32_bf16 v[48:51], v[80:83], v[96:99], v[48:51]
    v_mfma_f32_16x16x32_bf16 v[52:55], v[84:87], v[96:99], v[52:55]
    v_mfma_f32_16x16x32_bf16 v[56:59], v[88:91], v[96:99], v[56:59]
    buffer_load_dwordx4 v[236:239], v21, s[8:11], s33 offen offset:3072
    s_add_u32 s33, s33, s44
    v_mfma_f32_16x16x32_bf16 v[60:63], v[92:95], v[96:99], v[60:63]
    s_waitcnt lgkmcnt(0)
    v_mfma_f32_16x16x32_bf16 v[60:63], v[140:143], v[176:179], v[60:63]
    v_mfma_f32_16x16x32_bf16 v[56:59], v[140:143], v[172:175], v[56:59]
    v_mfma_f32_16x16x32_bf16 v[52:55], v[136:139], v[172:175], v[52:55]
    ds_read_b128 v[76:79], v3 offset:2176
    v_mfma_f32_16x16x32_bf16 v[60:63], v[144:147], v[172:175], v[60:63]
    ds_read_b64 v[108:109], v4 offset:1664
    buffer_load_dwordx4 v[240:243], v18, s[8:11], s33 offen offset:0
    v_mfma_f32_16x16x32_bf16 v[56:59], v[136:139], v[176:179], v[56:59]
    ds_read_b64 v[110:111], v4 offset:1672
    v_mfma_f32_16x16x32_bf16 v[48:51], v[136:139], v[168:171], v[48:51]
    ds_read_b128 v[80:83], v3 offset:1664
    v_mfma_f32_16x16x32_bf16 v[60:63], v[136:139], v[180:183], v[60:63]
    ds_read_b64 v[112:113], v4 offset:2176
    v_mfma_f32_16x16x32_bf16 v[52:55], v[140:143], v[168:171], v[52:55]
    ds_read_b64 v[114:115], v4 offset:2184
    v_mfma_f32_16x16x32_bf16 v[56:59], v[144:147], v[168:171], v[56:59]
    ds_read_b128 v[72:75], v3 offset:2688
    buffer_load_dwordx4 v[244:247], v19, s[8:11], s33 offen offset:1024
    v_mfma_f32_16x16x32_bf16 v[60:63], v[148:151], v[168:171], v[60:63]
    ds_read_b64 v[104:105], v4 offset:1152
    v_mfma_f32_16x16x32_bf16 v[44:47], v[132:135], v[168:171], v[44:47]
    ds_read_b64 v[106:107], v4 offset:1160
    v_mfma_f32_16x16x32_bf16 v[48:51], v[132:135], v[172:175], v[48:51]
    ds_read_b128 v[84:87], v3 offset:1152
    v_mfma_f32_16x16x32_bf16 v[52:55], v[132:135], v[176:179], v[52:55]
    ds_read_b64 v[116:117], v4 offset:2688
    v_mfma_f32_16x16x32_bf16 v[56:59], v[132:135], v[180:183], v[56:59]
    ds_read_b64 v[118:119], v4 offset:2696
    buffer_load_dwordx4 v[248:251], v20, s[8:11], s33 offen offset:2048
    v_mfma_f32_16x16x32_bf16 v[60:63], v[132:135], v[184:187], v[60:63]
    ds_read_b128 v[68:71], v3 offset:3200
    v_mfma_f32_16x16x32_bf16 v[40:43], v[132:135], v[164:167], v[40:43]
    ds_read_b64 v[100:101], v4 offset:640
    v_mfma_f32_16x16x32_bf16 v[44:47], v[136:139], v[164:167], v[44:47]
    ds_read_b64 v[102:103], v4 offset:648
    v_mfma_f32_16x16x32_bf16 v[48:51], v[140:143], v[164:167], v[48:51]
    ds_read_b128 v[88:91], v3 offset:640
    buffer_load_dwordx4 v[252:255], v21, s[8:11], s33 offen offset:3072
    s_add_u32 s33, s33, s45
    v_mfma_f32_16x16x32_bf16 v[52:55], v[144:147], v[164:167], v[52:55]
    ds_read_b64 v[120:121], v4 offset:3200
    v_mfma_f32_16x16x32_bf16 v[56:59], v[148:151], v[164:167], v[56:59]
    ds_read_b64 v[122:123], v4 offset:3208
    v_mfma_f32_16x16x32_bf16 v[60:63], v[152:155], v[164:167], v[60:63]
    ds_read_b128 v[64:67], v3 offset:3712
    v_mfma_f32_16x16x32_bf16 v[36:39], v[128:131], v[164:167], v[36:39]
    ds_read_b64 v[96:97], v4 offset:128
    v_mfma_f32_16x16x32_bf16 v[40:43], v[128:131], v[168:171], v[40:43]
    ds_read_b64 v[98:99], v4 offset:136
    buffer_load_dwordx4 a[240:243], v18, s[8:11], s33 offen offset:0
    v_mfma_f32_16x16x32_bf16 v[44:47], v[128:131], v[172:175], v[44:47]
    ds_read_b128 v[92:95], v3 offset:128
    v_mfma_f32_16x16x32_bf16 v[48:51], v[128:131], v[176:179], v[48:51]
    ds_read_b64 v[124:125], v4 offset:3712
    v_mfma_f32_16x16x32_bf16 v[52:55], v[128:131], v[180:183], v[52:55]
    ds_read_b64 v[126:127], v4 offset:3720
    v_mfma_f32_16x16x32_bf16 v[56:59], v[128:131], v[184:187], v[56:59]
    v_mfma_f32_16x16x32_bf16 v[60:63], v[128:131], v[188:191], v[60:63]
    buffer_load_dwordx4 a[244:247], v19, s[8:11], s33 offen offset:1024
    v_mfma_f32_16x16x32_bf16 v[32:35], v[128:131], v[160:163], v[32:35]
    v_mfma_f32_16x16x32_bf16 v[36:39], v[132:135], v[160:163], v[36:39]
    v_mfma_f32_16x16x32_bf16 v[40:43], v[136:139], v[160:163], v[40:43]
    v_mfma_f32_16x16x32_bf16 v[44:47], v[140:143], v[160:163], v[44:47]
    buffer_load_dwordx4 a[248:251], v20, s[8:11], s33 offen offset:2048
    v_mfma_f32_16x16x32_bf16 v[48:51], v[144:147], v[160:163], v[48:51]
    v_mfma_f32_16x16x32_bf16 v[52:55], v[148:151], v[160:163], v[52:55]
    v_mfma_f32_16x16x32_bf16 v[56:59], v[152:155], v[160:163], v[56:59]
    v_mfma_f32_16x16x32_bf16 v[60:63], v[156:159], v[160:163], v[60:63]
    s_waitcnt lgkmcnt(0)
    v_mfma_f32_16x16x32_bf16 v[60:63], v[76:79], v[112:115], v[60:63]
    s_and_b32 s36, s24, 1
    buffer_load_dwordx4 a[252:255], v21, s[8:11], s33 offen offset:3072
    s_add_u32 s33, s33, s44
    v_mfma_f32_16x16x32_bf16 v[56:59], v[76:79], v[108:111], v[56:59]
    s_lshr_b32 s37, s24, 1
    v_mfma_f32_16x16x32_bf16 v[52:55], v[72:75], v[108:111], v[52:55]
    ds_read_b128 v[140:143], v3 offset:2240
    s_lshl_b32 s38, s27, 3
    v_mfma_f32_16x16x32_bf16 v[60:63], v[80:83], v[108:111], v[60:63]
    ds_read_b64 v[172:173], v4 offset:1728
    s_lshl_b32 s39, s36, 2
    v_mfma_f32_16x16x32_bf16 v[56:59], v[72:75], v[112:115], v[56:59]
    ds_read_b64 v[174:175], v4 offset:1736
    s_add_u32 s38, s38, s39
    v_mfma_f32_16x16x32_bf16 v[48:51], v[72:75], v[104:107], v[48:51]
    ds_read_b128 v[144:147], v3 offset:1728
    s_lshl_b32 s39, s37, 1
    buffer_load_dwordx4 a[224:227], v18, s[8:11], s33 offen offset:0
    v_mfma_f32_16x16x32_bf16 v[60:63], v[72:75], v[116:119], v[60:63]
    ds_read_b64 v[176:177], v4 offset:2240
    s_add_u32 s35, s38, s39
    v_mfma_f32_16x16x32_bf16 v[52:55], v[76:79], v[104:107], v[52:55]
    ds_read_b64 v[178:179], v4 offset:2248
    s_xor_b32 s38, s35, 2
    v_mfma_f32_16x16x32_bf16 v[56:59], v[80:83], v[104:107], v[56:59]
    ds_read_b128 v[136:139], v3 offset:2752
    s_mul_i32 s39, s29, 56
    v_mfma_f32_16x16x32_bf16 v[60:63], v[84:87], v[104:107], v[60:63]
    ds_read_b64 v[168:169], v4 offset:1216
    s_add_u32 s39, s39, s37
    buffer_load_dwordx4 a[228:231], v19, s[8:11], s33 offen offset:1024
    v_mfma_f32_16x16x32_bf16 v[44:47], v[68:71], v[104:107], v[44:47]
    ds_read_b64 v[170:171], v4 offset:1224
    s_mul_i32 s100, s35, 112
    v_mfma_f32_16x16x32_bf16 v[48:51], v[68:71], v[108:111], v[48:51]
    ds_read_b128 v[148:151], v3 offset:1216
    s_mul_i32 s38, s38, 112
    v_mfma_f32_16x16x32_bf16 v[52:55], v[68:71], v[112:115], v[52:55]
    ds_read_b64 v[180:181], v4 offset:2752
    s_add_u32 s100, s100, s39
    v_mfma_f32_16x16x32_bf16 v[56:59], v[68:71], v[116:119], v[56:59]
    ds_read_b64 v[182:183], v4 offset:2760
    s_add_u32 s38, s38, s39
    v_mfma_f32_16x16x32_bf16 v[60:63], v[68:71], v[120:123], v[60:63]
    ds_read_b128 v[132:135], v3 offset:3264
    s_lshl_b32 s100, s100, 10
    buffer_load_dwordx4 a[232:235], v20, s[8:11], s33 offen offset:2048
    v_mfma_f32_16x16x32_bf16 v[40:43], v[68:71], v[100:103], v[40:43]
    ds_read_b64 v[164:165], v4 offset:704
    s_lshl_b32 s38, s38, 10
    v_mfma_f32_16x16x32_bf16 v[44:47], v[72:75], v[100:103], v[44:47]
    ds_read_b64 v[166:167], v4 offset:712
    v_add_u32 v12, s100, v1
    v_mfma_f32_16x16x32_bf16 v[48:51], v[76:79], v[100:103], v[48:51]
    ds_read_b128 v[152:155], v3 offset:704
    v_add_u32 v14, s38, v1
    v_mfma_f32_16x16x32_bf16 v[52:55], v[80:83], v[100:103], v[52:55]
    ds_read_b64 v[184:185], v4 offset:3264
    v_add_u32 v13, 114688, v12
    v_mfma_f32_16x16x32_bf16 v[56:59], v[84:87], v[100:103], v[56:59]
    ds_read_b64 v[186:187], v4 offset:3272
    v_add_u32 v15, 114688, v14
    buffer_load_dwordx4 a[236:239], v21, s[8:11], s33 offen offset:3072
    s_add_u32 s33, s33, s45
    v_mfma_f32_16x16x32_bf16 v[60:63], v[88:91], v[100:103], v[60:63]
    ds_read_b128 v[128:131], v3 offset:3776
    v_lshrrev_b32 v16, 2, v0
    v_mfma_f32_16x16x32_bf16 v[36:39], v[64:67], v[100:103], v[36:39]
    ds_read_b64 v[160:161], v4 offset:192
    v_lshlrev_b32 v17, 8, v16
    v_mfma_f32_16x16x32_bf16 v[40:43], v[64:67], v[104:107], v[40:43]
    ds_read_b64 v[162:163], v4 offset:200
    v_and_b32 v16, 7, v16
    v_mfma_f32_16x16x32_bf16 v[44:47], v[64:67], v[108:111], v[44:47]
    ds_read_b128 v[156:159], v3 offset:192
    s_lshl_b32 s38, s29, 2
    v_mfma_f32_16x16x32_bf16 v[48:51], v[64:67], v[112:115], v[48:51]
    ds_read_b64 v[188:189], v4 offset:3776
    v_xor_b32 v16, s38, v16
    buffer_load_dwordx4 a[208:211], v18, s[8:11], s33 offen offset:0
    v_mfma_f32_16x16x32_bf16 v[52:55], v[64:67], v[116:119], v[52:55]
    ds_read_b64 v[190:191], v4 offset:3784
    v_lshl_add_u32 v17, v16, 5, v17
    v_mfma_f32_16x16x32_bf16 v[56:59], v[64:67], v[120:123], v[56:59]
    v_and_b32 v16, 3, v0
    v_mfma_f32_16x16x32_bf16 v[60:63], v[64:67], v[124:127], v[60:63]
    v_lshl_add_u32 v17, v16, 3, v17
    v_mfma_f32_16x16x32_bf16 v[32:35], v[64:67], v[96:99], v[32:35]
    s_lshl_b32 s38, s37, 13
    buffer_load_dwordx4 a[212:215], v19, s[8:11], s33 offen offset:1024
    v_mfma_f32_16x16x32_bf16 v[36:39], v[68:71], v[96:99], v[36:39]
    v_add_u32 v192, s38, v17
    v_mfma_f32_16x16x32_bf16 v[40:43], v[72:75], v[96:99], v[40:43]
    s_lshl_b32 s38, s27, 1
    v_mfma_f32_16x16x32_bf16 v[44:47], v[76:79], v[96:99], v[44:47]
    s_add_u32 s38, s38, s29
    v_mfma_f32_16x16x32_bf16 v[48:51], v[80:83], v[96:99], v[48:51]
    s_lshl_b32 s38, s38, 8
    v_mfma_f32_16x16x32_bf16 v[52:55], v[84:87], v[96:99], v[52:55]
    s_add_u32 s38, s38, 36864
    buffer_load_dwordx4 a[216:219], v20, s[8:11], s33 offen offset:2048
    v_mfma_f32_16x16x32_bf16 v[56:59], v[88:91], v[96:99], v[56:59]
    v_mov_b32 v23, s38
    v_mfma_f32_16x16x32_bf16 v[60:63], v[92:95], v[96:99], v[60:63]
    v_add_u32 v26, s32, v1
    s_waitcnt lgkmcnt(0)
    v_mfma_f32_16x16x32_bf16 v[60:63], v[140:143], v[176:179], v[60:63]
    v_add_u32 v27, 65536, v26
    v_mfma_f32_16x16x32_bf16 v[56:59], v[140:143], v[172:175], v[56:59]
    v_xor_b32 v193, 32, v192
    v_mfma_f32_16x16x32_bf16 v[52:55], v[136:139], v[172:175], v[52:55]
    ds_read_b128 v[76:79], v3 offset:2304
    v_xor_b32 v194, 64, v192
    buffer_load_dwordx4 a[220:223], v21, s[8:11], s33 offen offset:3072
    s_add_u32 s33, s33, s44
    v_mfma_f32_16x16x32_bf16 v[60:63], v[144:147], v[172:175], v[60:63]
    ds_read_b64 v[108:109], v4 offset:1792
    v_xor_b32 v195, 96, v192
    v_mfma_f32_16x16x32_bf16 v[56:59], v[136:139], v[176:179], v[56:59]
    ds_read_b64 v[110:111], v4 offset:1800
    v_xor_b32 v196, 128, v192
    v_mfma_f32_16x16x32_bf16 v[48:51], v[136:139], v[168:171], v[48:51]
    ds_read_b128 v[80:83], v3 offset:1792
    v_xor_b32 v197, 160, v192
    v_mfma_f32_16x16x32_bf16 v[60:63], v[136:139], v[180:183], v[60:63]
    ds_read_b64 v[112:113], v4 offset:2304
    v_xor_b32 v198, 192, v192
    buffer_load_dwordx4 a[192:195], v18, s[8:11], s33 offen offset:0
    v_mfma_f32_16x16x32_bf16 v[52:55], v[140:143], v[168:171], v[52:55]
    ds_read_b64 v[114:115], v4 offset:2312
    v_xor_b32 v199, 224, v192
    v_mfma_f32_16x16x32_bf16 v[56:59], v[144:147], v[168:171], v[56:59]
    ds_read_b128 v[72:75], v3 offset:2816
    v_xor_b32 v200, 65536, v192
    v_mfma_f32_16x16x32_bf16 v[60:63], v[148:151], v[168:171], v[60:63]
    ds_read_b64 v[104:105], v4 offset:1280
    v_xor_b32 v201, 65568, v192
    v_mfma_f32_16x16x32_bf16 v[44:47], v[132:135], v[168:171], v[44:47]
    ds_read_b64 v[106:107], v4 offset:1288
    v_xor_b32 v202, 65600, v192
    v_mfma_f32_16x16x32_bf16 v[48:51], v[132:135], v[172:175], v[48:51]
    ds_read_b128 v[84:87], v3 offset:1280
    v_xor_b32 v203, 65632, v192
    buffer_load_dwordx4 a[196:199], v19, s[8:11], s33 offen offset:1024
    v_mfma_f32_16x16x32_bf16 v[52:55], v[132:135], v[176:179], v[52:55]
    ds_read_b64 v[116:117], v4 offset:2816
    v_xor_b32 v204, 65664, v192
    v_mfma_f32_16x16x32_bf16 v[56:59], v[132:135], v[180:183], v[56:59]
    ds_read_b64 v[118:119], v4 offset:2824
    v_xor_b32 v205, 65696, v192
    v_mfma_f32_16x16x32_bf16 v[60:63], v[132:135], v[184:187], v[60:63]
    ds_read_b128 v[68:71], v3 offset:3328
    v_xor_b32 v206, 65728, v192
    v_mfma_f32_16x16x32_bf16 v[40:43], v[132:135], v[164:167], v[40:43]
    ds_read_b64 v[100:101], v4 offset:768
    v_xor_b32 v207, 65760, v192
    v_mfma_f32_16x16x32_bf16 v[44:47], v[136:139], v[164:167], v[44:47]
    ds_read_b64 v[102:103], v4 offset:776
    s_mov_b32 s88, s96
    buffer_load_dwordx4 a[200:203], v20, s[8:11], s33 offen offset:2048
    v_mfma_f32_16x16x32_bf16 v[48:51], v[140:143], v[164:167], v[48:51]
    ds_read_b128 v[88:91], v3 offset:768
    s_and_b32 s89, s97, 0xffff
    v_mfma_f32_16x16x32_bf16 v[52:55], v[144:147], v[164:167], v[52:55]
    ds_read_b64 v[120:121], v4 offset:3328
    s_mov_b32 s90, 0x400000
    v_mfma_f32_16x16x32_bf16 v[56:59], v[148:151], v[164:167], v[56:59]
    ds_read_b64 v[122:123], v4 offset:3336
    s_mov_b32 s91, 0x20000
    v_mfma_f32_16x16x32_bf16 v[60:63], v[152:155], v[164:167], v[60:63]
    ds_read_b128 v[64:67], v3 offset:3840
    s_add_u32 s4, s6, 20971520
    s_addc_u32 s5, s7, 0
    buffer_load_dwordx4 a[204:207], v21, s[8:11], s33 offen offset:3072
    s_add_u32 s33, s33, s45
    v_mfma_f32_16x16x32_bf16 v[36:39], v[128:131], v[164:167], v[36:39]
    ds_read_b64 v[96:97], v4 offset:256
    s_mov_b32 s40, s4
    v_mfma_f32_16x16x32_bf16 v[40:43], v[128:131], v[168:171], v[40:43]
    ds_read_b64 v[98:99], v4 offset:264
    s_and_b32 s41, s5, 0xffff
    v_mfma_f32_16x16x32_bf16 v[44:47], v[128:131], v[172:175], v[44:47]
    ds_read_b128 v[92:95], v3 offset:256
    s_mov_b32 s42, 0x2000
    v_mfma_f32_16x16x32_bf16 v[48:51], v[128:131], v[176:179], v[48:51]
    ds_read_b64 v[124:125], v4 offset:3840
    s_mov_b32 s43, 0x20000
    v_mfma_f32_16x16x32_bf16 v[52:55], v[128:131], v[180:183], v[52:55]
    ds_read_b64 v[126:127], v4 offset:3848
    s_add_u32 s4, s6, 50331648
    s_addc_u32 s5, s7, 0
    buffer_load_dwordx4 a[176:179], v18, s[8:11], s33 offen offset:0
    v_mfma_f32_16x16x32_bf16 v[56:59], v[128:131], v[184:187], v[56:59]
    s_mov_b32 s52, s4
    v_mfma_f32_16x16x32_bf16 v[60:63], v[128:131], v[188:191], v[60:63]
    s_and_b32 s53, s5, 0xffff
    v_mfma_f32_16x16x32_bf16 v[32:35], v[128:131], v[160:163], v[32:35]
    s_mov_b32 s54, 0x800000
    v_mfma_f32_16x16x32_bf16 v[36:39], v[132:135], v[160:163], v[36:39]
    s_mov_b32 s55, 0x20000
    v_mfma_f32_16x16x32_bf16 v[40:43], v[136:139], v[160:163], v[40:43]
    buffer_load_dwordx4 a[180:183], v19, s[8:11], s33 offen offset:1024
    v_mfma_f32_16x16x32_bf16 v[44:47], v[140:143], v[160:163], v[44:47]
    v_mfma_f32_16x16x32_bf16 v[48:51], v[144:147], v[160:163], v[48:51]
    v_mfma_f32_16x16x32_bf16 v[52:55], v[148:151], v[160:163], v[52:55]
    v_mfma_f32_16x16x32_bf16 v[56:59], v[152:155], v[160:163], v[56:59]
    v_mfma_f32_16x16x32_bf16 v[60:63], v[156:159], v[160:163], v[60:63]
    buffer_load_dwordx4 a[184:187], v20, s[8:11], s33 offen offset:2048
    s_waitcnt lgkmcnt(0)
    v_mfma_f32_16x16x32_bf16 v[60:63], v[76:79], v[112:115], v[60:63]
    v_mfma_f32_16x16x32_bf16 v[56:59], v[76:79], v[108:111], v[56:59]
    v_mfma_f32_16x16x32_bf16 v[52:55], v[72:75], v[108:111], v[52:55]
    ds_read_b128 v[140:143], v3 offset:2368
    v_mfma_f32_16x16x32_bf16 v[60:63], v[80:83], v[108:111], v[60:63]
    ds_read_b64 v[172:173], v4 offset:1856
    buffer_load_dwordx4 a[188:191], v21, s[8:11], s33 offen offset:3072
    s_add_u32 s33, s33, s44
    v_mfma_f32_16x16x32_bf16 v[56:59], v[72:75], v[112:115], v[56:59]
    ds_read_b64 v[174:175], v4 offset:1864
    v_mfma_f32_16x16x32_bf16 v[48:51], v[72:75], v[104:107], v[48:51]
    ds_read_b128 v[144:147], v3 offset:1856
    v_mfma_f32_16x16x32_bf16 v[60:63], v[72:75], v[116:119], v[60:63]
    ds_read_b64 v[176:177], v4 offset:2368
    v_mfma_f32_16x16x32_bf16 v[52:55], v[76:79], v[104:107], v[52:55]
    ds_read_b64 v[178:179], v4 offset:2376
    v_mfma_f32_16x16x32_bf16 v[56:59], v[80:83], v[104:107], v[56:59]
    ds_read_b128 v[136:139], v3 offset:2880
    buffer_load_dwordx4 a[160:163], v18, s[8:11], s33 offen offset:0
    v_mfma_f32_16x16x32_bf16 v[60:63], v[84:87], v[104:107], v[60:63]
    ds_read_b64 v[168:169], v4 offset:1344
    v_mfma_f32_16x16x32_bf16 v[44:47], v[68:71], v[104:107], v[44:47]
    ds_read_b64 v[170:171], v4 offset:1352
    v_mfma_f32_16x16x32_bf16 v[48:51], v[68:71], v[108:111], v[48:51]
    ds_read_b128 v[148:151], v3 offset:1344
    v_mfma_f32_16x16x32_bf16 v[52:55], v[68:71], v[112:115], v[52:55]
    ds_read_b64 v[180:181], v4 offset:2880
    v_mfma_f32_16x16x32_bf16 v[56:59], v[68:71], v[116:119], v[56:59]
    ds_read_b64 v[182:183], v4 offset:2888
    buffer_load_dwordx4 a[164:167], v19, s[8:11], s33 offen offset:1024
    v_mfma_f32_16x16x32_bf16 v[60:63], v[68:71], v[120:123], v[60:63]
    ds_read_b128 v[132:135], v3 offset:3392
    v_mfma_f32_16x16x32_bf16 v[40:43], v[68:71], v[100:103], v[40:43]
    ds_read_b64 v[164:165], v4 offset:832
    v_mfma_f32_16x16x32_bf16 v[44:47], v[72:75], v[100:103], v[44:47]
    ds_read_b64 v[166:167], v4 offset:840
    v_mfma_f32_16x16x32_bf16 v[48:51], v[76:79], v[100:103], v[48:51]
    ds_read_b128 v[152:155], v3 offset:832
    buffer_load_dwordx4 a[168:171], v20, s[8:11], s33 offen offset:2048
    v_mfma_f32_16x16x32_bf16 v[52:55], v[80:83], v[100:103], v[52:55]
    ds_read_b64 v[184:185], v4 offset:3392
    v_mfma_f32_16x16x32_bf16 v[56:59], v[84:87], v[100:103], v[56:59]
    ds_read_b64 v[186:187], v4 offset:3400
    v_mfma_f32_16x16x32_bf16 v[60:63], v[88:91], v[100:103], v[60:63]
    ds_read_b128 v[128:131], v3 offset:3904
    v_mfma_f32_16x16x32_bf16 v[36:39], v[64:67], v[100:103], v[36:39]
    ds_read_b64 v[160:161], v4 offset:320
    v_mfma_f32_16x16x32_bf16 v[40:43], v[64:67], v[104:107], v[40:43]
    ds_read_b64 v[162:163], v4 offset:328
    buffer_load_dwordx4 a[172:175], v21, s[8:11], s33 offen offset:3072
    s_add_u32 s33, s33, s45
    v_mfma_f32_16x16x32_bf16 v[44:47], v[64:67], v[108:111], v[44:47]
    ds_read_b128 v[156:159], v3 offset:320
    v_mfma_f32_16x16x32_bf16 v[48:51], v[64:67], v[112:115], v[48:51]
    ds_read_b64 v[188:189], v4 offset:3904
    v_mfma_f32_16x16x32_bf16 v[52:55], v[64:67], v[116:119], v[52:55]
    ds_read_b64 v[190:191], v4 offset:3912
    v_mfma_f32_16x16x32_bf16 v[56:59], v[64:67], v[120:123], v[56:59]
    v_mfma_f32_16x16x32_bf16 v[60:63], v[64:67], v[124:127], v[60:63]
    buffer_load_dwordx4 a[144:147], v18, s[8:11], s33 offen offset:0
    v_mfma_f32_16x16x32_bf16 v[32:35], v[64:67], v[96:99], v[32:35]
    v_mfma_f32_16x16x32_bf16 v[36:39], v[68:71], v[96:99], v[36:39]
    v_mfma_f32_16x16x32_bf16 v[40:43], v[72:75], v[96:99], v[40:43]
    v_mfma_f32_16x16x32_bf16 v[44:47], v[76:79], v[96:99], v[44:47]
    buffer_load_dwordx4 a[148:151], v19, s[8:11], s33 offen offset:1024
    v_mfma_f32_16x16x32_bf16 v[48:51], v[80:83], v[96:99], v[48:51]
    v_mfma_f32_16x16x32_bf16 v[52:55], v[84:87], v[96:99], v[52:55]
    v_mfma_f32_16x16x32_bf16 v[56:59], v[88:91], v[96:99], v[56:59]
    v_mfma_f32_16x16x32_bf16 v[60:63], v[92:95], v[96:99], v[60:63]
    s_waitcnt lgkmcnt(0)
    v_mfma_f32_16x16x32_bf16 v[60:63], v[140:143], v[176:179], v[60:63]
    buffer_load_dwordx4 a[152:155], v20, s[8:11], s33 offen offset:2048
    v_mfma_f32_16x16x32_bf16 v[56:59], v[140:143], v[172:175], v[56:59]
    v_mfma_f32_16x16x32_bf16 v[52:55], v[136:139], v[172:175], v[52:55]
    ds_read_b128 v[76:79], v3 offset:2432
    v_mfma_f32_16x16x32_bf16 v[60:63], v[144:147], v[172:175], v[60:63]
    ds_read_b64 v[108:109], v4 offset:1920
    v_mfma_f32_16x16x32_bf16 v[56:59], v[136:139], v[176:179], v[56:59]
    ds_read_b64 v[110:111], v4 offset:1928
    v_mfma_f32_16x16x32_bf16 v[48:51], v[136:139], v[168:171], v[48:51]
    ds_read_b128 v[80:83], v3 offset:1920
    buffer_load_dwordx4 a[156:159], v21, s[8:11], s33 offen offset:3072
    s_add_u32 s33, s33, s44
    v_mfma_f32_16x16x32_bf16 v[60:63], v[136:139], v[180:183], v[60:63]
    ds_read_b64 v[112:113], v4 offset:2432
    v_mfma_f32_16x16x32_bf16 v[52:55], v[140:143], v[168:171], v[52:55]
    ds_read_b64 v[114:115], v4 offset:2440
    v_mfma_f32_16x16x32_bf16 v[56:59], v[144:147], v[168:171], v[56:59]
    ds_read_b128 v[72:75], v3 offset:2944
    v_mfma_f32_16x16x32_bf16 v[60:63], v[148:151], v[168:171], v[60:63]
    ds_read_b64 v[104:105], v4 offset:1408
    v_mfma_f32_16x16x32_bf16 v[44:47], v[132:135], v[168:171], v[44:47]
    ds_read_b64 v[106:107], v4 offset:1416
    v_mfma_f32_16x16x32_bf16 v[48:51], v[132:135], v[172:175], v[48:51]
    ds_read_b128 v[84:87], v3 offset:1408
    v_mfma_f32_16x16x32_bf16 v[52:55], v[132:135], v[176:179], v[52:55]
    ds_read_b64 v[116:117], v4 offset:2944
    v_mfma_f32_16x16x32_bf16 v[56:59], v[132:135], v[180:183], v[56:59]
    ds_read_b64 v[118:119], v4 offset:2952
    v_mfma_f32_16x16x32_bf16 v[60:63], v[132:135], v[184:187], v[60:63]
    ds_read_b128 v[68:71], v3 offset:3456
    v_mfma_f32_16x16x32_bf16 v[40:43], v[132:135], v[164:167], v[40:43]
    ds_read_b64 v[100:101], v4 offset:896
    v_mfma_f32_16x16x32_bf16 v[44:47], v[136:139], v[164:167], v[44:47]
    ds_read_b64 v[102:103], v4 offset:904
    v_mfma_f32_16x16x32_bf16 v[48:51], v[140:143], v[164:167], v[48:51]
    ds_read_b128 v[88:91], v3 offset:896
    v_mfma_f32_16x16x32_bf16 v[52:55], v[144:147], v[164:167], v[52:55]
    ds_read_b64 v[120:121], v4 offset:3456
    v_mfma_f32_16x16x32_bf16 v[56:59], v[148:151], v[164:167], v[56:59]
    ds_read_b64 v[122:123], v4 offset:3464
    v_mfma_f32_16x16x32_bf16 v[60:63], v[152:155], v[164:167], v[60:63]
    ds_read_b128 v[64:67], v3 offset:3968
    s_cmp_lg_u32 s24, 0
    s_cbranch_scc1 fused_kernel_nq
    global_load_dword v22, v23, s[56:57] sc1
    fused_kernel_nq:
    v_mfma_f32_16x16x32_bf16 v[36:39], v[128:131], v[164:167], v[36:39]
    ds_read_b64 v[96:97], v4 offset:384
    v_mfma_f32_16x16x32_bf16 v[40:43], v[128:131], v[168:171], v[40:43]
    ds_read_b64 v[98:99], v4 offset:392
    v_mfma_f32_16x16x32_bf16 v[44:47], v[128:131], v[172:175], v[44:47]
    ds_read_b128 v[92:95], v3 offset:384
    v_mfma_f32_16x16x32_bf16 v[48:51], v[128:131], v[176:179], v[48:51]
    ds_read_b64 v[124:125], v4 offset:3968
    v_mfma_f32_16x16x32_bf16 v[52:55], v[128:131], v[180:183], v[52:55]
    ds_read_b64 v[126:127], v4 offset:3976
    v_mfma_f32_16x16x32_bf16 v[56:59], v[128:131], v[184:187], v[56:59]
    v_mfma_f32_16x16x32_bf16 v[60:63], v[128:131], v[188:191], v[60:63]
    v_mfma_f32_16x16x32_bf16 v[32:35], v[128:131], v[160:163], v[32:35]
    v_mfma_f32_16x16x32_bf16 v[36:39], v[132:135], v[160:163], v[36:39]
    v_mfma_f32_16x16x32_bf16 v[40:43], v[136:139], v[160:163], v[40:43]
    v_mfma_f32_16x16x32_bf16 v[44:47], v[140:143], v[160:163], v[44:47]
    v_mfma_f32_16x16x32_bf16 v[48:51], v[144:147], v[160:163], v[48:51]
    v_mfma_f32_16x16x32_bf16 v[52:55], v[148:151], v[160:163], v[52:55]
    v_mfma_f32_16x16x32_bf16 v[56:59], v[152:155], v[160:163], v[56:59]
    v_mfma_f32_16x16x32_bf16 v[60:63], v[156:159], v[160:163], v[60:63]
    s_waitcnt lgkmcnt(0)
    s_cmp_lg_u32 s24, 0
    s_cbranch_scc1 fused_kernel_sh_go
    s_waitcnt vmcnt(0)
    v_readfirstlane_b32 s48, v22
    s_mov_b32 s49, 0
    s_cmp_ge_u32 s48, 28
    s_cbranch_scc1 fused_kernel_sh_go
    fused_kernel_sh:
    s_sleep 4
    global_load_dword v22, v23, s[56:57] sc1
    s_add_u32 s49, s49, 1
    s_waitcnt vmcnt(0)
    v_readfirstlane_b32 s48, v22
    s_cmp_ge_u32 s49, 0x40000
    s_cbranch_scc1 fused_kernel_sh_go
    s_cmp_lt_u32 s48, 28
    s_cbranch_scc1 fused_kernel_sh
    fused_kernel_sh_go:
    s_barrier
    v_mfma_f32_16x16x32_bf16 v[60:63], v[76:79], v[112:115], v[60:63]
    buffer_load_dwordx4 a[128:131], v12, s[20:23], s34 offen sc1
    v_mfma_f32_16x16x32_bf16 v[56:59], v[76:79], v[108:111], v[56:59]
    buffer_load_dwordx4 a[132:135], v13, s[20:23], s34 offen sc1
    v_mfma_f32_16x16x32_bf16 v[52:55], v[72:75], v[108:111], v[52:55]
    ds_read_b128 v[140:143], v3 offset:2496
    buffer_load_dwordx4 a[136:139], v14, s[20:23], s34 offen sc1
    v_mfma_f32_16x16x32_bf16 v[60:63], v[80:83], v[108:111], v[60:63]
    ds_read_b64 v[172:173], v4 offset:1984
    buffer_load_dwordx4 a[140:143], v15, s[20:23], s34 offen sc1
    s_add_u32 s34, s34, s46
    v_mfma_f32_16x16x32_bf16 v[56:59], v[72:75], v[112:115], v[56:59]
    ds_read_b64 v[174:175], v4 offset:1992
    buffer_load_dwordx4 a[112:115], v12, s[20:23], s34 offen sc1
    v_mfma_f32_16x16x32_bf16 v[48:51], v[72:75], v[104:107], v[48:51]
    ds_read_b128 v[144:147], v3 offset:1984
    buffer_load_dwordx4 a[116:119], v13, s[20:23], s34 offen sc1
    v_mfma_f32_16x16x32_bf16 v[60:63], v[72:75], v[116:119], v[60:63]
    ds_read_b64 v[176:177], v4 offset:2496
    v_mfma_f32_16x16x32_bf16 v[52:55], v[76:79], v[104:107], v[52:55]
    ds_read_b64 v[178:179], v4 offset:2504
    v_mfma_f32_16x16x32_bf16 v[56:59], v[80:83], v[104:107], v[56:59]
    ds_read_b128 v[136:139], v3 offset:3008
    buffer_load_dwordx4 a[120:123], v14, s[20:23], s34 offen sc1
    v_mfma_f32_16x16x32_bf16 v[60:63], v[84:87], v[104:107], v[60:63]
    ds_read_b64 v[168:169], v4 offset:1472
    v_mfma_f32_16x16x32_bf16 v[44:47], v[68:71], v[104:107], v[44:47]
    ds_read_b64 v[170:171], v4 offset:1480
    v_mfma_f32_16x16x32_bf16 v[48:51], v[68:71], v[108:111], v[48:51]
    ds_read_b128 v[148:151], v3 offset:1472
    v_mfma_f32_16x16x32_bf16 v[52:55], v[68:71], v[112:115], v[52:55]
    ds_read_b64 v[180:181], v4 offset:3008
    buffer_load_dwordx4 a[124:127], v15, s[20:23], s34 offen sc1
    s_add_u32 s34, s34, s47
    v_mfma_f32_16x16x32_bf16 v[56:59], v[68:71], v[116:119], v[56:59]
    ds_read_b64 v[182:183], v4 offset:3016
    v_mfma_f32_16x16x32_bf16 v[60:63], v[68:71], v[120:123], v[60:63]
    ds_read_b128 v[132:135], v3 offset:3520
    v_mfma_f32_16x16x32_bf16 v[40:43], v[68:71], v[100:103], v[40:43]
    ds_read_b64 v[164:165], v4 offset:960
    v_mfma_f32_16x16x32_bf16 v[44:47], v[72:75], v[100:103], v[44:47]
    ds_read_b64 v[166:167], v4 offset:968
    buffer_load_dwordx4 a[96:99], v12, s[20:23], s34 offen sc1
    v_mfma_f32_16x16x32_bf16 v[48:51], v[76:79], v[100:103], v[48:51]
    ds_read_b128 v[152:155], v3 offset:960
    v_mfma_f32_16x16x32_bf16 v[52:55], v[80:83], v[100:103], v[52:55]
    ds_read_b64 v[184:185], v4 offset:3520
    v_mfma_f32_16x16x32_bf16 v[56:59], v[84:87], v[100:103], v[56:59]
    ds_read_b64 v[186:187], v4 offset:3528
    v_mfma_f32_16x16x32_bf16 v[60:63], v[88:91], v[100:103], v[60:63]
    ds_read_b128 v[128:131], v3 offset:4032
    buffer_load_dwordx4 a[100:103], v13, s[20:23], s34 offen sc1
    v_mfma_f32_16x16x32_bf16 v[36:39], v[64:67], v[100:103], v[36:39]
    ds_read_b64 v[160:161], v4 offset:448
    v_mfma_f32_16x16x32_bf16 v[40:43], v[64:67], v[104:107], v[40:43]
    ds_read_b64 v[162:163], v4 offset:456
    v_mfma_f32_16x16x32_bf16 v[44:47], v[64:67], v[108:111], v[44:47]
    ds_read_b128 v[156:159], v3 offset:448
    v_mfma_f32_16x16x32_bf16 v[48:51], v[64:67], v[112:115], v[48:51]
    ds_read_b64 v[188:189], v4 offset:4032
    buffer_load_dwordx4 a[104:107], v14, s[20:23], s34 offen sc1
    v_mfma_f32_16x16x32_bf16 v[52:55], v[64:67], v[116:119], v[52:55]
    ds_read_b64 v[190:191], v4 offset:4040
    v_mfma_f32_16x16x32_bf16 v[56:59], v[64:67], v[120:123], v[56:59]
    v_mfma_f32_16x16x32_bf16 v[60:63], v[64:67], v[124:127], v[60:63]
    v_mfma_f32_16x16x32_bf16 v[32:35], v[64:67], v[96:99], v[32:35]
    buffer_load_dwordx4 a[108:111], v15, s[20:23], s34 offen sc1
    s_add_u32 s34, s34, s46
    v_mfma_f32_16x16x32_bf16 v[36:39], v[68:71], v[96:99], v[36:39]
    v_mfma_f32_16x16x32_bf16 v[40:43], v[72:75], v[96:99], v[40:43]
    v_mfma_f32_16x16x32_bf16 v[44:47], v[76:79], v[96:99], v[44:47]
    v_mfma_f32_16x16x32_bf16 v[48:51], v[80:83], v[96:99], v[48:51]
    buffer_load_dwordx4 a[80:83], v12, s[20:23], s34 offen sc1
    v_mfma_f32_16x16x32_bf16 v[52:55], v[84:87], v[96:99], v[52:55]
    v_mfma_f32_16x16x32_bf16 v[56:59], v[88:91], v[96:99], v[56:59]
    v_mfma_f32_16x16x32_bf16 v[60:63], v[92:95], v[96:99], v[60:63]
    s_waitcnt lgkmcnt(0)
    v_mfma_f32_16x16x32_bf16 v[60:63], v[140:143], v[176:179], v[60:63]
    buffer_load_dwordx4 a[84:87], v13, s[20:23], s34 offen sc1
    v_mfma_f32_16x16x32_bf16 v[56:59], v[140:143], v[172:175], v[56:59]
    v_mfma_f32_16x16x32_bf16 v[52:55], v[136:139], v[172:175], v[52:55]
    v_mfma_f32_16x16x32_bf16 v[60:63], v[144:147], v[172:175], v[60:63]
    v_mfma_f32_16x16x32_bf16 v[56:59], v[136:139], v[176:179], v[56:59]
    buffer_load_dwordx4 a[88:91], v14, s[20:23], s34 offen sc1
    v_mfma_f32_16x16x32_bf16 v[48:51], v[136:139], v[168:171], v[48:51]
    v_mfma_f32_16x16x32_bf16 v[60:63], v[136:139], v[180:183], v[60:63]
    v_mfma_f32_16x16x32_bf16 v[52:55], v[140:143], v[168:171], v[52:55]
    v_mfma_f32_16x16x32_bf16 v[56:59], v[144:147], v[168:171], v[56:59]
    buffer_load_dwordx4 a[92:95], v15, s[20:23], s34 offen sc1
    s_add_u32 s34, s34, s47
    v_mfma_f32_16x16x32_bf16 v[60:63], v[148:151], v[168:171], v[60:63]
    v_mfma_f32_16x16x32_bf16 v[44:47], v[132:135], v[168:171], v[44:47]
    v_mfma_f32_16x16x32_bf16 v[48:51], v[132:135], v[172:175], v[48:51]
    v_mfma_f32_16x16x32_bf16 v[52:55], v[132:135], v[176:179], v[52:55]
    buffer_load_dwordx4 a[64:67], v12, s[20:23], s34 offen sc1
    v_mfma_f32_16x16x32_bf16 v[56:59], v[132:135], v[180:183], v[56:59]
    v_mfma_f32_16x16x32_bf16 v[60:63], v[132:135], v[184:187], v[60:63]
    v_mfma_f32_16x16x32_bf16 v[40:43], v[132:135], v[164:167], v[40:43]
    v_mfma_f32_16x16x32_bf16 v[44:47], v[136:139], v[164:167], v[44:47]
    buffer_load_dwordx4 a[68:71], v13, s[20:23], s34 offen sc1
    v_mfma_f32_16x16x32_bf16 v[48:51], v[140:143], v[164:167], v[48:51]
    v_mfma_f32_16x16x32_bf16 v[52:55], v[144:147], v[164:167], v[52:55]
    v_mfma_f32_16x16x32_bf16 v[56:59], v[148:151], v[164:167], v[56:59]
    v_mfma_f32_16x16x32_bf16 v[60:63], v[152:155], v[164:167], v[60:63]
    buffer_load_dwordx4 a[72:75], v14, s[20:23], s34 offen sc1
    v_mfma_f32_16x16x32_bf16 v[36:39], v[128:131], v[164:167], v[36:39]
    v_mfma_f32_16x16x32_bf16 v[40:43], v[128:131], v[168:171], v[40:43]
    v_mfma_f32_16x16x32_bf16 v[44:47], v[128:131], v[172:175], v[44:47]
    v_mfma_f32_16x16x32_bf16 v[48:51], v[128:131], v[176:179], v[48:51]
    buffer_load_dwordx4 a[76:79], v15, s[20:23], s34 offen sc1
    s_add_u32 s34, s34, s46
    v_mfma_f32_16x16x32_bf16 v[52:55], v[128:131], v[180:183], v[52:55]
    v_mfma_f32_16x16x32_bf16 v[56:59], v[128:131], v[184:187], v[56:59]
    v_mfma_f32_16x16x32_bf16 v[60:63], v[128:131], v[188:191], v[60:63]
    v_mfma_f32_16x16x32_bf16 v[32:35], v[128:131], v[160:163], v[32:35]
    v_mfma_f32_16x16x32_bf16 v[36:39], v[132:135], v[160:163], v[36:39]
    v_mfma_f32_16x16x32_bf16 v[40:43], v[136:139], v[160:163], v[40:43]
    v_mfma_f32_16x16x32_bf16 v[44:47], v[140:143], v[160:163], v[44:47]
    v_mfma_f32_16x16x32_bf16 v[48:51], v[144:147], v[160:163], v[48:51]
    v_mfma_f32_16x16x32_bf16 v[52:55], v[148:151], v[160:163], v[52:55]
    v_mfma_f32_16x16x32_bf16 v[56:59], v[152:155], v[160:163], v[56:59]
    v_mfma_f32_16x16x32_bf16 v[60:63], v[156:159], v[160:163], v[60:63]
    ds_read_b64_tr_b16 a[0:1], v192 offset:0
    ds_read_b64_tr_b16 a[2:3], v192 offset:4096
    ds_read_b64_tr_b16 a[4:5], v193 offset:0
    ds_read_b64_tr_b16 a[6:7], v193 offset:4096
    ds_read_b64_tr_b16 a[8:9], v194 offset:0
    ds_read_b64_tr_b16 a[10:11], v194 offset:4096
    ds_read_b64_tr_b16 a[12:13], v195 offset:0
    ds_read_b64_tr_b16 a[14:15], v195 offset:4096
    ds_read_b64_tr_b16 a[16:17], v196 offset:0
    ds_read_b64_tr_b16 a[18:19], v196 offset:4096
    ds_read_b64_tr_b16 a[20:21], v197 offset:0
    ds_read_b64_tr_b16 a[22:23], v197 offset:4096
    ds_read_b64_tr_b16 a[24:25], v198 offset:0
    ds_read_b64_tr_b16 a[26:27], v198 offset:4096
    ds_read_b64_tr_b16 a[28:29], v199 offset:0
    ds_read_b64_tr_b16 a[30:31], v199 offset:4096
    s_nop 3
    v_cvt_pk_bf16_f32 v32, v32, v33
    ds_write_b32 v6, v32 offset:0
    v_cvt_pk_bf16_f32 v34, v34, v35
    ds_write_b32 v6, v34 offset:64
    v_cvt_pk_bf16_f32 v36, v36, v37
    ds_write_b32 v6, v36 offset:512
    v_cvt_pk_bf16_f32 v38, v38, v39
    ds_write_b32 v6, v38 offset:576
    v_cvt_pk_bf16_f32 v40, v40, v41
    ds_write_b32 v6, v40 offset:1024
    v_cvt_pk_bf16_f32 v42, v42, v43
    ds_write_b32 v6, v42 offset:1088
    v_cvt_pk_bf16_f32 v44, v44, v45
    ds_write_b32 v6, v44 offset:1536
    v_cvt_pk_bf16_f32 v46, v46, v47
    ds_write_b32 v6, v46 offset:1600
    v_cvt_pk_bf16_f32 v48, v48, v49
    ds_write_b32 v6, v48 offset:2048
    v_cvt_pk_bf16_f32 v50, v50, v51
    ds_write_b32 v6, v50 offset:2112
    v_cvt_pk_bf16_f32 v52, v52, v53
    ds_write_b32 v6, v52 offset:2560
    v_cvt_pk_bf16_f32 v54, v54, v55
    ds_write_b32 v6, v54 offset:2624
    v_cvt_pk_bf16_f32 v56, v56, v57
    ds_write_b32 v6, v56 offset:3072
    v_cvt_pk_bf16_f32 v58, v58, v59
    ds_write_b32 v6, v58 offset:3136
    v_cvt_pk_bf16_f32 v60, v60, v61
    ds_write_b32 v6, v60 offset:3584
    v_cvt_pk_bf16_f32 v62, v62, v63
    ds_write_b32 v6, v62 offset:3648
    ds_read_b128 v[64:67], v7 offset:0
    ds_read_b128 v[68:71], v7 offset:1024
    ds_read_b128 v[72:75], v7 offset:2048
    ds_read_b128 v[76:79], v7 offset:3072
    s_lshl_b32 s48, s30, 12
    s_waitcnt lgkmcnt(3)
    buffer_store_dwordx4 v[64:67], v1, s[84:87], s48 offen offset:0 sc1
    s_waitcnt lgkmcnt(2)
    buffer_store_dwordx4 v[68:71], v1, s[84:87], s48 offen offset:1024 sc1
    s_waitcnt lgkmcnt(1)
    buffer_store_dwordx4 v[72:75], v1, s[84:87], s48 offen offset:2048 sc1
    s_waitcnt lgkmcnt(0)
    buffer_store_dwordx4 v[76:79], v1, s[84:87], s48 offen offset:3072 sc1
    s_waitcnt vmcnt(20)
    s_waitcnt lgkmcnt(0)
    v_mfma_f32_16x16x32_bf16 v[32:35], a[0:3], a[128:131], 0
    s_barrier
    v_mfma_f32_16x16x32_bf16 v[36:39], a[4:7], a[128:131], 0
    s_waitcnt vmcnt(60)
    ds_write_b128 v27, v[208:211] offset:16384
    v_mfma_f32_16x16x32_bf16 v[40:43], a[8:11], a[128:131], 0
    ds_read_b64_tr_b16 a[32:33], v192 offset:16384
    v_mfma_f32_16x16x32_bf16 v[44:47], a[12:15], a[128:131], 0
    ds_read_b64_tr_b16 a[34:35], v192 offset:20480
    v_mfma_f32_16x16x32_bf16 v[96:99], a[16:19], a[128:131], 0
    buffer_load_dwordx4 v[160:163], v12, s[20:23], s34 offen sc1
    v_mfma_f32_16x16x32_bf16 v[100:103], a[20:23], a[128:131], 0
    ds_read_b64_tr_b16 a[36:37], v193 offset:16384
    v_mfma_f32_16x16x32_bf16 v[104:107], a[24:27], a[128:131], 0
    ds_read_b64_tr_b16 a[38:39], v193 offset:20480
    v_mfma_f32_16x16x32_bf16 v[108:111], a[28:31], a[128:131], 0
    buffer_load_dwordx4 v[164:167], v13, s[20:23], s34 offen sc1
    v_mfma_f32_16x16x32_bf16 v[48:51], a[0:3], a[132:135], 0
    ds_read_b64_tr_b16 a[40:41], v194 offset:16384
    v_mfma_f32_16x16x32_bf16 v[52:55], a[4:7], a[132:135], 0
    ds_read_b64_tr_b16 a[42:43], v194 offset:20480
    v_mfma_f32_16x16x32_bf16 v[56:59], a[8:11], a[132:135], 0
    ds_write_b128 v27, v[212:215] offset:17408
    v_mfma_f32_16x16x32_bf16 v[60:63], a[12:15], a[132:135], 0
    ds_read_b64_tr_b16 a[44:45], v195 offset:16384
    v_mfma_f32_16x16x32_bf16 v[112:115], a[16:19], a[132:135], 0
    ds_read_b64_tr_b16 a[46:47], v195 offset:20480
    v_mfma_f32_16x16x32_bf16 v[116:119], a[20:23], a[132:135], 0
    buffer_load_dwordx4 v[168:171], v14, s[20:23], s34 offen sc1
    v_mfma_f32_16x16x32_bf16 v[120:123], a[24:27], a[132:135], 0
    ds_read_b64_tr_b16 a[48:49], v196 offset:16384
    v_mfma_f32_16x16x32_bf16 v[124:127], a[28:31], a[132:135], 0
    ds_read_b64_tr_b16 a[50:51], v196 offset:20480
    v_mfma_f32_16x16x32_bf16 v[64:67], a[0:3], a[136:139], 0
    buffer_load_dwordx4 v[172:175], v15, s[20:23], s34 offen sc1
    s_add_u32 s34, s34, s47
    v_mfma_f32_16x16x32_bf16 v[68:71], a[4:7], a[136:139], 0
    ds_read_b64_tr_b16 a[52:53], v197 offset:16384
    v_mfma_f32_16x16x32_bf16 v[72:75], a[8:11], a[136:139], 0
    ds_read_b64_tr_b16 a[54:55], v197 offset:20480
    v_mfma_f32_16x16x32_bf16 v[76:79], a[12:15], a[136:139], 0
    ds_write_b128 v27, v[216:219] offset:18432
    v_mfma_f32_16x16x32_bf16 v[128:131], a[16:19], a[136:139], 0
    ds_read_b64_tr_b16 a[56:57], v198 offset:16384
    v_mfma_f32_16x16x32_bf16 v[132:135], a[20:23], a[136:139], 0
    ds_read_b64_tr_b16 a[58:59], v198 offset:20480
    v_mfma_f32_16x16x32_bf16 v[136:139], a[24:27], a[136:139], 0
    buffer_load_dwordx4 v[176:179], v12, s[20:23], s34 offen sc1
    v_mfma_f32_16x16x32_bf16 v[140:143], a[28:31], a[136:139], 0
    ds_read_b64_tr_b16 a[60:61], v199 offset:16384
    v_mfma_f32_16x16x32_bf16 v[80:83], a[0:3], a[140:143], 0
    ds_read_b64_tr_b16 a[62:63], v199 offset:20480
    v_mfma_f32_16x16x32_bf16 v[84:87], a[4:7], a[140:143], 0
    ds_write_b128 v27, v[220:223] offset:19456
    v_mfma_f32_16x16x32_bf16 v[88:91], a[8:11], a[140:143], 0
    s_waitcnt vmcnt(61)
    ds_write_b128 v27, v[224:227] offset:32768
    v_mfma_f32_16x16x32_bf16 v[92:95], a[12:15], a[140:143], 0
    buffer_load_dwordx4 v[180:183], v13, s[20:23], s34 offen sc1
    v_mfma_f32_16x16x32_bf16 v[144:147], a[16:19], a[140:143], 0
    ds_write_b128 v27, v[228:231] offset:33792
    v_mfma_f32_16x16x32_bf16 v[148:151], a[20:23], a[140:143], 0
    ds_write_b128 v27, v[232:235] offset:34816
    v_mfma_f32_16x16x32_bf16 v[152:155], a[24:27], a[140:143], 0
    buffer_load_dwordx4 v[184:187], v14, s[20:23], s34 offen sc1
    v_mfma_f32_16x16x32_bf16 v[156:159], a[28:31], a[140:143], 0
    ds_write_b128 v27, v[236:239] offset:35840
    s_waitcnt vmcnt(23)
    s_waitcnt lgkmcnt(0)
    v_mfma_f32_16x16x32_bf16 v[32:35], a[32:35], a[112:115], v[32:35]
    s_barrier
    v_mfma_f32_16x16x32_bf16 v[36:39], a[36:39], a[112:115], v[36:39]
    s_waitcnt vmcnt(59)
    ds_write_b128 v27, v[240:243] offset:49152
    v_mfma_f32_16x16x32_bf16 v[40:43], a[40:43], a[112:115], v[40:43]
    ds_read_b64_tr_b16 a[0:1], v192 offset:32768
    v_mfma_f32_16x16x32_bf16 v[44:47], a[44:47], a[112:115], v[44:47]
    ds_read_b64_tr_b16 a[2:3], v192 offset:36864
    v_mfma_f32_16x16x32_bf16 v[96:99], a[48:51], a[112:115], v[96:99]
    buffer_load_dwordx4 v[188:191], v15, s[20:23], s34 offen sc1
    s_add_u32 s34, s34, s46
    v_mfma_f32_16x16x32_bf16 v[100:103], a[52:55], a[112:115], v[100:103]
    ds_read_b64_tr_b16 a[4:5], v193 offset:32768
    v_mfma_f32_16x16x32_bf16 v[104:107], a[56:59], a[112:115], v[104:107]
    ds_read_b64_tr_b16 a[6:7], v193 offset:36864
    v_mfma_f32_16x16x32_bf16 v[108:111], a[60:63], a[112:115], v[108:111]
    buffer_load_dwordx4 v[208:211], v12, s[20:23], s34 offen sc1
    v_mfma_f32_16x16x32_bf16 v[48:51], a[32:35], a[116:119], v[48:51]
    ds_read_b64_tr_b16 a[8:9], v194 offset:32768
    v_mfma_f32_16x16x32_bf16 v[52:55], a[36:39], a[116:119], v[52:55]
    ds_read_b64_tr_b16 a[10:11], v194 offset:36864
    v_mfma_f32_16x16x32_bf16 v[56:59], a[40:43], a[116:119], v[56:59]
    ds_write_b128 v27, v[244:247] offset:50176
    v_mfma_f32_16x16x32_bf16 v[60:63], a[44:47], a[116:119], v[60:63]
    ds_read_b64_tr_b16 a[12:13], v195 offset:32768
    v_mfma_f32_16x16x32_bf16 v[112:115], a[48:51], a[116:119], v[112:115]
    ds_read_b64_tr_b16 a[14:15], v195 offset:36864
    v_mfma_f32_16x16x32_bf16 v[116:119], a[52:55], a[116:119], v[116:119]
    buffer_load_dwordx4 v[212:215], v13, s[20:23], s34 offen sc1
    v_mfma_f32_16x16x32_bf16 v[120:123], a[56:59], a[116:119], v[120:123]
    ds_read_b64_tr_b16 a[16:17], v196 offset:32768
    v_mfma_f32_16x16x32_bf16 v[124:127], a[60:63], a[116:119], v[124:127]
    ds_read_b64_tr_b16 a[18:19], v196 offset:36864
    v_mfma_f32_16x16x32_bf16 v[64:67], a[32:35], a[120:123], v[64:67]
    buffer_load_dwordx4 v[216:219], v14, s[20:23], s34 offen sc1
    v_mfma_f32_16x16x32_bf16 v[68:71], a[36:39], a[120:123], v[68:71]
    ds_read_b64_tr_b16 a[20:21], v197 offset:32768
    v_mfma_f32_16x16x32_bf16 v[72:75], a[40:43], a[120:123], v[72:75]
    ds_read_b64_tr_b16 a[22:23], v197 offset:36864
    v_mfma_f32_16x16x32_bf16 v[76:79], a[44:47], a[120:123], v[76:79]
    ds_write_b128 v27, v[248:251] offset:51200
    v_mfma_f32_16x16x32_bf16 v[128:131], a[48:51], a[120:123], v[128:131]
    ds_read_b64_tr_b16 a[24:25], v198 offset:32768
    v_mfma_f32_16x16x32_bf16 v[132:135], a[52:55], a[120:123], v[132:135]
    ds_read_b64_tr_b16 a[26:27], v198 offset:36864
    v_mfma_f32_16x16x32_bf16 v[136:139], a[56:59], a[120:123], v[136:139]
    buffer_load_dwordx4 v[220:223], v15, s[20:23], s34 offen sc1
    s_add_u32 s34, s34, s47
    v_mfma_f32_16x16x32_bf16 v[140:143], a[60:63], a[120:123], v[140:143]
    ds_read_b64_tr_b16 a[28:29], v199 offset:32768
    v_mfma_f32_16x16x32_bf16 v[80:83], a[32:35], a[124:127], v[80:83]
    ds_read_b64_tr_b16 a[30:31], v199 offset:36864
    v_mfma_f32_16x16x32_bf16 v[84:87], a[36:39], a[124:127], v[84:87]
    ds_write_b128 v27, v[252:255] offset:52224
    v_mfma_f32_16x16x32_bf16 v[88:91], a[40:43], a[124:127], v[88:91]
    s_waitcnt vmcnt(60)
    ds_write_b128 v26, a[240:243] offset:0
    v_mfma_f32_16x16x32_bf16 v[92:95], a[44:47], a[124:127], v[92:95]
    buffer_load_dwordx4 v[224:227], v12, s[20:23], s34 offen sc1
    v_mfma_f32_16x16x32_bf16 v[144:147], a[48:51], a[124:127], v[144:147]
    ds_write_b128 v26, a[244:247] offset:1024
    v_mfma_f32_16x16x32_bf16 v[148:151], a[52:55], a[124:127], v[148:151]
    ds_write_b128 v26, a[248:251] offset:2048
    v_mfma_f32_16x16x32_bf16 v[152:155], a[56:59], a[124:127], v[152:155]
    buffer_load_dwordx4 v[228:231], v13, s[20:23], s34 offen sc1
    v_mfma_f32_16x16x32_bf16 v[156:159], a[60:63], a[124:127], v[156:159]
    ds_write_b128 v26, a[252:255] offset:3072
    s_waitcnt vmcnt(26)
    s_waitcnt lgkmcnt(0)
    v_mfma_f32_16x16x32_bf16 v[32:35], a[0:3], a[96:99], v[32:35]
    s_barrier
    v_mfma_f32_16x16x32_bf16 v[36:39], a[4:7], a[96:99], v[36:39]
    s_waitcnt vmcnt(58)
    ds_write_b128 v26, a[224:227] offset:16384
    v_mfma_f32_16x16x32_bf16 v[40:43], a[8:11], a[96:99], v[40:43]
    ds_read_b64_tr_b16 a[32:33], v192 offset:49152
    v_mfma_f32_16x16x32_bf16 v[44:47], a[12:15], a[96:99], v[44:47]
    ds_read_b64_tr_b16 a[34:35], v192 offset:53248
    v_mfma_f32_16x16x32_bf16 v[96:99], a[16:19], a[96:99], v[96:99]
    buffer_load_dwordx4 v[232:235], v14, s[20:23], s34 offen sc1
    v_mfma_f32_16x16x32_bf16 v[100:103], a[20:23], a[96:99], v[100:103]
    ds_read_b64_tr_b16 a[36:37], v193 offset:49152
    v_mfma_f32_16x16x32_bf16 v[104:107], a[24:27], a[96:99], v[104:107]
    ds_read_b64_tr_b16 a[38:39], v193 offset:53248
    v_mfma_f32_16x16x32_bf16 v[108:111], a[28:31], a[96:99], v[108:111]
    buffer_load_dwordx4 v[236:239], v15, s[20:23], s34 offen sc1
    s_add_u32 s34, s34, s46
    v_mfma_f32_16x16x32_bf16 v[48:51], a[0:3], a[100:103], v[48:51]
    ds_read_b64_tr_b16 a[40:41], v194 offset:49152
    v_mfma_f32_16x16x32_bf16 v[52:55], a[4:7], a[100:103], v[52:55]
    ds_read_b64_tr_b16 a[42:43], v194 offset:53248
    v_mfma_f32_16x16x32_bf16 v[56:59], a[8:11], a[100:103], v[56:59]
    ds_write_b128 v26, a[228:231] offset:17408
    v_mfma_f32_16x16x32_bf16 v[60:63], a[12:15], a[100:103], v[60:63]
    ds_read_b64_tr_b16 a[44:45], v195 offset:49152
    v_mfma_f32_16x16x32_bf16 v[112:115], a[16:19], a[100:103], v[112:115]
    ds_read_b64_tr_b16 a[46:47], v195 offset:53248
    v_mfma_f32_16x16x32_bf16 v[116:119], a[20:23], a[100:103], v[116:119]
    buffer_load_dwordx4 v[240:243], v12, s[20:23], s34 offen sc1
    v_mfma_f32_16x16x32_bf16 v[120:123], a[24:27], a[100:103], v[120:123]
    ds_read_b64_tr_b16 a[48:49], v196 offset:49152
    v_mfma_f32_16x16x32_bf16 v[124:127], a[28:31], a[100:103], v[124:127]
    ds_read_b64_tr_b16 a[50:51], v196 offset:53248
    v_mfma_f32_16x16x32_bf16 v[64:67], a[0:3], a[104:107], v[64:67]
    buffer_load_dwordx4 v[244:247], v13, s[20:23], s34 offen sc1
    v_mfma_f32_16x16x32_bf16 v[68:71], a[4:7], a[104:107], v[68:71]
    ds_read_b64_tr_b16 a[52:53], v197 offset:49152
    v_mfma_f32_16x16x32_bf16 v[72:75], a[8:11], a[104:107], v[72:75]
    ds_read_b64_tr_b16 a[54:55], v197 offset:53248
    v_mfma_f32_16x16x32_bf16 v[76:79], a[12:15], a[104:107], v[76:79]
    ds_write_b128 v26, a[232:235] offset:18432
    v_mfma_f32_16x16x32_bf16 v[128:131], a[16:19], a[104:107], v[128:131]
    ds_read_b64_tr_b16 a[56:57], v198 offset:49152
    v_mfma_f32_16x16x32_bf16 v[132:135], a[20:23], a[104:107], v[132:135]
    ds_read_b64_tr_b16 a[58:59], v198 offset:53248
    v_mfma_f32_16x16x32_bf16 v[136:139], a[24:27], a[104:107], v[136:139]
    buffer_load_dwordx4 v[248:251], v14, s[20:23], s34 offen sc1
    v_mfma_f32_16x16x32_bf16 v[140:143], a[28:31], a[104:107], v[140:143]
    ds_read_b64_tr_b16 a[60:61], v199 offset:49152
    v_mfma_f32_16x16x32_bf16 v[80:83], a[0:3], a[108:111], v[80:83]
    ds_read_b64_tr_b16 a[62:63], v199 offset:53248
    v_mfma_f32_16x16x32_bf16 v[84:87], a[4:7], a[108:111], v[84:87]
    ds_write_b128 v26, a[236:239] offset:19456
    v_mfma_f32_16x16x32_bf16 v[88:91], a[8:11], a[108:111], v[88:91]
    s_waitcnt vmcnt(59)
    ds_write_b128 v26, a[208:211] offset:32768
    v_mfma_f32_16x16x32_bf16 v[92:95], a[12:15], a[108:111], v[92:95]
    buffer_load_dwordx4 v[252:255], v15, s[20:23], s34 offen sc1
    s_add_u32 s34, s34, s47
    v_mfma_f32_16x16x32_bf16 v[144:147], a[16:19], a[108:111], v[144:147]
    ds_write_b128 v26, a[212:215] offset:33792
    v_mfma_f32_16x16x32_bf16 v[148:151], a[20:23], a[108:111], v[148:151]
    ds_write_b128 v26, a[216:219] offset:34816
    v_mfma_f32_16x16x32_bf16 v[152:155], a[24:27], a[108:111], v[152:155]
    buffer_load_dwordx4 a[240:243], v12, s[20:23], s34 offen sc1
    v_mfma_f32_16x16x32_bf16 v[156:159], a[28:31], a[108:111], v[156:159]
    ds_write_b128 v26, a[220:223] offset:35840
    s_waitcnt vmcnt(29)
    s_waitcnt lgkmcnt(0)
    v_mfma_f32_16x16x32_bf16 v[32:35], a[32:35], a[80:83], v[32:35]
    s_barrier
    v_mfma_f32_16x16x32_bf16 v[36:39], a[36:39], a[80:83], v[36:39]
    s_waitcnt vmcnt(57)
    ds_write_b128 v26, a[192:195] offset:49152
    v_mfma_f32_16x16x32_bf16 v[40:43], a[40:43], a[80:83], v[40:43]
    ds_read_b64_tr_b16 a[0:1], v200 offset:0
    v_mfma_f32_16x16x32_bf16 v[44:47], a[44:47], a[80:83], v[44:47]
    ds_read_b64_tr_b16 a[2:3], v200 offset:4096
    v_mfma_f32_16x16x32_bf16 v[96:99], a[48:51], a[80:83], v[96:99]
    buffer_load_dwordx4 a[244:247], v13, s[20:23], s34 offen sc1
    v_mfma_f32_16x16x32_bf16 v[100:103], a[52:55], a[80:83], v[100:103]
    ds_read_b64_tr_b16 a[4:5], v201 offset:0
    v_mfma_f32_16x16x32_bf16 v[104:107], a[56:59], a[80:83], v[104:107]
    ds_read_b64_tr_b16 a[6:7], v201 offset:4096
    v_mfma_f32_16x16x32_bf16 v[108:111], a[60:63], a[80:83], v[108:111]
    buffer_load_dwordx4 a[248:251], v14, s[20:23], s34 offen sc1
    v_mfma_f32_16x16x32_bf16 v[48:51], a[32:35], a[84:87], v[48:51]
    ds_read_b64_tr_b16 a[8:9], v202 offset:0
    v_mfma_f32_16x16x32_bf16 v[52:55], a[36:39], a[84:87], v[52:55]
    ds_read_b64_tr_b16 a[10:11], v202 offset:4096
    v_mfma_f32_16x16x32_bf16 v[56:59], a[40:43], a[84:87], v[56:59]
    ds_write_b128 v26, a[196:199] offset:50176
    v_mfma_f32_16x16x32_bf16 v[60:63], a[44:47], a[84:87], v[60:63]
    ds_read_b64_tr_b16 a[12:13], v203 offset:0
    v_mfma_f32_16x16x32_bf16 v[112:115], a[48:51], a[84:87], v[112:115]
    ds_read_b64_tr_b16 a[14:15], v203 offset:4096
    v_mfma_f32_16x16x32_bf16 v[116:119], a[52:55], a[84:87], v[116:119]
    buffer_load_dwordx4 a[252:255], v15, s[20:23], s34 offen sc1
    s_add_u32 s34, s34, s46
    v_mfma_f32_16x16x32_bf16 v[120:123], a[56:59], a[84:87], v[120:123]
    ds_read_b64_tr_b16 a[16:17], v204 offset:0
    v_mfma_f32_16x16x32_bf16 v[124:127], a[60:63], a[84:87], v[124:127]
    ds_read_b64_tr_b16 a[18:19], v204 offset:4096
    v_mfma_f32_16x16x32_bf16 v[64:67], a[32:35], a[88:91], v[64:67]
    buffer_load_dwordx4 a[224:227], v12, s[20:23], s34 offen sc1
    v_mfma_f32_16x16x32_bf16 v[68:71], a[36:39], a[88:91], v[68:71]
    ds_read_b64_tr_b16 a[20:21], v205 offset:0
    v_mfma_f32_16x16x32_bf16 v[72:75], a[40:43], a[88:91], v[72:75]
    ds_read_b64_tr_b16 a[22:23], v205 offset:4096
    v_mfma_f32_16x16x32_bf16 v[76:79], a[44:47], a[88:91], v[76:79]
    ds_write_b128 v26, a[200:203] offset:51200
    v_mfma_f32_16x16x32_bf16 v[128:131], a[48:51], a[88:91], v[128:131]
    ds_read_b64_tr_b16 a[24:25], v206 offset:0
    v_mfma_f32_16x16x32_bf16 v[132:135], a[52:55], a[88:91], v[132:135]
    ds_read_b64_tr_b16 a[26:27], v206 offset:4096
    v_mfma_f32_16x16x32_bf16 v[136:139], a[56:59], a[88:91], v[136:139]
    buffer_load_dwordx4 a[228:231], v13, s[20:23], s34 offen sc1
    v_mfma_f32_16x16x32_bf16 v[140:143], a[60:63], a[88:91], v[140:143]
    ds_read_b64_tr_b16 a[28:29], v207 offset:0
    v_mfma_f32_16x16x32_bf16 v[80:83], a[32:35], a[92:95], v[80:83]
    ds_read_b64_tr_b16 a[30:31], v207 offset:4096
    v_mfma_f32_16x16x32_bf16 v[84:87], a[36:39], a[92:95], v[84:87]
    ds_write_b128 v26, a[204:207] offset:52224
    v_mfma_f32_16x16x32_bf16 v[88:91], a[40:43], a[92:95], v[88:91]
    s_lshr_b32 s36, s2, 4
    v_mfma_f32_16x16x32_bf16 v[92:95], a[44:47], a[92:95], v[92:95]
    buffer_load_dwordx4 a[232:235], v14, s[20:23], s34 offen sc1
    v_mfma_f32_16x16x32_bf16 v[144:147], a[48:51], a[92:95], v[144:147]
    s_lshl_b32 s36, s36, 8
    v_mfma_f32_16x16x32_bf16 v[148:151], a[52:55], a[92:95], v[148:151]
    s_add_u32 s36, s36, 32768
    v_mfma_f32_16x16x32_bf16 v[152:155], a[56:59], a[92:95], v[152:155]
    buffer_load_dwordx4 a[236:239], v15, s[20:23], s34 offen sc1
    s_add_u32 s34, s34, s47
    v_mfma_f32_16x16x32_bf16 v[156:159], a[60:63], a[92:95], v[156:159]
    v_mov_b32 v16, s36
    s_waitcnt vmcnt(32)
    s_waitcnt lgkmcnt(0)
    v_mfma_f32_16x16x32_bf16 v[32:35], a[0:3], a[64:67], v[32:35]
    s_barrier
    v_mfma_f32_16x16x32_bf16 v[36:39], a[4:7], a[64:67], v[36:39]
    s_waitcnt vmcnt(60)
    ds_write_b128 v27, a[176:179] offset:0
    v_mfma_f32_16x16x32_bf16 v[40:43], a[8:11], a[64:67], v[40:43]
    ds_read_b64_tr_b16 a[32:33], v200 offset:16384
    v_mfma_f32_16x16x32_bf16 v[44:47], a[12:15], a[64:67], v[44:47]
    ds_read_b64_tr_b16 a[34:35], v200 offset:20480
    v_mfma_f32_16x16x32_bf16 v[96:99], a[16:19], a[64:67], v[96:99]
    buffer_load_dwordx4 a[208:211], v12, s[20:23], s34 offen sc1
    v_mfma_f32_16x16x32_bf16 v[100:103], a[20:23], a[64:67], v[100:103]
    ds_read_b64_tr_b16 a[36:37], v201 offset:16384
    v_mfma_f32_16x16x32_bf16 v[104:107], a[24:27], a[64:67], v[104:107]
    ds_read_b64_tr_b16 a[38:39], v201 offset:20480
    v_mfma_f32_16x16x32_bf16 v[108:111], a[28:31], a[64:67], v[108:111]
    buffer_load_dwordx4 a[212:215], v13, s[20:23], s34 offen sc1
    v_mfma_f32_16x16x32_bf16 v[48:51], a[0:3], a[68:71], v[48:51]
    ds_read_b64_tr_b16 a[40:41], v202 offset:16384
    v_mfma_f32_16x16x32_bf16 v[52:55], a[4:7], a[68:71], v[52:55]
    ds_read_b64_tr_b16 a[42:43], v202 offset:20480
    v_mfma_f32_16x16x32_bf16 v[56:59], a[8:11], a[68:71], v[56:59]
    ds_write_b128 v27, a[180:183] offset:1024
    v_mfma_f32_16x16x32_bf16 v[60:63], a[12:15], a[68:71], v[60:63]
    ds_read_b64_tr_b16 a[44:45], v203 offset:16384
    v_mfma_f32_16x16x32_bf16 v[112:115], a[16:19], a[68:71], v[112:115]
    ds_read_b64_tr_b16 a[46:47], v203 offset:20480
    v_mfma_f32_16x16x32_bf16 v[116:119], a[20:23], a[68:71], v[116:119]
    buffer_load_dwordx4 a[216:219], v14, s[20:23], s34 offen sc1
    v_mfma_f32_16x16x32_bf16 v[120:123], a[24:27], a[68:71], v[120:123]
    ds_read_b64_tr_b16 a[48:49], v204 offset:16384
    v_mfma_f32_16x16x32_bf16 v[124:127], a[28:31], a[68:71], v[124:127]
    ds_read_b64_tr_b16 a[50:51], v204 offset:20480
    v_mfma_f32_16x16x32_bf16 v[64:67], a[0:3], a[72:75], v[64:67]
    buffer_load_dwordx4 a[220:223], v15, s[20:23], s34 offen sc1
    s_add_u32 s34, s34, s46
    v_mfma_f32_16x16x32_bf16 v[68:71], a[4:7], a[72:75], v[68:71]
    ds_read_b64_tr_b16 a[52:53], v205 offset:16384
    v_mfma_f32_16x16x32_bf16 v[72:75], a[8:11], a[72:75], v[72:75]
    ds_read_b64_tr_b16 a[54:55], v205 offset:20480
    v_mfma_f32_16x16x32_bf16 v[76:79], a[12:15], a[72:75], v[76:79]
    ds_write_b128 v27, a[184:187] offset:2048
    v_mfma_f32_16x16x32_bf16 v[128:131], a[16:19], a[72:75], v[128:131]
    ds_read_b64_tr_b16 a[56:57], v206 offset:16384
    v_mfma_f32_16x16x32_bf16 v[132:135], a[20:23], a[72:75], v[132:135]
    ds_read_b64_tr_b16 a[58:59], v206 offset:20480
    v_mfma_f32_16x16x32_bf16 v[136:139], a[24:27], a[72:75], v[136:139]
    buffer_load_dwordx4 a[192:195], v12, s[20:23], s34 offen sc1
    v_mfma_f32_16x16x32_bf16 v[140:143], a[28:31], a[72:75], v[140:143]
    ds_read_b64_tr_b16 a[60:61], v207 offset:16384
    v_mfma_f32_16x16x32_bf16 v[80:83], a[0:3], a[76:79], v[80:83]
    ds_read_b64_tr_b16 a[62:63], v207 offset:20480
    v_mfma_f32_16x16x32_bf16 v[84:87], a[4:7], a[76:79], v[84:87]
    ds_write_b128 v27, a[188:191] offset:3072
    v_mfma_f32_16x16x32_bf16 v[88:91], a[8:11], a[76:79], v[88:91]
    v_mfma_f32_16x16x32_bf16 v[92:95], a[12:15], a[76:79], v[92:95]
    buffer_load_dwordx4 a[196:199], v13, s[20:23], s34 offen sc1
    v_mfma_f32_16x16x32_bf16 v[144:147], a[16:19], a[76:79], v[144:147]
    v_mfma_f32_16x16x32_bf16 v[148:151], a[20:23], a[76:79], v[148:151]
    v_mfma_f32_16x16x32_bf16 v[152:155], a[24:27], a[76:79], v[152:155]
    buffer_load_dwordx4 a[200:203], v14, s[20:23], s34 offen sc1
    v_mfma_f32_16x16x32_bf16 v[156:159], a[28:31], a[76:79], v[156:159]
    s_waitcnt vmcnt(31)
    s_waitcnt lgkmcnt(0)
    v_mfma_f32_16x16x32_bf16 v[32:35], a[32:35], v[160:163], v[32:35]
    s_waitcnt vmcnt(35)
    s_barrier
    v_mfma_f32_16x16x32_bf16 v[36:39], a[36:39], v[160:163], v[36:39]
    s_waitcnt vmcnt(63)
    ds_write_b128 v27, a[160:163] offset:16384
    s_cmp_lg_u32 s24, 0
    s_cbranch_scc1 fused_kernel_na
    s_mov_b64 exec, 1
    global_atomic_add v16, v25, s[56:57] sc1
    s_mov_b64 exec, -1
    fused_kernel_na:
    v_mfma_f32_16x16x32_bf16 v[40:43], a[40:43], v[160:163], v[40:43]
    ds_read_b64_tr_b16 a[0:1], v200 offset:32768
    v_mfma_f32_16x16x32_bf16 v[44:47], a[44:47], v[160:163], v[44:47]
    ds_read_b64_tr_b16 a[2:3], v200 offset:36864
    v_mfma_f32_16x16x32_bf16 v[96:99], a[48:51], v[160:163], v[96:99]
    buffer_load_dwordx4 a[204:207], v15, s[20:23], s34 offen sc1
    s_add_u32 s34, s34, s47
    v_mfma_f32_16x16x32_bf16 v[100:103], a[52:55], v[160:163], v[100:103]
    ds_read_b64_tr_b16 a[4:5], v201 offset:32768
    v_mfma_f32_16x16x32_bf16 v[104:107], a[56:59], v[160:163], v[104:107]
    ds_read_b64_tr_b16 a[6:7], v201 offset:36864
    v_mfma_f32_16x16x32_bf16 v[108:111], a[60:63], v[160:163], v[108:111]
    buffer_load_dwordx4 a[176:179], v12, s[20:23], s34 offen sc1
    v_mfma_f32_16x16x32_bf16 v[48:51], a[32:35], v[164:167], v[48:51]
    ds_read_b64_tr_b16 a[8:9], v202 offset:32768
    v_mfma_f32_16x16x32_bf16 v[52:55], a[36:39], v[164:167], v[52:55]
    ds_read_b64_tr_b16 a[10:11], v202 offset:36864
    v_mfma_f32_16x16x32_bf16 v[56:59], a[40:43], v[164:167], v[56:59]
    ds_write_b128 v27, a[164:167] offset:17408
    v_mfma_f32_16x16x32_bf16 v[60:63], a[44:47], v[164:167], v[60:63]
    ds_read_b64_tr_b16 a[12:13], v203 offset:32768
    v_mfma_f32_16x16x32_bf16 v[112:115], a[48:51], v[164:167], v[112:115]
    ds_read_b64_tr_b16 a[14:15], v203 offset:36864
    v_mfma_f32_16x16x32_bf16 v[116:119], a[52:55], v[164:167], v[116:119]
    buffer_load_dwordx4 a[180:183], v13, s[20:23], s34 offen sc1
    v_mfma_f32_16x16x32_bf16 v[120:123], a[56:59], v[164:167], v[120:123]
    ds_read_b64_tr_b16 a[16:17], v204 offset:32768
    v_mfma_f32_16x16x32_bf16 v[124:127], a[60:63], v[164:167], v[124:127]
    ds_read_b64_tr_b16 a[18:19], v204 offset:36864
    v_mfma_f32_16x16x32_bf16 v[64:67], a[32:35], v[168:171], v[64:67]
    buffer_load_dwordx4 a[184:187], v14, s[20:23], s34 offen sc1
    v_mfma_f32_16x16x32_bf16 v[68:71], a[36:39], v[168:171], v[68:71]
    ds_read_b64_tr_b16 a[20:21], v205 offset:32768
    v_mfma_f32_16x16x32_bf16 v[72:75], a[40:43], v[168:171], v[72:75]
    ds_read_b64_tr_b16 a[22:23], v205 offset:36864
    v_mfma_f32_16x16x32_bf16 v[76:79], a[44:47], v[168:171], v[76:79]
    ds_write_b128 v27, a[168:171] offset:18432
    v_mfma_f32_16x16x32_bf16 v[128:131], a[48:51], v[168:171], v[128:131]
    ds_read_b64_tr_b16 a[24:25], v206 offset:32768
    v_mfma_f32_16x16x32_bf16 v[132:135], a[52:55], v[168:171], v[132:135]
    ds_read_b64_tr_b16 a[26:27], v206 offset:36864
    v_mfma_f32_16x16x32_bf16 v[136:139], a[56:59], v[168:171], v[136:139]
    buffer_load_dwordx4 a[188:191], v15, s[20:23], s34 offen sc1
    s_add_u32 s34, s34, s46
    v_mfma_f32_16x16x32_bf16 v[140:143], a[60:63], v[168:171], v[140:143]
    ds_read_b64_tr_b16 a[28:29], v207 offset:32768
    v_mfma_f32_16x16x32_bf16 v[80:83], a[32:35], v[172:175], v[80:83]
    ds_read_b64_tr_b16 a[30:31], v207 offset:36864
    v_mfma_f32_16x16x32_bf16 v[84:87], a[36:39], v[172:175], v[84:87]
    ds_write_b128 v27, a[172:175] offset:19456
    v_mfma_f32_16x16x32_bf16 v[88:91], a[40:43], v[172:175], v[88:91]
    v_mfma_f32_16x16x32_bf16 v[92:95], a[44:47], v[172:175], v[92:95]
    buffer_load_dwordx4 a[128:131], v12, s[20:23], s34 offen sc1
    v_mfma_f32_16x16x32_bf16 v[144:147], a[48:51], v[172:175], v[144:147]
    v_mfma_f32_16x16x32_bf16 v[148:151], a[52:55], v[172:175], v[148:151]
    v_mfma_f32_16x16x32_bf16 v[152:155], a[56:59], v[172:175], v[152:155]
    buffer_load_dwordx4 a[132:135], v13, s[20:23], s34 offen sc1
    v_mfma_f32_16x16x32_bf16 v[156:159], a[60:63], v[172:175], v[156:159]
    s_waitcnt vmcnt(34)
    s_waitcnt lgkmcnt(0)
    v_mfma_f32_16x16x32_bf16 v[32:35], a[0:3], v[176:179], v[32:35]
    s_barrier
    v_mfma_f32_16x16x32_bf16 v[36:39], a[4:7], v[176:179], v[36:39]
    s_waitcnt vmcnt(63)
    ds_write_b128 v27, a[144:147] offset:32768
    v_mfma_f32_16x16x32_bf16 v[40:43], a[8:11], v[176:179], v[40:43]
    ds_read_b64_tr_b16 a[32:33], v200 offset:49152
    v_mfma_f32_16x16x32_bf16 v[44:47], a[12:15], v[176:179], v[44:47]
    ds_read_b64_tr_b16 a[34:35], v200 offset:53248
    v_mfma_f32_16x16x32_bf16 v[96:99], a[16:19], v[176:179], v[96:99]
    buffer_load_dwordx4 a[136:139], v14, s[20:23], s34 offen sc1
    v_mfma_f32_16x16x32_bf16 v[100:103], a[20:23], v[176:179], v[100:103]
    ds_read_b64_tr_b16 a[36:37], v201 offset:49152
    v_mfma_f32_16x16x32_bf16 v[104:107], a[24:27], v[176:179], v[104:107]
    ds_read_b64_tr_b16 a[38:39], v201 offset:53248
    v_mfma_f32_16x16x32_bf16 v[108:111], a[28:31], v[176:179], v[108:111]
    buffer_load_dwordx4 a[140:143], v15, s[20:23], s34 offen sc1
    s_add_u32 s34, s34, s47
    v_mfma_f32_16x16x32_bf16 v[48:51], a[0:3], v[180:183], v[48:51]
    ds_read_b64_tr_b16 a[40:41], v202 offset:49152
    v_mfma_f32_16x16x32_bf16 v[52:55], a[4:7], v[180:183], v[52:55]
    ds_read_b64_tr_b16 a[42:43], v202 offset:53248
    v_mfma_f32_16x16x32_bf16 v[56:59], a[8:11], v[180:183], v[56:59]
    ds_write_b128 v27, a[148:151] offset:33792
    v_mfma_f32_16x16x32_bf16 v[60:63], a[12:15], v[180:183], v[60:63]
    ds_read_b64_tr_b16 a[44:45], v203 offset:49152
    v_mfma_f32_16x16x32_bf16 v[112:115], a[16:19], v[180:183], v[112:115]
    ds_read_b64_tr_b16 a[46:47], v203 offset:53248
    v_mfma_f32_16x16x32_bf16 v[116:119], a[20:23], v[180:183], v[116:119]
    buffer_load_dwordx4 v[160:163], v12, s[20:23], s34 offen sc1
    v_mfma_f32_16x16x32_bf16 v[120:123], a[24:27], v[180:183], v[120:123]
    ds_read_b64_tr_b16 a[48:49], v204 offset:49152
    v_mfma_f32_16x16x32_bf16 v[124:127], a[28:31], v[180:183], v[124:127]
    ds_read_b64_tr_b16 a[50:51], v204 offset:53248
    v_mfma_f32_16x16x32_bf16 v[64:67], a[0:3], v[184:187], v[64:67]
    buffer_load_dwordx4 v[164:167], v13, s[20:23], s34 offen sc1
    v_mfma_f32_16x16x32_bf16 v[68:71], a[4:7], v[184:187], v[68:71]
    ds_read_b64_tr_b16 a[52:53], v205 offset:49152
    v_mfma_f32_16x16x32_bf16 v[72:75], a[8:11], v[184:187], v[72:75]
    ds_read_b64_tr_b16 a[54:55], v205 offset:53248
    v_mfma_f32_16x16x32_bf16 v[76:79], a[12:15], v[184:187], v[76:79]
    ds_write_b128 v27, a[152:155] offset:34816
    v_mfma_f32_16x16x32_bf16 v[128:131], a[16:19], v[184:187], v[128:131]
    ds_read_b64_tr_b16 a[56:57], v206 offset:49152
    v_mfma_f32_16x16x32_bf16 v[132:135], a[20:23], v[184:187], v[132:135]
    ds_read_b64_tr_b16 a[58:59], v206 offset:53248
    v_mfma_f32_16x16x32_bf16 v[136:139], a[24:27], v[184:187], v[136:139]
    buffer_load_dwordx4 v[168:171], v14, s[20:23], s34 offen sc1
    v_mfma_f32_16x16x32_bf16 v[140:143], a[28:31], v[184:187], v[140:143]
    ds_read_b64_tr_b16 a[60:61], v207 offset:49152
    v_mfma_f32_16x16x32_bf16 v[80:83], a[0:3], v[188:191], v[80:83]
    ds_read_b64_tr_b16 a[62:63], v207 offset:53248
    v_mfma_f32_16x16x32_bf16 v[84:87], a[4:7], v[188:191], v[84:87]
    ds_write_b128 v27, a[156:159] offset:35840
    v_mfma_f32_16x16x32_bf16 v[88:91], a[8:11], v[188:191], v[88:91]
    v_mfma_f32_16x16x32_bf16 v[92:95], a[12:15], v[188:191], v[92:95]
    buffer_load_dwordx4 v[172:175], v15, s[20:23], s34 offen sc1
    s_add_u32 s34, s34, s46
    v_mfma_f32_16x16x32_bf16 v[144:147], a[16:19], v[188:191], v[144:147]
    v_mfma_f32_16x16x32_bf16 v[148:151], a[20:23], v[188:191], v[148:151]
    v_mfma_f32_16x16x32_bf16 v[152:155], a[24:27], v[188:191], v[152:155]
    buffer_load_dwordx4 a[160:163], v12, s[20:23], s34 offen sc1
    v_mfma_f32_16x16x32_bf16 v[156:159], a[28:31], v[188:191], v[156:159]
    s_waitcnt vmcnt(37)
    s_waitcnt lgkmcnt(0)
    v_mfma_f32_16x16x32_bf16 v[32:35], a[32:35], v[208:211], v[32:35]
    s_barrier
    v_mfma_f32_16x16x32_bf16 v[36:39], a[36:39], v[208:211], v[36:39]
    v_mfma_f32_16x16x32_bf16 v[40:43], a[40:43], v[208:211], v[40:43]
    ds_read_b64_tr_b16 a[0:1], v192 offset:0
    v_mfma_f32_16x16x32_bf16 v[44:47], a[44:47], v[208:211], v[44:47]
    ds_read_b64_tr_b16 a[2:3], v192 offset:4096
    s_add_u32 m0, s32, 114688
    v_mfma_f32_16x16x32_bf16 v[96:99], a[48:51], v[208:211], v[96:99]
    buffer_load_dwordx4 v18, s[8:11], s33 offen offset:0 lds
    v_mfma_f32_16x16x32_bf16 v[100:103], a[52:55], v[208:211], v[100:103]
    ds_read_b64_tr_b16 a[4:5], v193 offset:0
    v_mfma_f32_16x16x32_bf16 v[104:107], a[56:59], v[208:211], v[104:107]
    ds_read_b64_tr_b16 a[6:7], v193 offset:4096
    v_mfma_f32_16x16x32_bf16 v[108:111], a[60:63], v[208:211], v[108:111]
    buffer_load_dwordx4 v19, s[8:11], s33 offen offset:1024 lds
    v_mfma_f32_16x16x32_bf16 v[48:51], a[32:35], v[212:215], v[48:51]
    ds_read_b64_tr_b16 a[8:9], v194 offset:0
    v_mfma_f32_16x16x32_bf16 v[52:55], a[36:39], v[212:215], v[52:55]
    ds_read_b64_tr_b16 a[10:11], v194 offset:4096
    v_mfma_f32_16x16x32_bf16 v[56:59], a[40:43], v[212:215], v[56:59]
    v_mfma_f32_16x16x32_bf16 v[60:63], a[44:47], v[212:215], v[60:63]
    ds_read_b64_tr_b16 a[12:13], v195 offset:0
    v_mfma_f32_16x16x32_bf16 v[112:115], a[48:51], v[212:215], v[112:115]
    ds_read_b64_tr_b16 a[14:15], v195 offset:4096
    v_mfma_f32_16x16x32_bf16 v[116:119], a[52:55], v[212:215], v[116:119]
    buffer_load_dwordx4 v20, s[8:11], s33 offen offset:2048 lds
    v_mfma_f32_16x16x32_bf16 v[120:123], a[56:59], v[212:215], v[120:123]
    ds_read_b64_tr_b16 a[16:17], v196 offset:0
    v_mfma_f32_16x16x32_bf16 v[124:127], a[60:63], v[212:215], v[124:127]
    ds_read_b64_tr_b16 a[18:19], v196 offset:4096
    v_mfma_f32_16x16x32_bf16 v[64:67], a[32:35], v[216:219], v[64:67]
    buffer_load_dwordx4 v21, s[8:11], s33 offen offset:3072 lds
    s_add_u32 s33, s33, s45
    v_mfma_f32_16x16x32_bf16 v[68:71], a[36:39], v[216:219], v[68:71]
    ds_read_b64_tr_b16 a[20:21], v197 offset:0
    v_mfma_f32_16x16x32_bf16 v[72:75], a[40:43], v[216:219], v[72:75]
    ds_read_b64_tr_b16 a[22:23], v197 offset:4096
    v_mfma_f32_16x16x32_bf16 v[76:79], a[44:47], v[216:219], v[76:79]
    v_mfma_f32_16x16x32_bf16 v[128:131], a[48:51], v[216:219], v[128:131]
    ds_read_b64_tr_b16 a[24:25], v198 offset:0
    v_mfma_f32_16x16x32_bf16 v[132:135], a[52:55], v[216:219], v[132:135]
    ds_read_b64_tr_b16 a[26:27], v198 offset:4096
    v_mfma_f32_16x16x32_bf16 v[136:139], a[56:59], v[216:219], v[136:139]
    buffer_load_dwordx4 a[164:167], v13, s[20:23], s34 offen sc1
    v_mfma_f32_16x16x32_bf16 v[140:143], a[60:63], v[216:219], v[140:143]
    ds_read_b64_tr_b16 a[28:29], v199 offset:0
    v_mfma_f32_16x16x32_bf16 v[80:83], a[32:35], v[220:223], v[80:83]
    ds_read_b64_tr_b16 a[30:31], v199 offset:4096
    v_mfma_f32_16x16x32_bf16 v[84:87], a[36:39], v[220:223], v[84:87]
    v_mfma_f32_16x16x32_bf16 v[88:91], a[40:43], v[220:223], v[88:91]
    v_mfma_f32_16x16x32_bf16 v[92:95], a[44:47], v[220:223], v[92:95]
    buffer_load_dwordx4 a[168:171], v14, s[20:23], s34 offen sc1
    v_mfma_f32_16x16x32_bf16 v[144:147], a[48:51], v[220:223], v[144:147]
    v_mfma_f32_16x16x32_bf16 v[148:151], a[52:55], v[220:223], v[148:151]
    v_mfma_f32_16x16x32_bf16 v[152:155], a[56:59], v[220:223], v[152:155]
    buffer_load_dwordx4 a[172:175], v15, s[20:23], s34 offen sc1
    s_add_u32 s34, s34, s47
    v_mfma_f32_16x16x32_bf16 v[156:159], a[60:63], v[220:223], v[156:159]
    s_waitcnt vmcnt(40)
    s_waitcnt lgkmcnt(0)
    v_mfma_f32_16x16x32_bf16 v[32:35], a[0:3], v[224:227], v[32:35]
    s_barrier
    v_mfma_f32_16x16x32_bf16 v[36:39], a[4:7], v[224:227], v[36:39]
    v_mfma_f32_16x16x32_bf16 v[40:43], a[8:11], v[224:227], v[40:43]
    ds_read_b64_tr_b16 a[32:33], v192 offset:16384
    v_mfma_f32_16x16x32_bf16 v[44:47], a[12:15], v[224:227], v[44:47]
    ds_read_b64_tr_b16 a[34:35], v192 offset:20480
    s_add_u32 m0, s32, 0
    v_mfma_f32_16x16x32_bf16 v[96:99], a[16:19], v[224:227], v[96:99]
    buffer_load_dwordx4 v18, s[8:11], s33 offen offset:0 lds
    v_mfma_f32_16x16x32_bf16 v[100:103], a[20:23], v[224:227], v[100:103]
    ds_read_b64_tr_b16 a[36:37], v193 offset:16384
    v_mfma_f32_16x16x32_bf16 v[104:107], a[24:27], v[224:227], v[104:107]
    ds_read_b64_tr_b16 a[38:39], v193 offset:20480
    v_mfma_f32_16x16x32_bf16 v[108:111], a[28:31], v[224:227], v[108:111]
    buffer_load_dwordx4 v19, s[8:11], s33 offen offset:1024 lds
    v_mfma_f32_16x16x32_bf16 v[48:51], a[0:3], v[228:231], v[48:51]
    ds_read_b64_tr_b16 a[40:41], v194 offset:16384
    v_mfma_f32_16x16x32_bf16 v[52:55], a[4:7], v[228:231], v[52:55]
    ds_read_b64_tr_b16 a[42:43], v194 offset:20480
    v_mfma_f32_16x16x32_bf16 v[56:59], a[8:11], v[228:231], v[56:59]
    v_mfma_f32_16x16x32_bf16 v[60:63], a[12:15], v[228:231], v[60:63]
    ds_read_b64_tr_b16 a[44:45], v195 offset:16384
    v_mfma_f32_16x16x32_bf16 v[112:115], a[16:19], v[228:231], v[112:115]
    ds_read_b64_tr_b16 a[46:47], v195 offset:20480
    v_mfma_f32_16x16x32_bf16 v[116:119], a[20:23], v[228:231], v[116:119]
    buffer_load_dwordx4 v20, s[8:11], s33 offen offset:2048 lds
    v_mfma_f32_16x16x32_bf16 v[120:123], a[24:27], v[228:231], v[120:123]
    ds_read_b64_tr_b16 a[48:49], v196 offset:16384
    v_mfma_f32_16x16x32_bf16 v[124:127], a[28:31], v[228:231], v[124:127]
    ds_read_b64_tr_b16 a[50:51], v196 offset:20480
    v_mfma_f32_16x16x32_bf16 v[64:67], a[0:3], v[232:235], v[64:67]
    buffer_load_dwordx4 v21, s[8:11], s33 offen offset:3072 lds
    s_add_u32 s33, s33, s44
    v_mfma_f32_16x16x32_bf16 v[68:71], a[4:7], v[232:235], v[68:71]
    ds_read_b64_tr_b16 a[52:53], v197 offset:16384
    v_mfma_f32_16x16x32_bf16 v[72:75], a[8:11], v[232:235], v[72:75]
    ds_read_b64_tr_b16 a[54:55], v197 offset:20480
    v_mfma_f32_16x16x32_bf16 v[76:79], a[12:15], v[232:235], v[76:79]
    v_mfma_f32_16x16x32_bf16 v[128:131], a[16:19], v[232:235], v[128:131]
    ds_read_b64_tr_b16 a[56:57], v198 offset:16384
    v_mfma_f32_16x16x32_bf16 v[132:135], a[20:23], v[232:235], v[132:135]
    ds_read_b64_tr_b16 a[58:59], v198 offset:20480
    v_mfma_f32_16x16x32_bf16 v[136:139], a[24:27], v[232:235], v[136:139]
    buffer_load_dwordx4 v[208:211], v12, s[20:23], s34 offen sc1
    v_mfma_f32_16x16x32_bf16 v[140:143], a[28:31], v[232:235], v[140:143]
    ds_read_b64_tr_b16 a[60:61], v199 offset:16384
    v_mfma_f32_16x16x32_bf16 v[80:83], a[0:3], v[236:239], v[80:83]
    ds_read_b64_tr_b16 a[62:63], v199 offset:20480
    v_mfma_f32_16x16x32_bf16 v[84:87], a[4:7], v[236:239], v[84:87]
    v_mfma_f32_16x16x32_bf16 v[88:91], a[8:11], v[236:239], v[88:91]
    v_mfma_f32_16x16x32_bf16 v[92:95], a[12:15], v[236:239], v[92:95]
    buffer_load_dwordx4 v[212:215], v13, s[20:23], s34 offen sc1
    v_mfma_f32_16x16x32_bf16 v[144:147], a[16:19], v[236:239], v[144:147]
    v_mfma_f32_16x16x32_bf16 v[148:151], a[20:23], v[236:239], v[148:151]
    v_mfma_f32_16x16x32_bf16 v[152:155], a[24:27], v[236:239], v[152:155]
    buffer_load_dwordx4 v[216:219], v14, s[20:23], s34 offen sc1
    v_mfma_f32_16x16x32_bf16 v[156:159], a[28:31], v[236:239], v[156:159]
    s_waitcnt vmcnt(43)
    s_waitcnt lgkmcnt(0)
    v_mfma_f32_16x16x32_bf16 v[32:35], a[32:35], v[240:243], v[32:35]
    s_barrier
    v_mfma_f32_16x16x32_bf16 v[36:39], a[36:39], v[240:243], v[36:39]
    v_mfma_f32_16x16x32_bf16 v[40:43], a[40:43], v[240:243], v[40:43]
    ds_read_b64_tr_b16 a[0:1], v192 offset:32768
    v_mfma_f32_16x16x32_bf16 v[44:47], a[44:47], v[240:243], v[44:47]
    ds_read_b64_tr_b16 a[2:3], v192 offset:36864
    s_add_u32 m0, s32, 16384
    v_mfma_f32_16x16x32_bf16 v[96:99], a[48:51], v[240:243], v[96:99]
    buffer_load_dwordx4 v18, s[8:11], s33 offen offset:0 lds
    v_mfma_f32_16x16x32_bf16 v[100:103], a[52:55], v[240:243], v[100:103]
    ds_read_b64_tr_b16 a[4:5], v193 offset:32768
    v_mfma_f32_16x16x32_bf16 v[104:107], a[56:59], v[240:243], v[104:107]
    ds_read_b64_tr_b16 a[6:7], v193 offset:36864
    v_mfma_f32_16x16x32_bf16 v[108:111], a[60:63], v[240:243], v[108:111]
    buffer_load_dwordx4 v19, s[8:11], s33 offen offset:1024 lds
    v_mfma_f32_16x16x32_bf16 v[48:51], a[32:35], v[244:247], v[48:51]
    ds_read_b64_tr_b16 a[8:9], v194 offset:32768
    v_mfma_f32_16x16x32_bf16 v[52:55], a[36:39], v[244:247], v[52:55]
    ds_read_b64_tr_b16 a[10:11], v194 offset:36864
    v_mfma_f32_16x16x32_bf16 v[56:59], a[40:43], v[244:247], v[56:59]
    v_mfma_f32_16x16x32_bf16 v[60:63], a[44:47], v[244:247], v[60:63]
    ds_read_b64_tr_b16 a[12:13], v195 offset:32768
    v_mfma_f32_16x16x32_bf16 v[112:115], a[48:51], v[244:247], v[112:115]
    ds_read_b64_tr_b16 a[14:15], v195 offset:36864
    v_mfma_f32_16x16x32_bf16 v[116:119], a[52:55], v[244:247], v[116:119]
    buffer_load_dwordx4 v20, s[8:11], s33 offen offset:2048 lds
    v_mfma_f32_16x16x32_bf16 v[120:123], a[56:59], v[244:247], v[120:123]
    ds_read_b64_tr_b16 a[16:17], v196 offset:32768
    v_mfma_f32_16x16x32_bf16 v[124:127], a[60:63], v[244:247], v[124:127]
    ds_read_b64_tr_b16 a[18:19], v196 offset:36864
    v_mfma_f32_16x16x32_bf16 v[64:67], a[32:35], v[248:251], v[64:67]
    buffer_load_dwordx4 v21, s[8:11], s33 offen offset:3072 lds
    s_add_u32 s33, s33, s45
    v_mfma_f32_16x16x32_bf16 v[68:71], a[36:39], v[248:251], v[68:71]
    ds_read_b64_tr_b16 a[20:21], v197 offset:32768
    v_mfma_f32_16x16x32_bf16 v[72:75], a[40:43], v[248:251], v[72:75]
    ds_read_b64_tr_b16 a[22:23], v197 offset:36864
    v_mfma_f32_16x16x32_bf16 v[76:79], a[44:47], v[248:251], v[76:79]
    v_mfma_f32_16x16x32_bf16 v[128:131], a[48:51], v[248:251], v[128:131]
    ds_read_b64_tr_b16 a[24:25], v198 offset:32768
    v_mfma_f32_16x16x32_bf16 v[132:135], a[52:55], v[248:251], v[132:135]
    ds_read_b64_tr_b16 a[26:27], v198 offset:36864
    v_mfma_f32_16x16x32_bf16 v[136:139], a[56:59], v[248:251], v[136:139]
    buffer_load_dwordx4 v[220:223], v15, s[20:23], s34 offen sc1
    s_add_u32 s34, s34, s46
    v_mfma_f32_16x16x32_bf16 v[140:143], a[60:63], v[248:251], v[140:143]
    ds_read_b64_tr_b16 a[28:29], v199 offset:32768
    v_mfma_f32_16x16x32_bf16 v[80:83], a[32:35], v[252:255], v[80:83]
    ds_read_b64_tr_b16 a[30:31], v199 offset:36864
    v_mfma_f32_16x16x32_bf16 v[84:87], a[36:39], v[252:255], v[84:87]
    v_mfma_f32_16x16x32_bf16 v[88:91], a[40:43], v[252:255], v[88:91]
    v_mfma_f32_16x16x32_bf16 v[92:95], a[44:47], v[252:255], v[92:95]
    buffer_load_dwordx4 v[224:227], v12, s[20:23], s34 offen sc1
    v_mfma_f32_16x16x32_bf16 v[144:147], a[48:51], v[252:255], v[144:147]
    v_mfma_f32_16x16x32_bf16 v[148:151], a[52:55], v[252:255], v[148:151]
    v_mfma_f32_16x16x32_bf16 v[152:155], a[56:59], v[252:255], v[152:155]
    buffer_load_dwordx4 v[228:231], v13, s[20:23], s34 offen sc1
    v_mfma_f32_16x16x32_bf16 v[156:159], a[60:63], v[252:255], v[156:159]
    s_waitcnt vmcnt(46)
    s_waitcnt lgkmcnt(0)
    v_mfma_f32_16x16x32_bf16 v[32:35], a[0:3], a[240:243], v[32:35]
    s_barrier
    v_mfma_f32_16x16x32_bf16 v[36:39], a[4:7], a[240:243], v[36:39]
    v_mfma_f32_16x16x32_bf16 v[40:43], a[8:11], a[240:243], v[40:43]
    ds_read_b64_tr_b16 a[32:33], v192 offset:49152
    v_mfma_f32_16x16x32_bf16 v[44:47], a[12:15], a[240:243], v[44:47]
    ds_read_b64_tr_b16 a[34:35], v192 offset:53248
    s_add_u32 m0, s32, 32768
    v_mfma_f32_16x16x32_bf16 v[96:99], a[16:19], a[240:243], v[96:99]
    buffer_load_dwordx4 v18, s[8:11], s33 offen offset:0 lds
    v_mfma_f32_16x16x32_bf16 v[100:103], a[20:23], a[240:243], v[100:103]
    ds_read_b64_tr_b16 a[36:37], v193 offset:49152
    v_mfma_f32_16x16x32_bf16 v[104:107], a[24:27], a[240:243], v[104:107]
    ds_read_b64_tr_b16 a[38:39], v193 offset:53248
    v_mfma_f32_16x16x32_bf16 v[108:111], a[28:31], a[240:243], v[108:111]
    buffer_load_dwordx4 v19, s[8:11], s33 offen offset:1024 lds
    v_mfma_f32_16x16x32_bf16 v[48:51], a[0:3], a[244:247], v[48:51]
    ds_read_b64_tr_b16 a[40:41], v194 offset:49152
    v_mfma_f32_16x16x32_bf16 v[52:55], a[4:7], a[244:247], v[52:55]
    ds_read_b64_tr_b16 a[42:43], v194 offset:53248
    v_mfma_f32_16x16x32_bf16 v[56:59], a[8:11], a[244:247], v[56:59]
    v_mfma_f32_16x16x32_bf16 v[60:63], a[12:15], a[244:247], v[60:63]
    ds_read_b64_tr_b16 a[44:45], v195 offset:49152
    v_mfma_f32_16x16x32_bf16 v[112:115], a[16:19], a[244:247], v[112:115]
    ds_read_b64_tr_b16 a[46:47], v195 offset:53248
    v_mfma_f32_16x16x32_bf16 v[116:119], a[20:23], a[244:247], v[116:119]
    buffer_load_dwordx4 v20, s[8:11], s33 offen offset:2048 lds
    v_mfma_f32_16x16x32_bf16 v[120:123], a[24:27], a[244:247], v[120:123]
    ds_read_b64_tr_b16 a[48:49], v196 offset:49152
    v_mfma_f32_16x16x32_bf16 v[124:127], a[28:31], a[244:247], v[124:127]
    ds_read_b64_tr_b16 a[50:51], v196 offset:53248
    v_mfma_f32_16x16x32_bf16 v[64:67], a[0:3], a[248:251], v[64:67]
    buffer_load_dwordx4 v21, s[8:11], s33 offen offset:3072 lds
    s_add_u32 s33, s33, s44
    v_mfma_f32_16x16x32_bf16 v[68:71], a[4:7], a[248:251], v[68:71]
    ds_read_b64_tr_b16 a[52:53], v197 offset:49152
    v_mfma_f32_16x16x32_bf16 v[72:75], a[8:11], a[248:251], v[72:75]
    ds_read_b64_tr_b16 a[54:55], v197 offset:53248
    v_mfma_f32_16x16x32_bf16 v[76:79], a[12:15], a[248:251], v[76:79]
    v_mfma_f32_16x16x32_bf16 v[128:131], a[16:19], a[248:251], v[128:131]
    ds_read_b64_tr_b16 a[56:57], v198 offset:49152
    v_mfma_f32_16x16x32_bf16 v[132:135], a[20:23], a[248:251], v[132:135]
    ds_read_b64_tr_b16 a[58:59], v198 offset:53248
    v_mfma_f32_16x16x32_bf16 v[136:139], a[24:27], a[248:251], v[136:139]
    buffer_load_dwordx4 v[232:235], v14, s[20:23], s34 offen sc1
    v_mfma_f32_16x16x32_bf16 v[140:143], a[28:31], a[248:251], v[140:143]
    ds_read_b64_tr_b16 a[60:61], v199 offset:49152
    v_mfma_f32_16x16x32_bf16 v[80:83], a[0:3], a[252:255], v[80:83]
    ds_read_b64_tr_b16 a[62:63], v199 offset:53248
    v_mfma_f32_16x16x32_bf16 v[84:87], a[4:7], a[252:255], v[84:87]
    v_mfma_f32_16x16x32_bf16 v[88:91], a[8:11], a[252:255], v[88:91]
    v_mfma_f32_16x16x32_bf16 v[92:95], a[12:15], a[252:255], v[92:95]
    buffer_load_dwordx4 v[236:239], v15, s[20:23], s34 offen sc1
    s_add_u32 s34, s34, s47
    v_mfma_f32_16x16x32_bf16 v[144:147], a[16:19], a[252:255], v[144:147]
    v_mfma_f32_16x16x32_bf16 v[148:151], a[20:23], a[252:255], v[148:151]
    v_mfma_f32_16x16x32_bf16 v[152:155], a[24:27], a[252:255], v[152:155]
    buffer_load_dwordx4 a[144:147], v12, s[20:23], s34 offen sc1
    v_mfma_f32_16x16x32_bf16 v[156:159], a[28:31], a[252:255], v[156:159]
    s_waitcnt vmcnt(49)
    s_waitcnt lgkmcnt(0)
    v_mfma_f32_16x16x32_bf16 v[32:35], a[32:35], a[224:227], v[32:35]
    s_barrier
    v_mfma_f32_16x16x32_bf16 v[36:39], a[36:39], a[224:227], v[36:39]
    v_mfma_f32_16x16x32_bf16 v[40:43], a[40:43], a[224:227], v[40:43]
    ds_read_b64_tr_b16 a[0:1], v200 offset:0
    v_mfma_f32_16x16x32_bf16 v[44:47], a[44:47], a[224:227], v[44:47]
    ds_read_b64_tr_b16 a[2:3], v200 offset:4096
    s_add_u32 m0, s32, 49152
    v_mfma_f32_16x16x32_bf16 v[96:99], a[48:51], a[224:227], v[96:99]
    buffer_load_dwordx4 v18, s[8:11], s33 offen offset:0 lds
    v_mfma_f32_16x16x32_bf16 v[100:103], a[52:55], a[224:227], v[100:103]
    ds_read_b64_tr_b16 a[4:5], v201 offset:0
    v_mfma_f32_16x16x32_bf16 v[104:107], a[56:59], a[224:227], v[104:107]
    ds_read_b64_tr_b16 a[6:7], v201 offset:4096
    v_mfma_f32_16x16x32_bf16 v[108:111], a[60:63], a[224:227], v[108:111]
    buffer_load_dwordx4 v19, s[8:11], s33 offen offset:1024 lds
    v_mfma_f32_16x16x32_bf16 v[48:51], a[32:35], a[228:231], v[48:51]
    ds_read_b64_tr_b16 a[8:9], v202 offset:0
    v_mfma_f32_16x16x32_bf16 v[52:55], a[36:39], a[228:231], v[52:55]
    ds_read_b64_tr_b16 a[10:11], v202 offset:4096
    v_mfma_f32_16x16x32_bf16 v[56:59], a[40:43], a[228:231], v[56:59]
    v_mfma_f32_16x16x32_bf16 v[60:63], a[44:47], a[228:231], v[60:63]
    ds_read_b64_tr_b16 a[12:13], v203 offset:0
    v_mfma_f32_16x16x32_bf16 v[112:115], a[48:51], a[228:231], v[112:115]
    ds_read_b64_tr_b16 a[14:15], v203 offset:4096
    v_mfma_f32_16x16x32_bf16 v[116:119], a[52:55], a[228:231], v[116:119]
    buffer_load_dwordx4 v20, s[8:11], s33 offen offset:2048 lds
    v_mfma_f32_16x16x32_bf16 v[120:123], a[56:59], a[228:231], v[120:123]
    ds_read_b64_tr_b16 a[16:17], v204 offset:0
    v_mfma_f32_16x16x32_bf16 v[124:127], a[60:63], a[228:231], v[124:127]
    ds_read_b64_tr_b16 a[18:19], v204 offset:4096
    v_mfma_f32_16x16x32_bf16 v[64:67], a[32:35], a[232:235], v[64:67]
    buffer_load_dwordx4 v21, s[8:11], s33 offen offset:3072 lds
    s_add_u32 s33, s33, s45
    v_mfma_f32_16x16x32_bf16 v[68:71], a[36:39], a[232:235], v[68:71]
    ds_read_b64_tr_b16 a[20:21], v205 offset:0
    v_mfma_f32_16x16x32_bf16 v[72:75], a[40:43], a[232:235], v[72:75]
    ds_read_b64_tr_b16 a[22:23], v205 offset:4096
    v_mfma_f32_16x16x32_bf16 v[76:79], a[44:47], a[232:235], v[76:79]
    v_mfma_f32_16x16x32_bf16 v[128:131], a[48:51], a[232:235], v[128:131]
    ds_read_b64_tr_b16 a[24:25], v206 offset:0
    v_mfma_f32_16x16x32_bf16 v[132:135], a[52:55], a[232:235], v[132:135]
    ds_read_b64_tr_b16 a[26:27], v206 offset:4096
    v_mfma_f32_16x16x32_bf16 v[136:139], a[56:59], a[232:235], v[136:139]
    buffer_load_dwordx4 a[148:151], v13, s[20:23], s34 offen sc1
    v_mfma_f32_16x16x32_bf16 v[140:143], a[60:63], a[232:235], v[140:143]
    ds_read_b64_tr_b16 a[28:29], v207 offset:0
    v_mfma_f32_16x16x32_bf16 v[80:83], a[32:35], a[236:239], v[80:83]
    ds_read_b64_tr_b16 a[30:31], v207 offset:4096
    v_mfma_f32_16x16x32_bf16 v[84:87], a[36:39], a[236:239], v[84:87]
    v_mfma_f32_16x16x32_bf16 v[88:91], a[40:43], a[236:239], v[88:91]
    v_mfma_f32_16x16x32_bf16 v[92:95], a[44:47], a[236:239], v[92:95]
    buffer_load_dwordx4 a[152:155], v14, s[20:23], s34 offen sc1
    v_mfma_f32_16x16x32_bf16 v[144:147], a[48:51], a[236:239], v[144:147]
    v_mfma_f32_16x16x32_bf16 v[148:151], a[52:55], a[236:239], v[148:151]
    v_mfma_f32_16x16x32_bf16 v[152:155], a[56:59], a[236:239], v[152:155]
    buffer_load_dwordx4 a[156:159], v15, s[20:23], s34 offen sc1
    s_add_u32 s34, s34, s46
    v_mfma_f32_16x16x32_bf16 v[156:159], a[60:63], a[236:239], v[156:159]
    s_waitcnt vmcnt(52)
    s_waitcnt lgkmcnt(0)
    v_mfma_f32_16x16x32_bf16 v[32:35], a[0:3], a[208:211], v[32:35]
    s_barrier
    v_mfma_f32_16x16x32_bf16 v[36:39], a[4:7], a[208:211], v[36:39]
    v_mfma_f32_16x16x32_bf16 v[40:43], a[8:11], a[208:211], v[40:43]
    ds_read_b64_tr_b16 a[32:33], v200 offset:16384
    v_mfma_f32_16x16x32_bf16 v[44:47], a[12:15], a[208:211], v[44:47]
    ds_read_b64_tr_b16 a[34:35], v200 offset:20480
    s_add_u32 m0, s32, 65536
    v_mfma_f32_16x16x32_bf16 v[96:99], a[16:19], a[208:211], v[96:99]
    buffer_load_dwordx4 v18, s[8:11], s33 offen offset:0 lds
    v_mfma_f32_16x16x32_bf16 v[100:103], a[20:23], a[208:211], v[100:103]
    ds_read_b64_tr_b16 a[36:37], v201 offset:16384
    v_mfma_f32_16x16x32_bf16 v[104:107], a[24:27], a[208:211], v[104:107]
    ds_read_b64_tr_b16 a[38:39], v201 offset:20480
    v_mfma_f32_16x16x32_bf16 v[108:111], a[28:31], a[208:211], v[108:111]
    buffer_load_dwordx4 v19, s[8:11], s33 offen offset:1024 lds
    v_mfma_f32_16x16x32_bf16 v[48:51], a[0:3], a[212:215], v[48:51]
    ds_read_b64_tr_b16 a[40:41], v202 offset:16384
    v_mfma_f32_16x16x32_bf16 v[52:55], a[4:7], a[212:215], v[52:55]
    ds_read_b64_tr_b16 a[42:43], v202 offset:20480
    v_mfma_f32_16x16x32_bf16 v[56:59], a[8:11], a[212:215], v[56:59]
    v_mfma_f32_16x16x32_bf16 v[60:63], a[12:15], a[212:215], v[60:63]
    ds_read_b64_tr_b16 a[44:45], v203 offset:16384
    v_mfma_f32_16x16x32_bf16 v[112:115], a[16:19], a[212:215], v[112:115]
    ds_read_b64_tr_b16 a[46:47], v203 offset:20480
    v_mfma_f32_16x16x32_bf16 v[116:119], a[20:23], a[212:215], v[116:119]
    buffer_load_dwordx4 v20, s[8:11], s33 offen offset:2048 lds
    v_mfma_f32_16x16x32_bf16 v[120:123], a[24:27], a[212:215], v[120:123]
    ds_read_b64_tr_b16 a[48:49], v204 offset:16384
    v_mfma_f32_16x16x32_bf16 v[124:127], a[28:31], a[212:215], v[124:127]
    ds_read_b64_tr_b16 a[50:51], v204 offset:20480
    v_mfma_f32_16x16x32_bf16 v[64:67], a[0:3], a[216:219], v[64:67]
    buffer_load_dwordx4 v21, s[8:11], s33 offen offset:3072 lds
    s_add_u32 s33, s33, s44
    v_mfma_f32_16x16x32_bf16 v[68:71], a[4:7], a[216:219], v[68:71]
    ds_read_b64_tr_b16 a[52:53], v205 offset:16384
    v_mfma_f32_16x16x32_bf16 v[72:75], a[8:11], a[216:219], v[72:75]
    ds_read_b64_tr_b16 a[54:55], v205 offset:20480
    v_mfma_f32_16x16x32_bf16 v[76:79], a[12:15], a[216:219], v[76:79]
    v_mfma_f32_16x16x32_bf16 v[128:131], a[16:19], a[216:219], v[128:131]
    ds_read_b64_tr_b16 a[56:57], v206 offset:16384
    v_mfma_f32_16x16x32_bf16 v[132:135], a[20:23], a[216:219], v[132:135]
    ds_read_b64_tr_b16 a[58:59], v206 offset:20480
    v_mfma_f32_16x16x32_bf16 v[136:139], a[24:27], a[216:219], v[136:139]
    buffer_load_dwordx4 a[240:243], v12, s[20:23], s34 offen sc1
    v_mfma_f32_16x16x32_bf16 v[140:143], a[28:31], a[216:219], v[140:143]
    ds_read_b64_tr_b16 a[60:61], v207 offset:16384
    v_mfma_f32_16x16x32_bf16 v[80:83], a[0:3], a[220:223], v[80:83]
    ds_read_b64_tr_b16 a[62:63], v207 offset:20480
    v_mfma_f32_16x16x32_bf16 v[84:87], a[4:7], a[220:223], v[84:87]
    v_mfma_f32_16x16x32_bf16 v[88:91], a[8:11], a[220:223], v[88:91]
    v_mfma_f32_16x16x32_bf16 v[92:95], a[12:15], a[220:223], v[92:95]
    buffer_load_dwordx4 a[244:247], v13, s[20:23], s34 offen sc1
    v_mfma_f32_16x16x32_bf16 v[144:147], a[16:19], a[220:223], v[144:147]
    v_mfma_f32_16x16x32_bf16 v[148:151], a[20:23], a[220:223], v[148:151]
    v_mfma_f32_16x16x32_bf16 v[152:155], a[24:27], a[220:223], v[152:155]
    buffer_load_dwordx4 a[248:251], v14, s[20:23], s34 offen sc1
    v_mfma_f32_16x16x32_bf16 v[156:159], a[28:31], a[220:223], v[156:159]
    s_waitcnt vmcnt(55)
    s_waitcnt lgkmcnt(0)
    v_mfma_f32_16x16x32_bf16 v[32:35], a[32:35], a[192:195], v[32:35]
    s_barrier
    v_mfma_f32_16x16x32_bf16 v[36:39], a[36:39], a[192:195], v[36:39]
    v_mfma_f32_16x16x32_bf16 v[40:43], a[40:43], a[192:195], v[40:43]
    ds_read_b64_tr_b16 a[0:1], v200 offset:32768
    v_mfma_f32_16x16x32_bf16 v[44:47], a[44:47], a[192:195], v[44:47]
    ds_read_b64_tr_b16 a[2:3], v200 offset:36864
    s_add_u32 m0, s32, 81920
    v_mfma_f32_16x16x32_bf16 v[96:99], a[48:51], a[192:195], v[96:99]
    buffer_load_dwordx4 v18, s[8:11], s33 offen offset:0 lds
    v_mfma_f32_16x16x32_bf16 v[100:103], a[52:55], a[192:195], v[100:103]
    ds_read_b64_tr_b16 a[4:5], v201 offset:32768
    v_mfma_f32_16x16x32_bf16 v[104:107], a[56:59], a[192:195], v[104:107]
    ds_read_b64_tr_b16 a[6:7], v201 offset:36864
    v_mfma_f32_16x16x32_bf16 v[108:111], a[60:63], a[192:195], v[108:111]
    buffer_load_dwordx4 v19, s[8:11], s33 offen offset:1024 lds
    v_mfma_f32_16x16x32_bf16 v[48:51], a[32:35], a[196:199], v[48:51]
    ds_read_b64_tr_b16 a[8:9], v202 offset:32768
    v_mfma_f32_16x16x32_bf16 v[52:55], a[36:39], a[196:199], v[52:55]
    ds_read_b64_tr_b16 a[10:11], v202 offset:36864
    v_mfma_f32_16x16x32_bf16 v[56:59], a[40:43], a[196:199], v[56:59]
    v_mfma_f32_16x16x32_bf16 v[60:63], a[44:47], a[196:199], v[60:63]
    ds_read_b64_tr_b16 a[12:13], v203 offset:32768
    v_mfma_f32_16x16x32_bf16 v[112:115], a[48:51], a[196:199], v[112:115]
    ds_read_b64_tr_b16 a[14:15], v203 offset:36864
    v_mfma_f32_16x16x32_bf16 v[116:119], a[52:55], a[196:199], v[116:119]
    buffer_load_dwordx4 v20, s[8:11], s33 offen offset:2048 lds
    v_mfma_f32_16x16x32_bf16 v[120:123], a[56:59], a[196:199], v[120:123]
    ds_read_b64_tr_b16 a[16:17], v204 offset:32768
    v_mfma_f32_16x16x32_bf16 v[124:127], a[60:63], a[196:199], v[124:127]
    ds_read_b64_tr_b16 a[18:19], v204 offset:36864
    v_mfma_f32_16x16x32_bf16 v[64:67], a[32:35], a[200:203], v[64:67]
    buffer_load_dwordx4 v21, s[8:11], s33 offen offset:3072 lds
    s_add_u32 s33, s33, s45
    v_mfma_f32_16x16x32_bf16 v[68:71], a[36:39], a[200:203], v[68:71]
    ds_read_b64_tr_b16 a[20:21], v205 offset:32768
    v_mfma_f32_16x16x32_bf16 v[72:75], a[40:43], a[200:203], v[72:75]
    ds_read_b64_tr_b16 a[22:23], v205 offset:36864
    v_mfma_f32_16x16x32_bf16 v[76:79], a[44:47], a[200:203], v[76:79]
    v_mfma_f32_16x16x32_bf16 v[128:131], a[48:51], a[200:203], v[128:131]
    ds_read_b64_tr_b16 a[24:25], v206 offset:32768
    v_mfma_f32_16x16x32_bf16 v[132:135], a[52:55], a[200:203], v[132:135]
    ds_read_b64_tr_b16 a[26:27], v206 offset:36864
    v_mfma_f32_16x16x32_bf16 v[136:139], a[56:59], a[200:203], v[136:139]
    buffer_load_dwordx4 a[252:255], v15, s[20:23], s34 offen sc1
    s_add_u32 s34, s34, s47
    v_mfma_f32_16x16x32_bf16 v[140:143], a[60:63], a[200:203], v[140:143]
    ds_read_b64_tr_b16 a[28:29], v207 offset:32768
    v_mfma_f32_16x16x32_bf16 v[80:83], a[32:35], a[204:207], v[80:83]
    ds_read_b64_tr_b16 a[30:31], v207 offset:36864
    v_mfma_f32_16x16x32_bf16 v[84:87], a[36:39], a[204:207], v[84:87]
    v_mfma_f32_16x16x32_bf16 v[88:91], a[40:43], a[204:207], v[88:91]
    v_mfma_f32_16x16x32_bf16 v[92:95], a[44:47], a[204:207], v[92:95]
    buffer_load_dwordx4 a[224:227], v12, s[20:23], s34 offen sc1
    v_mfma_f32_16x16x32_bf16 v[144:147], a[48:51], a[204:207], v[144:147]
    v_mfma_f32_16x16x32_bf16 v[148:151], a[52:55], a[204:207], v[148:151]
    v_mfma_f32_16x16x32_bf16 v[152:155], a[56:59], a[204:207], v[152:155]
    buffer_load_dwordx4 a[228:231], v13, s[20:23], s34 offen sc1
    v_mfma_f32_16x16x32_bf16 v[156:159], a[60:63], a[204:207], v[156:159]
    s_waitcnt vmcnt(58)
    s_waitcnt lgkmcnt(0)
    v_mfma_f32_16x16x32_bf16 v[32:35], a[0:3], a[176:179], v[32:35]
    s_waitcnt vmcnt(45)
    s_barrier
    v_mfma_f32_16x16x32_bf16 v[36:39], a[4:7], a[176:179], v[36:39]
    v_mfma_f32_16x16x32_bf16 v[40:43], a[8:11], a[176:179], v[40:43]
    ds_read_b64_tr_b16 a[32:33], v200 offset:49152
    v_mfma_f32_16x16x32_bf16 v[44:47], a[12:15], a[176:179], v[44:47]
    ds_read_b64_tr_b16 a[34:35], v200 offset:53248
    s_add_u32 m0, s32, 98304
    v_mfma_f32_16x16x32_bf16 v[96:99], a[16:19], a[176:179], v[96:99]
    buffer_load_dwordx4 v18, s[8:11], s33 offen offset:0 lds
    v_mfma_f32_16x16x32_bf16 v[100:103], a[20:23], a[176:179], v[100:103]
    ds_read_b64_tr_b16 a[36:37], v201 offset:49152
    v_mfma_f32_16x16x32_bf16 v[104:107], a[24:27], a[176:179], v[104:107]
    ds_read_b64_tr_b16 a[38:39], v201 offset:53248
    v_mfma_f32_16x16x32_bf16 v[108:111], a[28:31], a[176:179], v[108:111]
    buffer_load_dwordx4 v19, s[8:11], s33 offen offset:1024 lds
    v_mfma_f32_16x16x32_bf16 v[48:51], a[0:3], a[180:183], v[48:51]
    ds_read_b64_tr_b16 a[40:41], v202 offset:49152
    v_mfma_f32_16x16x32_bf16 v[52:55], a[4:7], a[180:183], v[52:55]
    ds_read_b64_tr_b16 a[42:43], v202 offset:53248
    v_mfma_f32_16x16x32_bf16 v[56:59], a[8:11], a[180:183], v[56:59]
    v_mfma_f32_16x16x32_bf16 v[60:63], a[12:15], a[180:183], v[60:63]
    ds_read_b64_tr_b16 a[44:45], v203 offset:49152
    v_mfma_f32_16x16x32_bf16 v[112:115], a[16:19], a[180:183], v[112:115]
    ds_read_b64_tr_b16 a[46:47], v203 offset:53248
    v_mfma_f32_16x16x32_bf16 v[116:119], a[20:23], a[180:183], v[116:119]
    buffer_load_dwordx4 v20, s[8:11], s33 offen offset:2048 lds
    v_mfma_f32_16x16x32_bf16 v[120:123], a[24:27], a[180:183], v[120:123]
    ds_read_b64_tr_b16 a[48:49], v204 offset:49152
    v_mfma_f32_16x16x32_bf16 v[124:127], a[28:31], a[180:183], v[124:127]
    ds_read_b64_tr_b16 a[50:51], v204 offset:53248
    v_mfma_f32_16x16x32_bf16 v[64:67], a[0:3], a[184:187], v[64:67]
    buffer_load_dwordx4 v21, s[8:11], s33 offen offset:3072 lds
    s_add_u32 s33, s33, s44
    v_mfma_f32_16x16x32_bf16 v[68:71], a[4:7], a[184:187], v[68:71]
    ds_read_b64_tr_b16 a[52:53], v205 offset:49152
    v_mfma_f32_16x16x32_bf16 v[72:75], a[8:11], a[184:187], v[72:75]
    ds_read_b64_tr_b16 a[54:55], v205 offset:53248
    v_mfma_f32_16x16x32_bf16 v[76:79], a[12:15], a[184:187], v[76:79]
    v_mfma_f32_16x16x32_bf16 v[128:131], a[16:19], a[184:187], v[128:131]
    ds_read_b64_tr_b16 a[56:57], v206 offset:49152
    v_mfma_f32_16x16x32_bf16 v[132:135], a[20:23], a[184:187], v[132:135]
    ds_read_b64_tr_b16 a[58:59], v206 offset:53248
    v_mfma_f32_16x16x32_bf16 v[136:139], a[24:27], a[184:187], v[136:139]
    buffer_load_dwordx4 a[232:235], v14, s[20:23], s34 offen sc1
    v_mfma_f32_16x16x32_bf16 v[140:143], a[28:31], a[184:187], v[140:143]
    ds_read_b64_tr_b16 a[60:61], v207 offset:49152
    v_mfma_f32_16x16x32_bf16 v[80:83], a[0:3], a[188:191], v[80:83]
    ds_read_b64_tr_b16 a[62:63], v207 offset:53248
    v_mfma_f32_16x16x32_bf16 v[84:87], a[4:7], a[188:191], v[84:87]
    v_mfma_f32_16x16x32_bf16 v[88:91], a[8:11], a[188:191], v[88:91]
    v_mfma_f32_16x16x32_bf16 v[92:95], a[12:15], a[188:191], v[92:95]
    buffer_load_dwordx4 a[236:239], v15, s[20:23], s34 offen sc1
    s_add_u32 s34, s34, s46
    v_mfma_f32_16x16x32_bf16 v[144:147], a[16:19], a[188:191], v[144:147]
    v_mfma_f32_16x16x32_bf16 v[148:151], a[20:23], a[188:191], v[148:151]
    v_mfma_f32_16x16x32_bf16 v[152:155], a[24:27], a[188:191], v[152:155]
    buffer_load_dwordx4 a[208:211], v12, s[20:23], s34 offen sc1
    v_mfma_f32_16x16x32_bf16 v[156:159], a[28:31], a[188:191], v[156:159]
    s_waitcnt vmcnt(61)
    s_waitcnt lgkmcnt(0)
    v_mfma_f32_16x16x32_bf16 v[32:35], a[32:35], a[128:131], v[32:35]
    s_waitcnt vmcnt(45)
    s_barrier
    v_mfma_f32_16x16x32_bf16 v[36:39], a[36:39], a[128:131], v[36:39]
    v_mfma_f32_16x16x32_bf16 v[40:43], a[40:43], a[128:131], v[40:43]
    ds_read_b64_tr_b16 a[0:1], v192 offset:0
    v_mfma_f32_16x16x32_bf16 v[44:47], a[44:47], a[128:131], v[44:47]
    ds_read_b64_tr_b16 a[2:3], v192 offset:4096
    s_add_u32 m0, s32, 114688
    v_mfma_f32_16x16x32_bf16 v[96:99], a[48:51], a[128:131], v[96:99]
    buffer_load_dwordx4 v18, s[8:11], s33 offen offset:0 lds
    v_mfma_f32_16x16x32_bf16 v[100:103], a[52:55], a[128:131], v[100:103]
    ds_read_b64_tr_b16 a[4:5], v193 offset:0
    v_mfma_f32_16x16x32_bf16 v[104:107], a[56:59], a[128:131], v[104:107]
    ds_read_b64_tr_b16 a[6:7], v193 offset:4096
    v_mfma_f32_16x16x32_bf16 v[108:111], a[60:63], a[128:131], v[108:111]
    buffer_load_dwordx4 v19, s[8:11], s33 offen offset:1024 lds
    v_mfma_f32_16x16x32_bf16 v[48:51], a[32:35], a[132:135], v[48:51]
    ds_read_b64_tr_b16 a[8:9], v194 offset:0
    v_mfma_f32_16x16x32_bf16 v[52:55], a[36:39], a[132:135], v[52:55]
    ds_read_b64_tr_b16 a[10:11], v194 offset:4096
    v_mfma_f32_16x16x32_bf16 v[56:59], a[40:43], a[132:135], v[56:59]
    v_mfma_f32_16x16x32_bf16 v[60:63], a[44:47], a[132:135], v[60:63]
    ds_read_b64_tr_b16 a[12:13], v195 offset:0
    v_mfma_f32_16x16x32_bf16 v[112:115], a[48:51], a[132:135], v[112:115]
    ds_read_b64_tr_b16 a[14:15], v195 offset:4096
    v_mfma_f32_16x16x32_bf16 v[116:119], a[52:55], a[132:135], v[116:119]
    buffer_load_dwordx4 v20, s[8:11], s33 offen offset:2048 lds
    v_mfma_f32_16x16x32_bf16 v[120:123], a[56:59], a[132:135], v[120:123]
    ds_read_b64_tr_b16 a[16:17], v196 offset:0
    v_mfma_f32_16x16x32_bf16 v[124:127], a[60:63], a[132:135], v[124:127]
    ds_read_b64_tr_b16 a[18:19], v196 offset:4096
    v_mfma_f32_16x16x32_bf16 v[64:67], a[32:35], a[136:139], v[64:67]
    buffer_load_dwordx4 v21, s[8:11], s33 offen offset:3072 lds
    s_add_u32 s33, s33, s45
    v_mfma_f32_16x16x32_bf16 v[68:71], a[36:39], a[136:139], v[68:71]
    ds_read_b64_tr_b16 a[20:21], v197 offset:0
    v_mfma_f32_16x16x32_bf16 v[72:75], a[40:43], a[136:139], v[72:75]
    ds_read_b64_tr_b16 a[22:23], v197 offset:4096
    v_mfma_f32_16x16x32_bf16 v[76:79], a[44:47], a[136:139], v[76:79]
    v_mfma_f32_16x16x32_bf16 v[128:131], a[48:51], a[136:139], v[128:131]
    ds_read_b64_tr_b16 a[24:25], v198 offset:0
    v_mfma_f32_16x16x32_bf16 v[132:135], a[52:55], a[136:139], v[132:135]
    ds_read_b64_tr_b16 a[26:27], v198 offset:4096
    v_mfma_f32_16x16x32_bf16 v[136:139], a[56:59], a[136:139], v[136:139]
    buffer_load_dwordx4 a[212:215], v13, s[20:23], s34 offen sc1
    v_mfma_f32_16x16x32_bf16 v[140:143], a[60:63], a[136:139], v[140:143]
    ds_read_b64_tr_b16 a[28:29], v199 offset:0
    v_mfma_f32_16x16x32_bf16 v[80:83], a[32:35], a[140:143], v[80:83]
    ds_read_b64_tr_b16 a[30:31], v199 offset:4096
    v_mfma_f32_16x16x32_bf16 v[84:87], a[36:39], a[140:143], v[84:87]
    v_mfma_f32_16x16x32_bf16 v[88:91], a[40:43], a[140:143], v[88:91]
    v_mfma_f32_16x16x32_bf16 v[92:95], a[44:47], a[140:143], v[92:95]
    buffer_load_dwordx4 a[216:219], v14, s[20:23], s34 offen sc1
    v_mfma_f32_16x16x32_bf16 v[144:147], a[48:51], a[140:143], v[144:147]
    v_mfma_f32_16x16x32_bf16 v[148:151], a[52:55], a[140:143], v[148:151]
    v_mfma_f32_16x16x32_bf16 v[152:155], a[56:59], a[140:143], v[152:155]
    buffer_load_dwordx4 a[220:223], v15, s[20:23], s34 offen sc1
    s_add_u32 s34, s34, s47
    v_mfma_f32_16x16x32_bf16 v[156:159], a[60:63], a[140:143], v[156:159]
    s_waitcnt vmcnt(63)
    s_waitcnt lgkmcnt(0)
    v_mfma_f32_16x16x32_bf16 v[32:35], a[0:3], v[160:163], v[32:35]
    s_waitcnt vmcnt(45)
    s_barrier
    v_mfma_f32_16x16x32_bf16 v[36:39], a[4:7], v[160:163], v[36:39]
    s_lshl_b32 s36, s2, 2
    v_mfma_f32_16x16x32_bf16 v[40:43], a[8:11], v[160:163], v[40:43]
    ds_read_b64_tr_b16 a[32:33], v192 offset:16384
    v_mfma_f32_16x16x32_bf16 v[44:47], a[12:15], v[160:163], v[44:47]
    ds_read_b64_tr_b16 a[34:35], v192 offset:20480
    s_add_u32 m0, s32, 0
    v_mfma_f32_16x16x32_bf16 v[96:99], a[16:19], v[160:163], v[96:99]
    buffer_load_dwordx4 v18, s[8:11], s33 offen offset:0 lds
    v_mfma_f32_16x16x32_bf16 v[100:103], a[20:23], v[160:163], v[100:103]
    ds_read_b64_tr_b16 a[36:37], v193 offset:16384
    v_mfma_f32_16x16x32_bf16 v[104:107], a[24:27], v[160:163], v[104:107]
    ds_read_b64_tr_b16 a[38:39], v193 offset:20480
    v_mfma_f32_16x16x32_bf16 v[108:111], a[28:31], v[160:163], v[108:111]
    buffer_load_dwordx4 v19, s[8:11], s33 offen offset:1024 lds
    v_mfma_f32_16x16x32_bf16 v[48:51], a[0:3], v[164:167], v[48:51]
    ds_read_b64_tr_b16 a[40:41], v194 offset:16384
    v_mfma_f32_16x16x32_bf16 v[52:55], a[4:7], v[164:167], v[52:55]
    ds_read_b64_tr_b16 a[42:43], v194 offset:20480
    v_mfma_f32_16x16x32_bf16 v[56:59], a[8:11], v[164:167], v[56:59]
    s_add_u32 s36, s36, s24
    v_mfma_f32_16x16x32_bf16 v[60:63], a[12:15], v[164:167], v[60:63]
    ds_read_b64_tr_b16 a[44:45], v195 offset:16384
    v_mfma_f32_16x16x32_bf16 v[112:115], a[16:19], v[164:167], v[112:115]
    ds_read_b64_tr_b16 a[46:47], v195 offset:20480
    v_mfma_f32_16x16x32_bf16 v[116:119], a[20:23], v[164:167], v[116:119]
    buffer_load_dwordx4 v20, s[8:11], s33 offen offset:2048 lds
    v_mfma_f32_16x16x32_bf16 v[120:123], a[24:27], v[164:167], v[120:123]
    ds_read_b64_tr_b16 a[48:49], v196 offset:16384
    v_mfma_f32_16x16x32_bf16 v[124:127], a[28:31], v[164:167], v[124:127]
    ds_read_b64_tr_b16 a[50:51], v196 offset:20480
    v_mfma_f32_16x16x32_bf16 v[64:67], a[0:3], v[168:171], v[64:67]
    buffer_load_dwordx4 v21, s[8:11], s33 offen offset:3072 lds
    s_add_u32 s33, s33, s44
    v_mfma_f32_16x16x32_bf16 v[68:71], a[4:7], v[168:171], v[68:71]
    ds_read_b64_tr_b16 a[52:53], v197 offset:16384
    v_mfma_f32_16x16x32_bf16 v[72:75], a[8:11], v[168:171], v[72:75]
    ds_read_b64_tr_b16 a[54:55], v197 offset:20480
    v_mfma_f32_16x16x32_bf16 v[76:79], a[12:15], v[168:171], v[76:79]
    s_lshl_b32 s37, s36, 5
    v_mfma_f32_16x16x32_bf16 v[128:131], a[16:19], v[168:171], v[128:131]
    ds_read_b64_tr_b16 a[56:57], v198 offset:16384
    v_mfma_f32_16x16x32_bf16 v[132:135], a[20:23], v[168:171], v[132:135]
    ds_read_b64_tr_b16 a[58:59], v198 offset:20480
    v_mfma_f32_16x16x32_bf16 v[136:139], a[24:27], v[168:171], v[136:139]
    buffer_load_dwordx4 a[192:195], v12, s[20:23], s34 offen sc1
    v_mfma_f32_16x16x32_bf16 v[140:143], a[28:31], v[168:171], v[140:143]
    ds_read_b64_tr_b16 a[60:61], v199 offset:16384
    v_mfma_f32_16x16x32_bf16 v[80:83], a[0:3], v[172:175], v[80:83]
    ds_read_b64_tr_b16 a[62:63], v199 offset:20480
    v_mfma_f32_16x16x32_bf16 v[84:87], a[4:7], v[172:175], v[84:87]
    v_mov_b32 v8, s37
    v_mfma_f32_16x16x32_bf16 v[88:91], a[8:11], v[172:175], v[88:91]
    s_xor_b32 s37, s37, 512
    v_mfma_f32_16x16x32_bf16 v[92:95], a[12:15], v[172:175], v[92:95]
    buffer_load_dwordx4 a[196:199], v13, s[20:23], s34 offen sc1
    v_mfma_f32_16x16x32_bf16 v[144:147], a[16:19], v[172:175], v[144:147]
    v_mov_b32 v9, s37
    v_mfma_f32_16x16x32_bf16 v[148:151], a[20:23], v[172:175], v[148:151]
    s_lshl_b32 s100, s36, 13
    v_mfma_f32_16x16x32_bf16 v[152:155], a[24:27], v[172:175], v[152:155]
    buffer_load_dwordx4 a[200:203], v14, s[20:23], s34 offen sc1
    v_mfma_f32_16x16x32_bf16 v[156:159], a[28:31], v[172:175], v[156:159]
    s_xor_b32 s101, s100, 131072
    s_waitcnt vmcnt(63)
    s_waitcnt lgkmcnt(0)
    v_mfma_f32_16x16x32_bf16 v[32:35], a[32:35], a[160:163], v[32:35]
    s_waitcnt vmcnt(45)
    s_barrier
    v_mfma_f32_16x16x32_bf16 v[36:39], a[36:39], a[160:163], v[36:39]
    s_lshl_b32 s36, s24, 13
    v_mfma_f32_16x16x32_bf16 v[40:43], a[40:43], a[160:163], v[40:43]
    ds_read_b64_tr_b16 a[0:1], v192 offset:32768
    v_mfma_f32_16x16x32_bf16 v[44:47], a[44:47], a[160:163], v[44:47]
    ds_read_b64_tr_b16 a[2:3], v192 offset:36864
    s_add_u32 m0, s32, 16384
    v_mfma_f32_16x16x32_bf16 v[96:99], a[48:51], a[160:163], v[96:99]
    buffer_load_dwordx4 v18, s[8:11], s33 offen offset:0 lds
    v_mfma_f32_16x16x32_bf16 v[100:103], a[52:55], a[160:163], v[100:103]
    ds_read_b64_tr_b16 a[4:5], v193 offset:32768
    v_mfma_f32_16x16x32_bf16 v[104:107], a[56:59], a[160:163], v[104:107]
    ds_read_b64_tr_b16 a[6:7], v193 offset:36864
    v_mfma_f32_16x16x32_bf16 v[108:111], a[60:63], a[160:163], v[108:111]
    buffer_load_dwordx4 v19, s[8:11], s33 offen offset:1024 lds
    v_mfma_f32_16x16x32_bf16 v[48:51], a[32:35], a[164:167], v[48:51]
    ds_read_b64_tr_b16 a[8:9], v194 offset:32768
    v_mfma_f32_16x16x32_bf16 v[52:55], a[36:39], a[164:167], v[52:55]
    ds_read_b64_tr_b16 a[10:11], v194 offset:36864
    v_mfma_f32_16x16x32_bf16 v[56:59], a[40:43], a[164:167], v[56:59]
    s_add_u32 s36, s36, 131072
    v_mfma_f32_16x16x32_bf16 v[60:63], a[44:47], a[164:167], v[60:63]
    ds_read_b64_tr_b16 a[12:13], v195 offset:32768
    v_mfma_f32_16x16x32_bf16 v[112:115], a[48:51], a[164:167], v[112:115]
    ds_read_b64_tr_b16 a[14:15], v195 offset:36864
    v_mfma_f32_16x16x32_bf16 v[116:119], a[52:55], a[164:167], v[116:119]
    buffer_load_dwordx4 v20, s[8:11], s33 offen offset:2048 lds
    v_mfma_f32_16x16x32_bf16 v[120:123], a[56:59], a[164:167], v[120:123]
    ds_read_b64_tr_b16 a[16:17], v196 offset:32768
    v_mfma_f32_16x16x32_bf16 v[124:127], a[60:63], a[164:167], v[124:127]
    ds_read_b64_tr_b16 a[18:19], v196 offset:36864
    v_mfma_f32_16x16x32_bf16 v[64:67], a[32:35], a[168:171], v[64:67]
    buffer_load_dwordx4 v21, s[8:11], s33 offen offset:3072 lds
    s_add_u32 s33, s33, s45
    v_mfma_f32_16x16x32_bf16 v[68:71], a[36:39], a[168:171], v[68:71]
    ds_read_b64_tr_b16 a[20:21], v197 offset:32768
    v_mfma_f32_16x16x32_bf16 v[72:75], a[40:43], a[168:171], v[72:75]
    ds_read_b64_tr_b16 a[22:23], v197 offset:36864
    v_mfma_f32_16x16x32_bf16 v[76:79], a[44:47], a[168:171], v[76:79]
    v_add_u32 v6, s36, v1
    v_mfma_f32_16x16x32_bf16 v[128:131], a[48:51], a[168:171], v[128:131]
    ds_read_b64_tr_b16 a[24:25], v198 offset:32768
    v_mfma_f32_16x16x32_bf16 v[132:135], a[52:55], a[168:171], v[132:135]
    ds_read_b64_tr_b16 a[26:27], v198 offset:36864
    v_mfma_f32_16x16x32_bf16 v[136:139], a[56:59], a[168:171], v[136:139]
    buffer_load_dwordx4 a[204:207], v15, s[20:23], s34 offen sc1
    s_add_u32 s34, s34, s46
    v_mfma_f32_16x16x32_bf16 v[140:143], a[60:63], a[168:171], v[140:143]
    ds_read_b64_tr_b16 a[28:29], v199 offset:32768
    v_mfma_f32_16x16x32_bf16 v[80:83], a[32:35], a[172:175], v[80:83]
    ds_read_b64_tr_b16 a[30:31], v199 offset:36864
    v_mfma_f32_16x16x32_bf16 v[84:87], a[36:39], a[172:175], v[84:87]
    v_xor_b32 v7, 16384, v6
    v_mfma_f32_16x16x32_bf16 v[88:91], a[40:43], a[172:175], v[88:91]
    s_lshl_b32 s35, s28, 1
    v_mfma_f32_16x16x32_bf16 v[92:95], a[44:47], a[172:175], v[92:95]
    buffer_load_dwordx4 a[176:179], v12, s[20:23], s34 offen sc1
    v_mfma_f32_16x16x32_bf16 v[144:147], a[48:51], a[172:175], v[144:147]
    s_add_u32 s35, s35, s29
    v_mfma_f32_16x16x32_bf16 v[148:151], a[52:55], a[172:175], v[148:151]
    s_lshl_b32 s36, s35, 8
    v_mfma_f32_16x16x32_bf16 v[152:155], a[56:59], a[172:175], v[152:155]
    buffer_load_dwordx4 a[180:183], v13, s[20:23], s34 offen sc1
    v_mfma_f32_16x16x32_bf16 v[156:159], a[60:63], a[172:175], v[156:159]
    s_add_u32 s36, s36, 32768
    s_waitcnt vmcnt(58)
    s_waitcnt lgkmcnt(0)
    v_mfma_f32_16x16x32_bf16 v[32:35], a[0:3], v[208:211], v[32:35]
    s_waitcnt vmcnt(45)
    s_barrier
    v_mfma_f32_16x16x32_bf16 v[36:39], a[4:7], v[208:211], v[36:39]
    v_mov_b32 v23, s36
    v_mfma_f32_16x16x32_bf16 v[40:43], a[8:11], v[208:211], v[40:43]
    ds_read_b64_tr_b16 a[32:33], v192 offset:49152
    v_mfma_f32_16x16x32_bf16 v[44:47], a[12:15], v[208:211], v[44:47]
    ds_read_b64_tr_b16 a[34:35], v192 offset:53248
    v_mfma_f32_16x16x32_bf16 v[96:99], a[16:19], v[208:211], v[96:99]
    buffer_load_dwordx4 a[184:187], v14, s[20:23], s34 offen sc1
    v_mfma_f32_16x16x32_bf16 v[100:103], a[20:23], v[208:211], v[100:103]
    ds_read_b64_tr_b16 a[36:37], v193 offset:49152
    v_mfma_f32_16x16x32_bf16 v[104:107], a[24:27], v[208:211], v[104:107]
    ds_read_b64_tr_b16 a[38:39], v193 offset:53248
    v_mfma_f32_16x16x32_bf16 v[108:111], a[28:31], v[208:211], v[108:111]
    buffer_load_dwordx4 a[188:191], v15, s[20:23], s34 offen sc1
    s_add_u32 s34, s34, s47
    v_mfma_f32_16x16x32_bf16 v[48:51], a[0:3], v[212:215], v[48:51]
    ds_read_b64_tr_b16 a[40:41], v194 offset:49152
    v_mfma_f32_16x16x32_bf16 v[52:55], a[4:7], v[212:215], v[52:55]
    ds_read_b64_tr_b16 a[42:43], v194 offset:53248
    v_mfma_f32_16x16x32_bf16 v[56:59], a[8:11], v[212:215], v[56:59]
    s_mov_b32 s36, 49152
    v_mfma_f32_16x16x32_bf16 v[60:63], a[12:15], v[212:215], v[60:63]
    ds_read_b64_tr_b16 a[44:45], v195 offset:49152
    v_mfma_f32_16x16x32_bf16 v[112:115], a[16:19], v[212:215], v[112:115]
    ds_read_b64_tr_b16 a[46:47], v195 offset:53248
    s_add_u32 m0, s32, 32768
    v_mfma_f32_16x16x32_bf16 v[116:119], a[20:23], v[212:215], v[116:119]
    buffer_load_dwordx4 v18, s[8:11], s33 offen offset:0 lds
    v_mfma_f32_16x16x32_bf16 v[120:123], a[24:27], v[212:215], v[120:123]
    ds_read_b64_tr_b16 a[48:49], v196 offset:49152
    v_mfma_f32_16x16x32_bf16 v[124:127], a[28:31], v[212:215], v[124:127]
    ds_read_b64_tr_b16 a[50:51], v196 offset:53248
    v_mfma_f32_16x16x32_bf16 v[64:67], a[0:3], v[216:219], v[64:67]
    buffer_load_dwordx4 v19, s[8:11], s33 offen offset:1024 lds
    v_mfma_f32_16x16x32_bf16 v[68:71], a[4:7], v[216:219], v[68:71]
    ds_read_b64_tr_b16 a[52:53], v197 offset:49152
    v_mfma_f32_16x16x32_bf16 v[72:75], a[8:11], v[216:219], v[72:75]
    ds_read_b64_tr_b16 a[54:55], v197 offset:53248
    v_mfma_f32_16x16x32_bf16 v[76:79], a[12:15], v[216:219], v[76:79]
    v_writelane_b32 v23, s36, 1
    v_mfma_f32_16x16x32_bf16 v[128:131], a[16:19], v[216:219], v[128:131]
    ds_read_b64_tr_b16 a[56:57], v198 offset:49152
    v_mfma_f32_16x16x32_bf16 v[132:135], a[20:23], v[216:219], v[132:135]
    ds_read_b64_tr_b16 a[58:59], v198 offset:53248
    v_mfma_f32_16x16x32_bf16 v[136:139], a[24:27], v[216:219], v[136:139]
    buffer_load_dwordx4 v20, s[8:11], s33 offen offset:2048 lds
    v_mfma_f32_16x16x32_bf16 v[140:143], a[28:31], v[216:219], v[140:143]
    ds_read_b64_tr_b16 a[60:61], v199 offset:49152
    v_mfma_f32_16x16x32_bf16 v[80:83], a[0:3], v[220:223], v[80:83]
    ds_read_b64_tr_b16 a[62:63], v199 offset:53248
    v_mfma_f32_16x16x32_bf16 v[84:87], a[4:7], v[220:223], v[84:87]
    s_and_b32 s36, s24, 1
    v_mfma_f32_16x16x32_bf16 v[88:91], a[8:11], v[220:223], v[88:91]
    s_lshl_b32 s36, s36, 7
    v_mfma_f32_16x16x32_bf16 v[92:95], a[12:15], v[220:223], v[92:95]
    buffer_load_dwordx4 v21, s[8:11], s33 offen offset:3072 lds
    s_add_u32 s33, s33, s44
    v_mfma_f32_16x16x32_bf16 v[144:147], a[16:19], v[220:223], v[144:147]
    s_lshr_b32 s37, s24, 1
    v_mfma_f32_16x16x32_bf16 v[148:151], a[20:23], v[220:223], v[148:151]
    s_lshl_b32 s37, s37, 6
    v_mfma_f32_16x16x32_bf16 v[152:155], a[24:27], v[220:223], v[152:155]
    buffer_load_dwordx4 a[160:163], v12, s[20:23], s34 offen sc1
    v_mfma_f32_16x16x32_bf16 v[156:159], a[28:31], v[220:223], v[156:159]
    s_add_u32 s36, s36, s37
    s_waitcnt vmcnt(57)
    s_waitcnt lgkmcnt(0)
    v_mfma_f32_16x16x32_bf16 v[32:35], a[32:35], v[224:227], v[32:35]
    s_waitcnt vmcnt(38)
    s_barrier
    v_mfma_f32_16x16x32_bf16 v[36:39], a[36:39], v[224:227], v[36:39]
    s_lshl_b32 s37, s27, 8
    v_mfma_f32_16x16x32_bf16 v[40:43], a[40:43], v[224:227], v[40:43]
    ds_read_b64_tr_b16 a[0:1], v204 offset:0
    v_mfma_f32_16x16x32_bf16 v[44:47], a[44:47], v[224:227], v[44:47]
    ds_read_b64_tr_b16 a[2:3], v204 offset:4096
    s_add_u32 m0, s32, 49152
    v_mfma_f32_16x16x32_bf16 v[96:99], a[48:51], v[224:227], v[96:99]
    buffer_load_dwordx4 v18, s[8:11], s33 offen offset:0 lds
    v_mfma_f32_16x16x32_bf16 v[100:103], a[52:55], v[224:227], v[100:103]
    ds_read_b64_tr_b16 a[4:5], v205 offset:0
    v_mfma_f32_16x16x32_bf16 v[104:107], a[56:59], v[224:227], v[104:107]
    ds_read_b64_tr_b16 a[6:7], v205 offset:4096
    v_mfma_f32_16x16x32_bf16 v[108:111], a[60:63], v[224:227], v[108:111]
    buffer_load_dwordx4 v19, s[8:11], s33 offen offset:1024 lds
    v_mfma_f32_16x16x32_bf16 v[48:51], a[32:35], v[228:231], v[48:51]
    ds_read_b64_tr_b16 a[8:9], v206 offset:0
    v_mfma_f32_16x16x32_bf16 v[52:55], a[36:39], v[228:231], v[52:55]
    ds_read_b64_tr_b16 a[10:11], v206 offset:4096
    v_mfma_f32_16x16x32_bf16 v[56:59], a[40:43], v[228:231], v[56:59]
    s_add_u32 s37, s37, s36
    v_mfma_f32_16x16x32_bf16 v[60:63], a[44:47], v[228:231], v[60:63]
    ds_read_b64_tr_b16 a[12:13], v207 offset:0
    v_mfma_f32_16x16x32_bf16 v[112:115], a[48:51], v[228:231], v[112:115]
    ds_read_b64_tr_b16 a[14:15], v207 offset:4096
    v_mfma_f32_16x16x32_bf16 v[116:119], a[52:55], v[228:231], v[116:119]
    buffer_load_dwordx4 v20, s[8:11], s33 offen offset:2048 lds
    v_mfma_f32_16x16x32_bf16 v[120:123], a[56:59], v[228:231], v[120:123]
    ds_read_b64_tr_b16 a[16:17], v204 offset:16384
    v_mfma_f32_16x16x32_bf16 v[124:127], a[60:63], v[228:231], v[124:127]
    ds_read_b64_tr_b16 a[18:19], v204 offset:20480
    v_mfma_f32_16x16x32_bf16 v[64:67], a[32:35], v[232:235], v[64:67]
    buffer_load_dwordx4 v21, s[8:11], s33 offen offset:3072 lds
    s_add_u32 s33, s33, s45
    v_mfma_f32_16x16x32_bf16 v[68:71], a[36:39], v[232:235], v[68:71]
    ds_read_b64_tr_b16 a[20:21], v205 offset:16384
    v_mfma_f32_16x16x32_bf16 v[72:75], a[40:43], v[232:235], v[72:75]
    ds_read_b64_tr_b16 a[22:23], v205 offset:20480
    v_mfma_f32_16x16x32_bf16 v[76:79], a[44:47], v[232:235], v[76:79]
    s_lshl_b32 s38, s35, 18
    v_mfma_f32_16x16x32_bf16 v[128:131], a[48:51], v[232:235], v[128:131]
    ds_read_b64_tr_b16 a[24:25], v206 offset:16384
    v_mfma_f32_16x16x32_bf16 v[132:135], a[52:55], v[232:235], v[132:135]
    ds_read_b64_tr_b16 a[26:27], v206 offset:20480
    v_mfma_f32_16x16x32_bf16 v[136:139], a[56:59], v[232:235], v[136:139]
    buffer_load_dwordx4 a[164:167], v13, s[20:23], s34 offen sc1
    v_mfma_f32_16x16x32_bf16 v[140:143], a[60:63], v[232:235], v[140:143]
    ds_read_b64_tr_b16 a[28:29], v207 offset:16384
    v_mfma_f32_16x16x32_bf16 v[80:83], a[32:35], v[236:239], v[80:83]
    ds_read_b64_tr_b16 a[30:31], v207 offset:20480
    v_mfma_f32_16x16x32_bf16 v[84:87], a[36:39], v[236:239], v[84:87]
    s_add_u32 s38, s38, s37
    v_mfma_f32_16x16x32_bf16 v[88:91], a[40:43], v[236:239], v[88:91]
    s_lshl_b32 s39, s37, 1
    v_mfma_f32_16x16x32_bf16 v[92:95], a[44:47], v[236:239], v[92:95]
    buffer_load_dwordx4 a[168:171], v14, s[20:23], s34 offen sc1
    v_mfma_f32_16x16x32_bf16 v[144:147], a[48:51], v[236:239], v[144:147]
    s_lshl_b32 s25, s37, 10
    v_mfma_f32_16x16x32_bf16 v[148:151], a[52:55], v[236:239], v[148:151]
    s_lshl_b32 s36, s35, 7
    v_mfma_f32_16x16x32_bf16 v[152:155], a[56:59], v[236:239], v[152:155]
    buffer_load_dwordx4 a[172:175], v15, s[20:23], s34 offen sc1
    s_add_u32 s34, s34, s46
    v_mfma_f32_16x16x32_bf16 v[156:159], a[60:63], v[236:239], v[156:159]
    s_add_u32 s25, s25, s36
    s_waitcnt vmcnt(44)
    s_waitcnt lgkmcnt(0)
    v_mfma_f32_16x16x32_bf16 v[96:99], a[0:3], a[144:147], v[96:99]
    s_waitcnt vmcnt(31)
    s_barrier
    v_mfma_f32_16x16x32_bf16 v[100:103], a[4:7], a[144:147], v[100:103]
    s_add_u32 s26, s25, 32768
    v_mfma_f32_16x16x32_bf16 v[104:107], a[8:11], a[144:147], v[104:107]
    ds_read_b64_tr_b16 a[32:33], v204 offset:32768
    v_mfma_f32_16x16x32_bf16 v[108:111], a[12:15], a[144:147], v[108:111]
    ds_read_b64_tr_b16 a[34:35], v204 offset:36864
    v_mfma_f32_16x16x32_bf16 v[112:115], a[0:3], a[148:151], v[112:115]
    buffer_load_dwordx4 a[128:131], v12, s[20:23], s34 offen sc1
    v_mfma_f32_16x16x32_bf16 v[116:119], a[4:7], a[148:151], v[116:119]
    ds_read_b64_tr_b16 a[36:37], v205 offset:32768
    v_mfma_f32_16x16x32_bf16 v[120:123], a[8:11], a[148:151], v[120:123]
    ds_read_b64_tr_b16 a[38:39], v205 offset:36864
    v_mfma_f32_16x16x32_bf16 v[124:127], a[12:15], a[148:151], v[124:127]
    buffer_load_dwordx4 a[132:135], v13, s[20:23], s34 offen sc1
    v_mfma_f32_16x16x32_bf16 v[128:131], a[0:3], a[152:155], v[128:131]
    ds_read_b64_tr_b16 a[40:41], v206 offset:32768
    v_mfma_f32_16x16x32_bf16 v[132:135], a[4:7], a[152:155], v[132:135]
    ds_read_b64_tr_b16 a[42:43], v206 offset:36864
    v_mfma_f32_16x16x32_bf16 v[136:139], a[8:11], a[152:155], v[136:139]
    v_and_b32 v30, 15, v0
    v_mfma_f32_16x16x32_bf16 v[140:143], a[12:15], a[152:155], v[140:143]
    ds_read_b64_tr_b16 a[44:45], v207 offset:32768
    v_mfma_f32_16x16x32_bf16 v[144:147], a[0:3], a[156:159], v[144:147]
    ds_read_b64_tr_b16 a[46:47], v207 offset:36864
    v_mfma_f32_16x16x32_bf16 v[148:151], a[4:7], a[156:159], v[148:151]
    buffer_load_dwordx4 a[136:139], v14, s[20:23], s34 offen sc1
    v_mfma_f32_16x16x32_bf16 v[152:155], a[8:11], a[156:159], v[152:155]
    ds_read_b64_tr_b16 a[48:49], v204 offset:49152
    v_mfma_f32_16x16x32_bf16 v[156:159], a[12:15], a[156:159], v[156:159]
    ds_read_b64_tr_b16 a[50:51], v204 offset:53248
    v_mfma_f32_16x16x32_bf16 v[96:99], a[16:19], a[240:243], v[96:99]
    buffer_load_dwordx4 a[140:143], v15, s[20:23], s34 offen sc1
    s_add_u32 s34, s34, s47
    v_mfma_f32_16x16x32_bf16 v[100:103], a[20:23], a[240:243], v[100:103]
    ds_read_b64_tr_b16 a[52:53], v205 offset:49152
    v_mfma_f32_16x16x32_bf16 v[104:107], a[24:27], a[240:243], v[104:107]
    ds_read_b64_tr_b16 a[54:55], v205 offset:53248
    v_mfma_f32_16x16x32_bf16 v[108:111], a[28:31], a[240:243], v[108:111]
    v_lshrrev_b32 v31, 4, v0
    v_mfma_f32_16x16x32_bf16 v[112:115], a[16:19], a[244:247], v[112:115]
    ds_read_b64_tr_b16 a[56:57], v206 offset:49152
    v_mfma_f32_16x16x32_bf16 v[116:119], a[20:23], a[244:247], v[116:119]
    ds_read_b64_tr_b16 a[58:59], v206 offset:53248
    v_mfma_f32_16x16x32_bf16 v[120:123], a[24:27], a[244:247], v[120:123]
    v_lshlrev_b32 v10, 12, v30
    v_mfma_f32_16x16x32_bf16 v[124:127], a[28:31], a[244:247], v[124:127]
    ds_read_b64_tr_b16 a[60:61], v207 offset:49152
    v_mfma_f32_16x16x32_bf16 v[128:131], a[16:19], a[248:251], v[128:131]
    ds_read_b64_tr_b16 a[62:63], v207 offset:53248
    v_mfma_f32_16x16x32_bf16 v[132:135], a[20:23], a[248:251], v[132:135]
    v_lshl_add_u32 v10, v31, 4, v10
    v_mfma_f32_16x16x32_bf16 v[136:139], a[24:27], a[248:251], v[136:139]
    v_lshlrev_b32 v29, 2, v30
    v_mfma_f32_16x16x32_bf16 v[140:143], a[28:31], a[248:251], v[140:143]
    v_lshlrev_b32 v11, 11, v30
    v_mfma_f32_16x16x32_bf16 v[144:147], a[16:19], a[252:255], v[144:147]
    v_and_b32 v28, 1, v31
    v_mfma_f32_16x16x32_bf16 v[148:151], a[20:23], a[252:255], v[148:151]
    v_lshl_add_u32 v11, v28, 5, v11
    v_mfma_f32_16x16x32_bf16 v[152:155], a[24:27], a[252:255], v[152:155]
    v_lshrrev_b32 v28, 1, v31
    v_mfma_f32_16x16x32_bf16 v[156:159], a[28:31], a[252:255], v[156:159]
    v_lshl_add_u32 v11, v28, 4, v11
    s_waitcnt vmcnt(32)
    s_waitcnt lgkmcnt(0)
    v_mfma_f32_16x16x32_bf16 v[96:99], a[32:35], a[224:227], v[96:99]
    s_waitcnt vmcnt(21)
    s_barrier
    v_mfma_f32_16x16x32_bf16 v[100:103], a[36:39], a[224:227], v[100:103]
    v_lshlrev_b32 v31, 3, v31
    v_mfma_f32_16x16x32_bf16 v[104:107], a[40:43], a[224:227], v[104:107]
    ds_read_b64_tr_b16 a[0:1], v196 offset:0
    v_mfma_f32_16x16x32_bf16 v[108:111], a[44:47], a[224:227], v[108:111]
    ds_read_b64_tr_b16 a[2:3], v196 offset:4096
    v_mfma_f32_16x16x32_bf16 v[112:115], a[32:35], a[228:231], v[112:115]
    v_sub_u32 v17, v30, v31
    v_mfma_f32_16x16x32_bf16 v[116:119], a[36:39], a[228:231], v[116:119]
    ds_read_b64_tr_b16 a[4:5], v197 offset:0
    v_mfma_f32_16x16x32_bf16 v[120:123], a[40:43], a[228:231], v[120:123]
    ds_read_b64_tr_b16 a[6:7], v197 offset:4096
    v_mfma_f32_16x16x32_bf16 v[124:127], a[44:47], a[228:231], v[124:127]
    v_mfma_f32_16x16x32_bf16 v[128:131], a[32:35], a[232:235], v[128:131]
    ds_read_b64_tr_b16 a[8:9], v198 offset:0
    v_mfma_f32_16x16x32_bf16 v[132:135], a[36:39], a[232:235], v[132:135]
    ds_read_b64_tr_b16 a[10:11], v198 offset:4096
    v_mfma_f32_16x16x32_bf16 v[136:139], a[40:43], a[232:235], v[136:139]
    global_load_dword v22, v23, s[56:57] sc1
    v_mfma_f32_16x16x32_bf16 v[140:143], a[44:47], a[232:235], v[140:143]
    ds_read_b64_tr_b16 a[12:13], v199 offset:0
    v_mfma_f32_16x16x32_bf16 v[144:147], a[32:35], a[236:239], v[144:147]
    ds_read_b64_tr_b16 a[14:15], v199 offset:4096
    v_mfma_f32_16x16x32_bf16 v[148:151], a[36:39], a[236:239], v[148:151]
    v_mfma_f32_16x16x32_bf16 v[152:155], a[40:43], a[236:239], v[152:155]
    ds_read_b64_tr_b16 a[16:17], v196 offset:16384
    v_mfma_f32_16x16x32_bf16 v[156:159], a[44:47], a[236:239], v[156:159]
    ds_read_b64_tr_b16 a[18:19], v196 offset:20480
    v_mfma_f32_16x16x32_bf16 v[96:99], a[48:51], a[208:211], v[96:99]
    v_mfma_f32_16x16x32_bf16 v[100:103], a[52:55], a[208:211], v[100:103]
    ds_read_b64_tr_b16 a[20:21], v197 offset:16384
    v_mfma_f32_16x16x32_bf16 v[104:107], a[56:59], a[208:211], v[104:107]
    ds_read_b64_tr_b16 a[22:23], v197 offset:20480
    v_mfma_f32_16x16x32_bf16 v[108:111], a[60:63], a[208:211], v[108:111]
    v_mfma_f32_16x16x32_bf16 v[112:115], a[48:51], a[212:215], v[112:115]
    ds_read_b64_tr_b16 a[24:25], v198 offset:16384
    v_mfma_f32_16x16x32_bf16 v[116:119], a[52:55], a[212:215], v[116:119]
    ds_read_b64_tr_b16 a[26:27], v198 offset:20480
    v_mfma_f32_16x16x32_bf16 v[120:123], a[56:59], a[212:215], v[120:123]
    v_mfma_f32_16x16x32_bf16 v[124:127], a[60:63], a[212:215], v[124:127]
    ds_read_b64_tr_b16 a[28:29], v199 offset:16384
    v_mfma_f32_16x16x32_bf16 v[128:131], a[48:51], a[216:219], v[128:131]
    ds_read_b64_tr_b16 a[30:31], v199 offset:20480
    v_mfma_f32_16x16x32_bf16 v[132:135], a[52:55], a[216:219], v[132:135]
    v_mfma_f32_16x16x32_bf16 v[136:139], a[56:59], a[216:219], v[136:139]
    v_mfma_f32_16x16x32_bf16 v[140:143], a[60:63], a[216:219], v[140:143]
    v_mfma_f32_16x16x32_bf16 v[144:147], a[48:51], a[220:223], v[144:147]
    v_mfma_f32_16x16x32_bf16 v[148:151], a[52:55], a[220:223], v[148:151]
    v_mfma_f32_16x16x32_bf16 v[152:155], a[56:59], a[220:223], v[152:155]
    v_mfma_f32_16x16x32_bf16 v[156:159], a[60:63], a[220:223], v[156:159]
    s_waitcnt vmcnt(17)
    s_waitcnt lgkmcnt(0)
    v_mfma_f32_16x16x32_bf16 v[96:99], a[0:3], a[192:195], v[96:99]
    s_waitcnt vmcnt(8)
    s_barrier
    v_mfma_f32_16x16x32_bf16 v[100:103], a[4:7], a[192:195], v[100:103]
    v_mfma_f32_16x16x32_bf16 v[104:107], a[8:11], a[192:195], v[104:107]
    ds_read_b64_tr_b16 a[32:33], v196 offset:32768
    v_mfma_f32_16x16x32_bf16 v[108:111], a[12:15], a[192:195], v[108:111]
    ds_read_b64_tr_b16 a[34:35], v196 offset:36864
    v_mfma_f32_16x16x32_bf16 v[112:115], a[0:3], a[196:199], v[112:115]
    v_mfma_f32_16x16x32_bf16 v[116:119], a[4:7], a[196:199], v[116:119]
    ds_read_b64_tr_b16 a[36:37], v197 offset:32768
    v_mfma_f32_16x16x32_bf16 v[120:123], a[8:11], a[196:199], v[120:123]
    ds_read_b64_tr_b16 a[38:39], v197 offset:36864
    v_mfma_f32_16x16x32_bf16 v[124:127], a[12:15], a[196:199], v[124:127]
    v_mfma_f32_16x16x32_bf16 v[128:131], a[0:3], a[200:203], v[128:131]
    ds_read_b64_tr_b16 a[40:41], v198 offset:32768
    v_mfma_f32_16x16x32_bf16 v[132:135], a[4:7], a[200:203], v[132:135]
    ds_read_b64_tr_b16 a[42:43], v198 offset:36864
    v_mfma_f32_16x16x32_bf16 v[136:139], a[8:11], a[200:203], v[136:139]
    v_mfma_f32_16x16x32_bf16 v[140:143], a[12:15], a[200:203], v[140:143]
    ds_read_b64_tr_b16 a[44:45], v199 offset:32768
    v_mfma_f32_16x16x32_bf16 v[144:147], a[0:3], a[204:207], v[144:147]
    ds_read_b64_tr_b16 a[46:47], v199 offset:36864
    v_mfma_f32_16x16x32_bf16 v[148:151], a[4:7], a[204:207], v[148:151]
    v_mfma_f32_16x16x32_bf16 v[152:155], a[8:11], a[204:207], v[152:155]
    ds_read_b64_tr_b16 a[48:49], v196 offset:49152
    v_mfma_f32_16x16x32_bf16 v[156:159], a[12:15], a[204:207], v[156:159]
    ds_read_b64_tr_b16 a[50:51], v196 offset:53248
    v_mfma_f32_16x16x32_bf16 v[96:99], a[16:19], a[176:179], v[96:99]
    v_mfma_f32_16x16x32_bf16 v[100:103], a[20:23], a[176:179], v[100:103]
    ds_read_b64_tr_b16 a[52:53], v197 offset:49152
    v_mfma_f32_16x16x32_bf16 v[104:107], a[24:27], a[176:179], v[104:107]
    ds_read_b64_tr_b16 a[54:55], v197 offset:53248
    v_mfma_f32_16x16x32_bf16 v[108:111], a[28:31], a[176:179], v[108:111]
    s_waitcnt vmcnt(0)
    v_readfirstlane_b32 s48, v22
    v_readlane_b32 s50, v22, 1
    s_lshr_b32 s50, s50, 3
    s_min_u32 s48, s48, s50
    s_mov_b32 s49, 0
    s_cmp_ge_u32 s48, 16
    s_cbranch_scc1 fused_kernel_st_go
    fused_kernel_st:
    s_sleep 4
    global_load_dword v22, v23, s[56:57] sc1
    s_add_u32 s49, s49, 1
    s_waitcnt vmcnt(0)
    v_readfirstlane_b32 s48, v22
    v_readlane_b32 s50, v22, 1
    s_lshr_b32 s50, s50, 3
    s_min_u32 s48, s48, s50
    s_cmp_ge_u32 s49, 0x40000
    s_cbranch_scc1 fused_kernel_st_go
    s_cmp_lt_u32 s48, 16
    s_cbranch_scc1 fused_kernel_st
    fused_kernel_st_go:
    v_mfma_f32_16x16x32_bf16 v[112:115], a[16:19], a[180:183], v[112:115]
    ds_read_b64_tr_b16 a[56:57], v198 offset:49152
    buffer_load_dword v4, v29, s[40:43], s39 offen offset:0 sc1
    v_mfma_f32_16x16x32_bf16 v[116:119], a[20:23], a[180:183], v[116:119]
    ds_read_b64_tr_b16 a[58:59], v198 offset:53248
    buffer_load_dword v5, v29, s[40:43], s39 offen offset:64 sc1
    v_mfma_f32_16x16x32_bf16 v[120:123], a[24:27], a[180:183], v[120:123]
    buffer_load_dwordx4 v[224:227], v10, s[84:87], s38 offen sc1
    s_add_u32 s38, s38, 65536
    v_mfma_f32_16x16x32_bf16 v[124:127], a[28:31], a[180:183], v[124:127]
    ds_read_b64_tr_b16 a[60:61], v199 offset:49152
    v_mfma_f32_16x16x32_bf16 v[128:131], a[16:19], a[184:187], v[128:131]
    ds_read_b64_tr_b16 a[62:63], v199 offset:53248
    v_mfma_f32_16x16x32_bf16 v[132:135], a[20:23], a[184:187], v[132:135]
    buffer_load_dwordx4 v[228:231], v10, s[84:87], s38 offen sc1
    s_add_u32 s38, s38, 65536
    v_mfma_f32_16x16x32_bf16 v[136:139], a[24:27], a[184:187], v[136:139]
    v_mfma_f32_16x16x32_bf16 v[140:143], a[28:31], a[184:187], v[140:143]
    v_mfma_f32_16x16x32_bf16 v[144:147], a[16:19], a[188:191], v[144:147]
    buffer_load_dwordx4 v[232:235], v10, s[84:87], s38 offen sc1
    s_add_u32 s38, s38, 65536
    v_mfma_f32_16x16x32_bf16 v[148:151], a[20:23], a[188:191], v[148:151]
    v_mfma_f32_16x16x32_bf16 v[152:155], a[24:27], a[188:191], v[152:155]
    v_mfma_f32_16x16x32_bf16 v[156:159], a[28:31], a[188:191], v[156:159]
    buffer_load_dwordx4 v[236:239], v10, s[84:87], s38 offen sc1
    s_add_u32 s38, s38, 65536
    s_waitcnt vmcnt(7)
    s_waitcnt lgkmcnt(0)
    v_mfma_f32_16x16x32_bf16 v[128:131], a[32:35], a[168:171], v[128:131]
    ds_read_b64_tr_b16 a[0:1], v200 offset:0
    v_mfma_f32_16x16x32_bf16 v[132:135], a[36:39], a[168:171], v[132:135]
    ds_read_b64_tr_b16 a[2:3], v200 offset:4096
    v_mfma_f32_16x16x32_bf16 v[136:139], a[40:43], a[168:171], v[136:139]
    ds_read_b64_tr_b16 a[4:5], v201 offset:0
    v_mfma_f32_16x16x32_bf16 v[140:143], a[44:47], a[168:171], v[140:143]
    ds_read_b64_tr_b16 a[6:7], v201 offset:4096
    v_mfma_f32_16x16x32_bf16 v[144:147], a[32:35], a[172:175], v[144:147]
    ds_read_b64_tr_b16 a[8:9], v202 offset:0
    v_mfma_f32_16x16x32_bf16 v[148:151], a[36:39], a[172:175], v[148:151]
    ds_read_b64_tr_b16 a[10:11], v202 offset:4096
    v_mfma_f32_16x16x32_bf16 v[152:155], a[40:43], a[172:175], v[152:155]
    ds_read_b64_tr_b16 a[12:13], v203 offset:0
    v_mfma_f32_16x16x32_bf16 v[156:159], a[44:47], a[172:175], v[156:159]
    ds_read_b64_tr_b16 a[14:15], v203 offset:4096
    v_mfma_f32_16x16x32_bf16 v[128:131], a[48:51], a[136:139], v[128:131]
    ds_read_b64_tr_b16 a[16:17], v200 offset:16384
    v_mfma_f32_16x16x32_bf16 v[132:135], a[52:55], a[136:139], v[132:135]
    ds_read_b64_tr_b16 a[18:19], v200 offset:20480
    v_mfma_f32_16x16x32_bf16 v[136:139], a[56:59], a[136:139], v[136:139]
    ds_read_b64_tr_b16 a[20:21], v201 offset:16384
    v_mfma_f32_16x16x32_bf16 v[140:143], a[60:63], a[136:139], v[140:143]
    ds_read_b64_tr_b16 a[22:23], v201 offset:20480
    v_mfma_f32_16x16x32_bf16 v[144:147], a[48:51], a[140:143], v[144:147]
    ds_read_b64_tr_b16 a[24:25], v202 offset:16384
    v_mfma_f32_16x16x32_bf16 v[148:151], a[52:55], a[140:143], v[148:151]
    ds_read_b64_tr_b16 a[26:27], v202 offset:20480
    v_mfma_f32_16x16x32_bf16 v[152:155], a[56:59], a[140:143], v[152:155]
    ds_read_b64_tr_b16 a[28:29], v203 offset:16384
    v_mfma_f32_16x16x32_bf16 v[156:159], a[60:63], a[140:143], v[156:159]
    ds_read_b64_tr_b16 a[30:31], v203 offset:20480
    v_mfma_f32_16x16x32_bf16 v[96:99], a[32:35], a[160:163], v[96:99]
    v_mfma_f32_16x16x32_bf16 v[100:103], a[36:39], a[160:163], v[100:103]
    ds_write_b128 v6, v[128:131] offset:0
    v_mfma_f32_16x16x32_bf16 v[104:107], a[40:43], a[160:163], v[104:107]
    v_mfma_f32_16x16x32_bf16 v[108:111], a[44:47], a[160:163], v[108:111]
    ds_write_b128 v6, v[132:135] offset:1024
    v_mfma_f32_16x16x32_bf16 v[112:115], a[32:35], a[164:167], v[112:115]
    v_mfma_f32_16x16x32_bf16 v[116:119], a[36:39], a[164:167], v[116:119]
    ds_write_b128 v6, v[136:139] offset:2048
    v_mfma_f32_16x16x32_bf16 v[120:123], a[40:43], a[164:167], v[120:123]
    v_mfma_f32_16x16x32_bf16 v[124:127], a[44:47], a[164:167], v[124:127]
    ds_write_b128 v6, v[140:143] offset:3072
    v_mfma_f32_16x16x32_bf16 v[96:99], a[48:51], a[128:131], v[96:99]
    v_mfma_f32_16x16x32_bf16 v[100:103], a[52:55], a[128:131], v[100:103]
    ds_write_b128 v6, v[144:147] offset:4096
    v_mfma_f32_16x16x32_bf16 v[104:107], a[56:59], a[128:131], v[104:107]
    v_mfma_f32_16x16x32_bf16 v[108:111], a[60:63], a[128:131], v[108:111]
    ds_write_b128 v6, v[148:151] offset:5120
    v_mfma_f32_16x16x32_bf16 v[112:115], a[48:51], a[132:135], v[112:115]
    v_mfma_f32_16x16x32_bf16 v[116:119], a[52:55], a[132:135], v[116:119]
    ds_write_b128 v6, v[152:155] offset:6144
    v_mfma_f32_16x16x32_bf16 v[120:123], a[56:59], a[132:135], v[120:123]
    v_mfma_f32_16x16x32_bf16 v[124:127], a[60:63], a[132:135], v[124:127]
    ds_write_b128 v6, v[156:159] offset:7168
    s_waitcnt lgkmcnt(0)
    v_mfma_f32_16x16x32_bf16 v[32:35], a[0:3], a[144:147], v[32:35]
    s_barrier
    v_mfma_f32_16x16x32_bf16 v[36:39], a[4:7], a[144:147], v[36:39]
    ds_read_b128 v[160:163], v7 offset:0
    v_mfma_f32_16x16x32_bf16 v[40:43], a[8:11], a[144:147], v[40:43]
    ds_read_b128 v[164:167], v7 offset:1024
    v_mfma_f32_16x16x32_bf16 v[44:47], a[12:15], a[144:147], v[44:47]
    ds_read_b128 v[168:171], v7 offset:2048
    v_mfma_f32_16x16x32_bf16 v[48:51], a[0:3], a[148:151], v[48:51]
    ds_read_b128 v[172:175], v7 offset:3072
    v_mfma_f32_16x16x32_bf16 v[52:55], a[4:7], a[148:151], v[52:55]
    ds_read_b128 v[176:179], v7 offset:4096
    v_mfma_f32_16x16x32_bf16 v[56:59], a[8:11], a[148:151], v[56:59]
    ds_read_b128 v[180:183], v7 offset:5120
    v_mfma_f32_16x16x32_bf16 v[60:63], a[12:15], a[148:151], v[60:63]
    ds_read_b128 v[184:187], v7 offset:6144
    v_mfma_f32_16x16x32_bf16 v[64:67], a[0:3], a[152:155], v[64:67]
    ds_read_b128 v[188:191], v7 offset:7168
    v_mfma_f32_16x16x32_bf16 v[68:71], a[4:7], a[152:155], v[68:71]
    ds_read_b64_tr_b16 a[32:33], v200 offset:32768
    v_mfma_f32_16x16x32_bf16 v[72:75], a[8:11], a[152:155], v[72:75]
    ds_read_b64_tr_b16 a[34:35], v200 offset:36864
    v_mfma_f32_16x16x32_bf16 v[76:79], a[12:15], a[152:155], v[76:79]
    ds_read_b64_tr_b16 a[36:37], v201 offset:32768
    v_mfma_f32_16x16x32_bf16 v[80:83], a[0:3], a[156:159], v[80:83]
    ds_read_b64_tr_b16 a[38:39], v201 offset:36864
    s_waitcnt lgkmcnt(11)
    v_add_f32 v96, v96, v160
    v_add_f32 v97, v97, v161
    v_mfma_f32_16x16x32_bf16 v[84:87], a[4:7], a[156:159], v[84:87]
    ds_read_b64_tr_b16 a[40:41], v202 offset:32768
    v_add_f32 v98, v98, v162
    v_add_f32 v99, v99, v163
    v_mfma_f32_16x16x32_bf16 v[88:91], a[8:11], a[156:159], v[88:91]
    ds_read_b64_tr_b16 a[42:43], v202 offset:36864
    buffer_store_dwordx4 v[96:99], v1, s[52:55], s100 offen offset:0 sc1
    s_waitcnt lgkmcnt(12)
    v_add_f32 v100, v100, v164
    v_add_f32 v101, v101, v165
    v_mfma_f32_16x16x32_bf16 v[92:95], a[12:15], a[156:159], v[92:95]
    ds_read_b64_tr_b16 a[44:45], v203 offset:32768
    v_add_f32 v102, v102, v166
    v_add_f32 v103, v103, v167
    v_mfma_f32_16x16x32_bf16 v[32:35], a[16:19], a[240:243], v[32:35]
    ds_read_b64_tr_b16 a[46:47], v203 offset:36864
    buffer_store_dwordx4 v[100:103], v1, s[52:55], s100 offen offset:1024 sc1
    s_waitcnt lgkmcnt(13)
    v_add_f32 v104, v104, v168
    v_add_f32 v105, v105, v169
    v_mfma_f32_16x16x32_bf16 v[36:39], a[20:23], a[240:243], v[36:39]
    ds_read_b64_tr_b16 a[48:49], v200 offset:49152
    v_add_f32 v106, v106, v170
    v_add_f32 v107, v107, v171
    v_mfma_f32_16x16x32_bf16 v[40:43], a[24:27], a[240:243], v[40:43]
    ds_read_b64_tr_b16 a[50:51], v200 offset:53248
    buffer_store_dwordx4 v[104:107], v1, s[52:55], s100 offen offset:2048 sc1
    s_waitcnt lgkmcnt(14)
    v_add_f32 v108, v108, v172
    v_add_f32 v109, v109, v173
    v_mfma_f32_16x16x32_bf16 v[44:47], a[28:31], a[240:243], v[44:47]
    ds_read_b64_tr_b16 a[52:53], v201 offset:49152
    v_add_f32 v110, v110, v174
    v_add_f32 v111, v111, v175
    v_mfma_f32_16x16x32_bf16 v[48:51], a[16:19], a[244:247], v[48:51]
    ds_read_b64_tr_b16 a[54:55], v201 offset:53248
    buffer_store_dwordx4 v[108:111], v1, s[52:55], s100 offen offset:3072 sc1
    s_add_u32 s100, s100, 4096
    s_waitcnt lgkmcnt(15)
    v_add_f32 v112, v112, v176
    v_add_f32 v113, v113, v177
    v_mfma_f32_16x16x32_bf16 v[52:55], a[20:23], a[244:247], v[52:55]
    ds_read_b64_tr_b16 a[56:57], v202 offset:49152
    v_add_f32 v114, v114, v178
    v_add_f32 v115, v115, v179
    v_mfma_f32_16x16x32_bf16 v[56:59], a[24:27], a[244:247], v[56:59]
    ds_read_b64_tr_b16 a[58:59], v202 offset:53248
    buffer_store_dwordx4 v[112:115], v1, s[52:55], s100 offen offset:0 sc1
    s_waitcnt lgkmcnt(15)
    v_add_f32 v116, v116, v180
    v_add_f32 v117, v117, v181
    v_mfma_f32_16x16x32_bf16 v[60:63], a[28:31], a[244:247], v[60:63]
    ds_read_b64_tr_b16 a[60:61], v203 offset:49152
    v_add_f32 v118, v118, v182
    v_add_f32 v119, v119, v183
    v_mfma_f32_16x16x32_bf16 v[64:67], a[16:19], a[248:251], v[64:67]
    ds_read_b64_tr_b16 a[62:63], v203 offset:53248
    buffer_store_dwordx4 v[116:119], v1, s[52:55], s100 offen offset:1024 sc1
    s_waitcnt lgkmcnt(15)
    v_add_f32 v120, v120, v184
    v_add_f32 v121, v121, v185
    v_mfma_f32_16x16x32_bf16 v[68:71], a[20:23], a[248:251], v[68:71]
    v_add_f32 v122, v122, v186
    v_add_f32 v123, v123, v187
    v_mfma_f32_16x16x32_bf16 v[72:75], a[24:27], a[248:251], v[72:75]
    buffer_store_dwordx4 v[120:123], v1, s[52:55], s100 offen offset:2048 sc1
    s_waitcnt lgkmcnt(15)
    v_add_f32 v124, v124, v188
    v_add_f32 v125, v125, v189
    v_mfma_f32_16x16x32_bf16 v[76:79], a[28:31], a[248:251], v[76:79]
    v_add_f32 v126, v126, v190
    v_add_f32 v127, v127, v191
    v_mfma_f32_16x16x32_bf16 v[80:83], a[16:19], a[252:255], v[80:83]
    buffer_store_dwordx4 v[124:127], v1, s[52:55], s100 offen offset:3072 sc1
    v_mfma_f32_16x16x32_bf16 v[84:87], a[20:23], a[252:255], v[84:87]
    v_mfma_f32_16x16x32_bf16 v[88:91], a[24:27], a[252:255], v[88:91]
    v_mfma_f32_16x16x32_bf16 v[92:95], a[28:31], a[252:255], v[92:95]
    s_waitcnt lgkmcnt(0)
    v_mfma_f32_16x16x32_bf16 v[32:35], a[32:35], a[224:227], v[32:35]
    s_barrier
    v_mfma_f32_16x16x32_bf16 v[36:39], a[36:39], a[224:227], v[36:39]
    s_waitcnt vmcnt(12)
    v_sub_f32 v2, 1.0, v4
    v_mfma_f32_16x16x32_bf16 v[40:43], a[40:43], a[224:227], v[40:43]
    ds_read_b64_tr_b16 a[0:1], v192 offset:0
    v_mfma_f32_16x16x32_bf16 v[44:47], a[44:47], a[224:227], v[44:47]
    ds_read_b64_tr_b16 a[2:3], v192 offset:4096
    v_mfma_f32_16x16x32_bf16 v[48:51], a[32:35], a[228:231], v[48:51]
    v_add_u32 v30, 0, v17
    v_mfma_f32_16x16x32_bf16 v[52:55], a[36:39], a[228:231], v[52:55]
    ds_read_b64_tr_b16 a[4:5], v193 offset:0
    v_mfma_f32_16x16x32_bf16 v[56:59], a[40:43], a[228:231], v[56:59]
    ds_read_b64_tr_b16 a[6:7], v193 offset:4096
    v_mfma_f32_16x16x32_bf16 v[60:63], a[44:47], a[228:231], v[60:63]
    v_cvt_pk_bf16_f32 v2, v2, v2
    v_mfma_f32_16x16x32_bf16 v[64:67], a[32:35], a[232:235], v[64:67]
    ds_read_b64_tr_b16 a[8:9], v194 offset:0
    v_mfma_f32_16x16x32_bf16 v[68:71], a[36:39], a[232:235], v[68:71]
    ds_read_b64_tr_b16 a[10:11], v194 offset:4096
    v_mfma_f32_16x16x32_bf16 v[72:75], a[40:43], a[232:235], v[72:75]
    v_and_b32 v31, 1, v30
    v_mfma_f32_16x16x32_bf16 v[76:79], a[44:47], a[232:235], v[76:79]
    ds_read_b64_tr_b16 a[12:13], v195 offset:0
    v_mfma_f32_16x16x32_bf16 v[80:83], a[32:35], a[236:239], v[80:83]
    ds_read_b64_tr_b16 a[14:15], v195 offset:4096
    v_mfma_f32_16x16x32_bf16 v[84:87], a[36:39], a[236:239], v[84:87]
    v_lshlrev_b32 v2, 16, v2
    v_mfma_f32_16x16x32_bf16 v[88:91], a[40:43], a[236:239], v[88:91]
    ds_read_b64_tr_b16 a[16:17], v192 offset:16384
    v_mfma_f32_16x16x32_bf16 v[92:95], a[44:47], a[236:239], v[92:95]
    ds_read_b64_tr_b16 a[18:19], v192 offset:20480
    v_mfma_f32_16x16x32_bf16 v[32:35], a[48:51], a[208:211], v[32:35]
    v_cmp_eq_u32 vcc, 1, v31
    v_mfma_f32_16x16x32_bf16 v[36:39], a[52:55], a[208:211], v[36:39]
    ds_read_b64_tr_b16 a[20:21], v193 offset:16384
    v_mfma_f32_16x16x32_bf16 v[40:43], a[56:59], a[208:211], v[40:43]
    ds_read_b64_tr_b16 a[22:23], v193 offset:20480
    v_mfma_f32_16x16x32_bf16 v[44:47], a[60:63], a[208:211], v[44:47]
    v_lshrrev_b32 v31, 16, v4
    v_mfma_f32_16x16x32_bf16 v[48:51], a[48:51], a[212:215], v[48:51]
    ds_read_b64_tr_b16 a[24:25], v194 offset:16384
    v_mfma_f32_16x16x32_bf16 v[52:55], a[52:55], a[212:215], v[52:55]
    ds_read_b64_tr_b16 a[26:27], v194 offset:20480
    v_mfma_f32_16x16x32_bf16 v[56:59], a[56:59], a[212:215], v[56:59]
    v_and_b32 v4, 0xffff0000, v4
    v_mfma_f32_16x16x32_bf16 v[60:63], a[60:63], a[212:215], v[60:63]
    ds_read_b64_tr_b16 a[28:29], v195 offset:16384
    v_mfma_f32_16x16x32_bf16 v[64:67], a[48:51], a[216:219], v[64:67]
    ds_read_b64_tr_b16 a[30:31], v195 offset:20480
    v_mfma_f32_16x16x32_bf16 v[68:71], a[52:55], a[216:219], v[68:71]
    v_ashrrev_i32 v30, 1, v30
    v_mfma_f32_16x16x32_bf16 v[72:75], a[56:59], a[216:219], v[72:75]
    v_cndmask_b32 v4, v31, v4, vcc
    v_mfma_f32_16x16x32_bf16 v[76:79], a[60:63], a[216:219], v[76:79]
    v_cmp_eq_u32 vcc, 0, v30
    v_mfma_f32_16x16x32_bf16 v[80:83], a[48:51], a[220:223], v[80:83]
    v_cndmask_b32 v248, 0, v4, vcc
    v_mfma_f32_16x16x32_bf16 v[84:87], a[52:55], a[220:223], v[84:87]
    v_cmp_eq_u32 vcc, 1, v30
    v_mfma_f32_16x16x32_bf16 v[88:91], a[56:59], a[220:223], v[88:91]
    v_cndmask_b32 v249, 0, v4, vcc
    v_mfma_f32_16x16x32_bf16 v[92:95], a[60:63], a[220:223], v[92:95]
    v_cmp_eq_u32 vcc, 2, v30
    s_waitcnt lgkmcnt(0)
    v_mfma_f32_16x16x32_bf16 v[32:35], a[0:3], a[192:195], v[32:35]
    v_mfma_f32_16x16x32_bf16 v[36:39], a[4:7], a[192:195], v[36:39]
    v_cndmask_b32 v250, 0, v4, vcc
    v_mfma_f32_16x16x32_bf16 v[40:43], a[8:11], a[192:195], v[40:43]
    ds_read_b64_tr_b16 a[32:33], v192 offset:32768
    v_mfma_f32_16x16x32_bf16 v[44:47], a[12:15], a[192:195], v[44:47]
    ds_read_b64_tr_b16 a[34:35], v192 offset:36864
    v_mfma_f32_16x16x32_bf16 v[48:51], a[0:3], a[196:199], v[48:51]
    v_cmp_eq_u32 vcc, 3, v30
    v_mfma_f32_16x16x32_bf16 v[52:55], a[4:7], a[196:199], v[52:55]
    ds_read_b64_tr_b16 a[36:37], v193 offset:32768
    v_mfma_f32_16x16x32_bf16 v[56:59], a[8:11], a[196:199], v[56:59]
    ds_read_b64_tr_b16 a[38:39], v193 offset:36864
    v_mfma_f32_16x16x32_bf16 v[60:63], a[12:15], a[196:199], v[60:63]
    v_cndmask_b32 v251, 0, v4, vcc
    v_mfma_f32_16x16x32_bf16 v[64:67], a[0:3], a[200:203], v[64:67]
    ds_read_b64_tr_b16 a[40:41], v194 offset:32768
    v_mfma_f32_16x16x32_bf16 v[68:71], a[4:7], a[200:203], v[68:71]
    ds_read_b64_tr_b16 a[42:43], v194 offset:36864
    v_mfma_f32_16x16x32_bf16 v[72:75], a[8:11], a[200:203], v[72:75]
    v_sub_f32 v3, 1.0, v5
    v_mfma_f32_16x16x32_bf16 v[76:79], a[12:15], a[200:203], v[76:79]
    ds_read_b64_tr_b16 a[44:45], v195 offset:32768
    v_mfma_f32_16x16x32_bf16 v[80:83], a[0:3], a[204:207], v[80:83]
    ds_read_b64_tr_b16 a[46:47], v195 offset:36864
    v_mfma_f32_16x16x32_bf16 v[84:87], a[4:7], a[204:207], v[84:87]
    v_add_u32 v30, 16, v17
    v_mfma_f32_16x16x32_bf16 v[88:91], a[8:11], a[204:207], v[88:91]
    ds_read_b64_tr_b16 a[48:49], v192 offset:49152
    v_mfma_f32_16x16x32_bf16 v[92:95], a[12:15], a[204:207], v[92:95]
    ds_read_b64_tr_b16 a[50:51], v192 offset:53248
    v_mfma_f32_16x16x32_bf16 v[32:35], a[16:19], a[176:179], v[32:35]
    v_cvt_pk_bf16_f32 v3, v3, v3
    v_mfma_f32_16x16x32_bf16 v[36:39], a[20:23], a[176:179], v[36:39]
    ds_read_b64_tr_b16 a[52:53], v193 offset:49152
    v_mfma_f32_16x16x32_bf16 v[40:43], a[24:27], a[176:179], v[40:43]
    ds_read_b64_tr_b16 a[54:55], v193 offset:53248
    v_mfma_f32_16x16x32_bf16 v[44:47], a[28:31], a[176:179], v[44:47]
    v_and_b32 v31, 1, v30
    v_mfma_f32_16x16x32_bf16 v[48:51], a[16:19], a[180:183], v[48:51]
    ds_read_b64_tr_b16 a[56:57], v194 offset:49152
    v_mfma_f32_16x16x32_bf16 v[52:55], a[20:23], a[180:183], v[52:55]
    ds_read_b64_tr_b16 a[58:59], v194 offset:53248
    v_mfma_f32_16x16x32_bf16 v[56:59], a[24:27], a[180:183], v[56:59]
    v_lshlrev_b32 v3, 16, v3
    v_mfma_f32_16x16x32_bf16 v[60:63], a[28:31], a[180:183], v[60:63]
    ds_read_b64_tr_b16 a[60:61], v195 offset:49152
    v_mfma_f32_16x16x32_bf16 v[64:67], a[16:19], a[184:187], v[64:67]
    ds_read_b64_tr_b16 a[62:63], v195 offset:53248
    v_mfma_f32_16x16x32_bf16 v[68:71], a[20:23], a[184:187], v[68:71]
    v_cmp_eq_u32 vcc, 1, v31
    v_mfma_f32_16x16x32_bf16 v[72:75], a[24:27], a[184:187], v[72:75]
    v_lshrrev_b32 v31, 16, v5
    v_mfma_f32_16x16x32_bf16 v[76:79], a[28:31], a[184:187], v[76:79]
    v_and_b32 v5, 0xffff0000, v5
    v_mfma_f32_16x16x32_bf16 v[80:83], a[16:19], a[188:191], v[80:83]
    v_ashrrev_i32 v30, 1, v30
    v_mfma_f32_16x16x32_bf16 v[84:87], a[20:23], a[188:191], v[84:87]
    v_cndmask_b32 v5, v31, v5, vcc
    v_mfma_f32_16x16x32_bf16 v[88:91], a[24:27], a[188:191], v[88:91]
    v_cmp_eq_u32 vcc, 0, v30
    v_mfma_f32_16x16x32_bf16 v[92:95], a[28:31], a[188:191], v[92:95]
    v_cndmask_b32 v252, 0, v5, vcc
    s_waitcnt lgkmcnt(0)
    v_mfma_f32_16x16x32_bf16 v[64:67], a[32:35], a[168:171], v[64:67]
    v_mfma_f32_16x16x32_bf16 v[68:71], a[36:39], a[168:171], v[68:71]
    v_cmp_eq_u32 vcc, 1, v30
    v_mfma_f32_16x16x32_bf16 v[72:75], a[40:43], a[168:171], v[72:75]
    v_cndmask_b32 v253, 0, v5, vcc
    v_mfma_f32_16x16x32_bf16 v[76:79], a[44:47], a[168:171], v[76:79]
    v_cmp_eq_u32 vcc, 2, v30
    v_mfma_f32_16x16x32_bf16 v[80:83], a[32:35], a[172:175], v[80:83]
    v_cndmask_b32 v254, 0, v5, vcc
    v_mfma_f32_16x16x32_bf16 v[84:87], a[36:39], a[172:175], v[84:87]
    v_cmp_eq_u32 vcc, 3, v30
    v_mfma_f32_16x16x32_bf16 v[88:91], a[40:43], a[172:175], v[88:91]
    v_cndmask_b32 v255, 0, v5, vcc
    v_mfma_f32_16x16x32_bf16 v[92:95], a[44:47], a[172:175], v[92:95]
    v_mfma_f32_16x16x32_bf16 v[64:67], a[48:51], a[136:139], v[64:67]
    s_waitcnt vmcnt(0)
    s_mov_b64 exec, 1
    global_store_dword v8, v25, s[56:57] sc1
    s_mov_b64 exec, -1
    v_mfma_f32_16x16x32_bf16 v[68:71], a[52:55], a[136:139], v[68:71]
    v_mfma_f32_16x16x32_bf16 v[72:75], a[56:59], a[136:139], v[72:75]
    v_mfma_f32_16x16x32_bf16 v[76:79], a[60:63], a[136:139], v[76:79]
    v_mfma_f32_16x16x32_bf16 v[80:83], a[48:51], a[140:143], v[80:83]
    v_mfma_f32_16x16x32_bf16 v[84:87], a[52:55], a[140:143], v[84:87]
    v_mfma_f32_16x16x32_bf16 v[88:91], a[56:59], a[140:143], v[88:91]
    v_mfma_f32_16x16x32_bf16 v[92:95], a[60:63], a[140:143], v[92:95]
    v_mfma_f32_16x16x32_bf16 v[32:35], a[32:35], a[160:163], v[32:35]
    v_mfma_f32_16x16x32_bf16 v[36:39], a[36:39], a[160:163], v[36:39]
    ds_write_b128 v6, v[64:67] offset:0
    v_mfma_f32_16x16x32_bf16 v[40:43], a[40:43], a[160:163], v[40:43]
    v_mfma_f32_16x16x32_bf16 v[44:47], a[44:47], a[160:163], v[44:47]
    ds_write_b128 v6, v[68:71] offset:1024
    v_mfma_f32_16x16x32_bf16 v[48:51], a[32:35], a[164:167], v[48:51]
    v_mfma_f32_16x16x32_bf16 v[52:55], a[36:39], a[164:167], v[52:55]
    ds_write_b128 v6, v[72:75] offset:2048
    v_mfma_f32_16x16x32_bf16 v[56:59], a[40:43], a[164:167], v[56:59]
    v_mfma_f32_16x16x32_bf16 v[60:63], a[44:47], a[164:167], v[60:63]
    ds_write_b128 v6, v[76:79] offset:3072
    v_mfma_f32_16x16x32_bf16 v[32:35], a[48:51], a[128:131], v[32:35]
    v_mfma_f32_16x16x32_bf16 v[36:39], a[52:55], a[128:131], v[36:39]
    ds_write_b128 v6, v[80:83] offset:4096
    v_mfma_f32_16x16x32_bf16 v[40:43], a[56:59], a[128:131], v[40:43]
    v_mfma_f32_16x16x32_bf16 v[44:47], a[60:63], a[128:131], v[44:47]
    ds_write_b128 v6, v[84:87] offset:5120
    v_mfma_f32_16x16x32_bf16 v[48:51], a[48:51], a[132:135], v[48:51]
    v_mfma_f32_16x16x32_bf16 v[52:55], a[52:55], a[132:135], v[52:55]
    ds_write_b128 v6, v[88:91] offset:6144
    v_mfma_f32_16x16x32_bf16 v[56:59], a[56:59], a[132:135], v[56:59]
    global_load_dword v22, v9, s[56:57] sc1
    v_mfma_f32_16x16x32_bf16 v[60:63], a[60:63], a[132:135], v[60:63]
    ds_write_b128 v6, v[92:95] offset:7168
    s_waitcnt lgkmcnt(0)
    s_barrier
    ds_read_b128 v[160:163], v7 offset:0
    ds_read_b128 v[164:167], v7 offset:1024
    ds_read_b128 v[168:171], v7 offset:2048
    ds_read_b128 v[172:175], v7 offset:3072
    ds_read_b128 v[176:179], v7 offset:4096
    ds_read_b128 v[180:183], v7 offset:5120
    ds_read_b128 v[184:187], v7 offset:6144
    ds_read_b128 v[188:191], v7 offset:7168
    s_waitcnt vmcnt(0)
    v_readfirstlane_b32 s48, v22
    s_mov_b32 s49, 0
    s_cmp_ge_u32 s48, 1
    s_cbranch_scc1 fused_kernel_sp_go
    fused_kernel_sp:
    s_sleep 4
    global_load_dword v22, v9, s[56:57] sc1
    s_add_u32 s49, s49, 1
    s_waitcnt vmcnt(0)
    v_readfirstlane_b32 s48, v22
    s_cmp_ge_u32 s49, 0x40000
    s_cbranch_scc1 fused_kernel_sp_go
    s_cmp_lt_u32 s48, 1
    s_cbranch_scc1 fused_kernel_sp
    fused_kernel_sp_go:
    buffer_load_dwordx4 v[96:99], v1, s[52:55], s101 offen offset:0 sc1
    buffer_load_dwordx4 v[100:103], v1, s[52:55], s101 offen offset:1024 sc1
    buffer_load_dwordx4 v[104:107], v1, s[52:55], s101 offen offset:2048 sc1
    buffer_load_dwordx4 v[108:111], v1, s[52:55], s101 offen offset:3072 sc1
    s_add_u32 s101, s101, 4096
    buffer_load_dwordx4 v[112:115], v1, s[52:55], s101 offen offset:0 sc1
    buffer_load_dwordx4 v[116:119], v1, s[52:55], s101 offen offset:1024 sc1
    buffer_load_dwordx4 v[120:123], v1, s[52:55], s101 offen offset:2048 sc1
    buffer_load_dwordx4 v[124:127], v1, s[52:55], s101 offen offset:3072 sc1
    s_waitcnt lgkmcnt(0)
    v_add_f32 v32, v32, v160
    v_add_f32 v33, v33, v161
    v_add_f32 v34, v34, v162
    v_add_f32 v35, v35, v163
    v_mul_f32 v32, v2, v32
    v_mul_f32 v33, v2, v33
    v_mul_f32 v34, v2, v34
    v_mul_f32 v35, v2, v35
    v_add_f32 v36, v36, v164
    v_add_f32 v37, v37, v165
    v_add_f32 v38, v38, v166
    v_add_f32 v39, v39, v167
    v_mul_f32 v36, v2, v36
    v_mul_f32 v37, v2, v37
    v_mul_f32 v38, v2, v38
    v_mul_f32 v39, v2, v39
    v_add_f32 v40, v40, v168
    v_add_f32 v41, v41, v169
    v_add_f32 v42, v42, v170
    v_add_f32 v43, v43, v171
    v_mul_f32 v40, v2, v40
    v_mul_f32 v41, v2, v41
    v_mul_f32 v42, v2, v42
    v_mul_f32 v43, v2, v43
    v_add_f32 v44, v44, v172
    v_add_f32 v45, v45, v173
    v_add_f32 v46, v46, v174
    v_add_f32 v47, v47, v175
    v_mul_f32 v44, v2, v44
    v_mul_f32 v45, v2, v45
    v_mul_f32 v46, v2, v46
    v_mul_f32 v47, v2, v47
    v_add_f32 v48, v48, v176
    v_add_f32 v49, v49, v177
    v_add_f32 v50, v50, v178
    v_add_f32 v51, v51, v179
    v_mul_f32 v48, v3, v48
    v_mul_f32 v49, v3, v49
    v_mul_f32 v50, v3, v50
    v_mul_f32 v51, v3, v51
    v_add_f32 v52, v52, v180
    v_add_f32 v53, v53, v181
    v_add_f32 v54, v54, v182
    v_add_f32 v55, v55, v183
    v_mul_f32 v52, v3, v52
    v_mul_f32 v53, v3, v53
    v_mul_f32 v54, v3, v54
    v_mul_f32 v55, v3, v55
    v_add_f32 v56, v56, v184
    v_add_f32 v57, v57, v185
    v_add_f32 v58, v58, v186
    v_add_f32 v59, v59, v187
    v_mul_f32 v56, v3, v56
    v_mul_f32 v57, v3, v57
    v_mul_f32 v58, v3, v58
    v_mul_f32 v59, v3, v59
    v_add_f32 v60, v60, v188
    v_add_f32 v61, v61, v189
    v_add_f32 v62, v62, v190
    v_add_f32 v63, v63, v191
    v_mul_f32 v60, v3, v60
    v_mul_f32 v61, v3, v61
    v_mul_f32 v62, v3, v62
    v_mul_f32 v63, v3, v63
    s_nop 1
    v_mfma_f32_16x16x32_bf16 v[32:35], v[224:227], v[248:251], v[32:35]
    v_mfma_f32_16x16x32_bf16 v[36:39], v[228:231], v[248:251], v[36:39]
    v_mfma_f32_16x16x32_bf16 v[40:43], v[232:235], v[248:251], v[40:43]
    v_mfma_f32_16x16x32_bf16 v[44:47], v[236:239], v[248:251], v[44:47]
    v_mfma_f32_16x16x32_bf16 v[48:51], v[224:227], v[252:255], v[48:51]
    v_mfma_f32_16x16x32_bf16 v[52:55], v[228:231], v[252:255], v[52:55]
    v_mfma_f32_16x16x32_bf16 v[56:59], v[232:235], v[252:255], v[56:59]
    v_mfma_f32_16x16x32_bf16 v[60:63], v[236:239], v[252:255], v[60:63]
    s_nop 7
    s_waitcnt vmcnt(6)
    v_fma_f32 v32, v96, v2, v32
    v_fma_f32 v33, v97, v2, v33
    v_fma_f32 v34, v98, v2, v34
    v_fma_f32 v35, v99, v2, v35
    v_fma_f32 v36, v100, v2, v36
    v_fma_f32 v37, v101, v2, v37
    v_fma_f32 v38, v102, v2, v38
    v_fma_f32 v39, v103, v2, v39
    v_cvt_pk_bf16_f32 v160, v32, v33
    v_cvt_pk_bf16_f32 v161, v34, v35
    v_cvt_pk_bf16_f32 v162, v36, v37
    v_cvt_pk_bf16_f32 v163, v38, v39
    s_nop 1
    v_permlane16_swap_b32 v160, v162
    v_permlane16_swap_b32 v161, v163
    buffer_store_dwordx4 v[160:163], v11, s[88:91], s25 offen offset:0
    s_waitcnt vmcnt(5)
    v_fma_f32 v40, v104, v2, v40
    v_fma_f32 v41, v105, v2, v41
    v_fma_f32 v42, v106, v2, v42
    v_fma_f32 v43, v107, v2, v43
    v_fma_f32 v44, v108, v2, v44
    v_fma_f32 v45, v109, v2, v45
    v_fma_f32 v46, v110, v2, v46
    v_fma_f32 v47, v111, v2, v47
    v_cvt_pk_bf16_f32 v164, v40, v41
    v_cvt_pk_bf16_f32 v165, v42, v43
    v_cvt_pk_bf16_f32 v166, v44, v45
    v_cvt_pk_bf16_f32 v167, v46, v47
    s_nop 1
    v_permlane16_swap_b32 v164, v166
    v_permlane16_swap_b32 v165, v167
    buffer_store_dwordx4 v[164:167], v11, s[88:91], s25 offen offset:64
    s_waitcnt vmcnt(4)
    v_fma_f32 v48, v112, v3, v48
    v_fma_f32 v49, v113, v3, v49
    v_fma_f32 v50, v114, v3, v50
    v_fma_f32 v51, v115, v3, v51
    v_fma_f32 v52, v116, v3, v52
    v_fma_f32 v53, v117, v3, v53
    v_fma_f32 v54, v118, v3, v54
    v_fma_f32 v55, v119, v3, v55
    v_cvt_pk_bf16_f32 v168, v48, v49
    v_cvt_pk_bf16_f32 v169, v50, v51
    v_cvt_pk_bf16_f32 v170, v52, v53
    v_cvt_pk_bf16_f32 v171, v54, v55
    s_nop 1
    v_permlane16_swap_b32 v168, v170
    v_permlane16_swap_b32 v169, v171
    buffer_store_dwordx4 v[168:171], v11, s[88:91], s26 offen offset:0
    s_waitcnt vmcnt(3)
    v_fma_f32 v56, v120, v3, v56
    v_fma_f32 v57, v121, v3, v57
    v_fma_f32 v58, v122, v3, v58
    v_fma_f32 v59, v123, v3, v59
    v_fma_f32 v60, v124, v3, v60
    v_fma_f32 v61, v125, v3, v61
    v_fma_f32 v62, v126, v3, v62
    v_fma_f32 v63, v127, v3, v63
    v_cvt_pk_bf16_f32 v172, v56, v57
    v_cvt_pk_bf16_f32 v173, v58, v59
    v_cvt_pk_bf16_f32 v174, v60, v61
    v_cvt_pk_bf16_f32 v175, v62, v63
    s_nop 1
    v_permlane16_swap_b32 v172, v174
    v_permlane16_swap_b32 v173, v175
    buffer_store_dwordx4 v[172:175], v11, s[88:91], s26 offen offset:64
fused_kernel_end:
    s_endpgm
    fused_kernel_late:
    s_waitcnt vmcnt(0)
    v_mov_b32 v24, s51
    v_mov_b32 v25, 1
    s_mov_b64 exec, 1
    global_atomic_add v24, v25, s[56:57] sc1
    s_mov_b64 exec, -1
    s_mov_b32 s51, 0
    s_mov_b32 s14, 8388608
    s_mov_b32 s18, 4194320
    fused_kernel_late2:

    global_load_dword v22, v23, s[56:57] sc1
    s_waitcnt vmcnt(0)
    v_readfirstlane_b32 s48, v22
    s_mov_b32 s49, 0
    s_cmp_ge_u32 s48, 32
    s_cbranch_scc1 fused_kernel_sb_go
    fused_kernel_sb:
    s_sleep 4
    global_load_dword v22, v23, s[56:57] sc1
    s_add_u32 s49, s49, 1
    s_waitcnt vmcnt(0)
    v_readfirstlane_b32 s48, v22
    s_cmp_ge_u32 s49, 0x40000
    s_cbranch_scc1 fused_kernel_sb_go
    s_cmp_lt_u32 s48, 32
    s_cbranch_scc1 fused_kernel_sb
    fused_kernel_sb_go:
    s_lshl_b32 s50, s30, 12
    buffer_load_dwordx2 v[44:45], v40, s[12:15], 0 offen offset:128 sc1
    buffer_load_dwordx2 v[46:47], v40, s[12:15], 0 offen sc1
    buffer_load_dwordx2 v[48:49], v41, s[12:15], 0 offen sc1
    buffer_load_dwordx2 v[50:51], v42, s[12:15], 0 offen sc1
    buffer_load_dwordx4 v[52:55], v43, s[12:15], 0 offen sc1
    buffer_load_dwordx4 a[224:227], v1, s[16:19], s50 offen offset:16 sc1
    buffer_load_dwordx4 a[228:231], v1, s[16:19], s50 offen offset:1040 sc1
    buffer_load_dwordx4 a[232:235], v1, s[16:19], s50 offen offset:2064 sc1
    buffer_load_dwordx4 a[236:239], v1, s[16:19], s50 offen offset:3088 sc1
    buffer_load_dwordx4 a[240:243], v1, s[16:19], s50 offen offset:12 sc1
    buffer_load_dwordx4 a[244:247], v1, s[16:19], s50 offen offset:1036 sc1
    buffer_load_dwordx4 a[248:251], v1, s[16:19], s50 offen offset:2060 sc1
    buffer_load_dwordx4 a[252:255], v1, s[16:19], s50 offen offset:3084 sc1
    s_waitcnt vmcnt(0)
    s_branch fused_kernel_p2
fused_kernel_aux:
    s_cmp_ge_u32 s2, 256
    s_cbranch_scc1 fused_kernel_end2
    s_sub_u32 s3, s2, 224
    s_getpc_b64 s[80:81]
    fused_kernel_pc2:
    v_lshlrev_b32 v250, 6, v0
    v_min_u32 v250, fused_kernel_end2-fused_kernel_pc2, v250
    v_mov_b32 v251, s81
    v_add_co_u32 v250, vcc, s80, v250
    v_addc_co_u32 v251, vcc, 0, v251, vcc
    global_load_dword v57, v[250:251], off

    s_load_dwordx2 s[92:93], s[0:1], 96
    s_load_dwordx4 s[96:99], s[0:1], 112
    s_load_dwordx8 s[40:47], s[0:1], 8
    s_load_dwordx8 s[48:55], s[0:1], 40
    s_load_dwordx2 s[4:5], s[0:1], 0
    s_load_dwordx4 s[88:91], s[0:1], 96
    s_load_dwordx2 s[6:7], s[0:1], 128
    v_lshrrev_b32 v1, 6, v0
    v_and_b32 v0, 63, v0
    s_lshl_b32 s25, s3, 2
    v_readfirstlane_b32 s24, v1
    v_lshlrev_b32 v10, 2, v0
    v_lshlrev_b32 v12, 4, v0
    s_add_u32 s25, s25, s24
    s_mul_i32 s29, s25, -6
    s_add_u32 s29, s29, 890
    s_add_u32 s38, s25, 896
    s_lshl_b32 s38, s38, 1
    s_mul_i32 s25, s25, 7
    s_mul_i32 s26, s24, 36864
    s_lshl_b32 s36, s25, 8
    s_lshl_b32 s37, s25, 1
    s_lshl_b32 s28, s25, 11
    s_lshl_b32 s29, s29, 8
    v_add_u32 v10, s36, v10
    v_and_b32 v11, 7, v0
    v_lshl_add_u32 v11, v11, 1, s37
    v_writelane_b32 v11, s38, 7
    s_mov_b32 s27, 0
    s_mov_b32 s56, 1069066811
    s_mov_b32 s57, 1042479491

    v_lshrrev_b32 v28, 2, v0
    v_lshlrev_b32 v20, 11, v28
    v_and_b32 v29, 3, v0
    v_lshl_add_u32 v20, v29, 4, v20
    s_lshl_b32 s30, s3, 17
    s_lshl_b32 s36, s24, 9
    s_add_u32 s30, s30, s36
    s_mov_b32 s32, s36
    v_lshrrev_b32 v26, 4, v0
    v_and_b32 v27, 15, v0
    v_lshlrev_b32 v24, 4, v26
    s_waitcnt lgkmcnt(0)

    global_load_ushort v8, v11, s[52:53]
    global_load_ushort v9, v11, s[54:55]
    global_load_dword v2, v10, s[40:41]
    global_load_dword v3, v10, s[42:43]
    global_load_dword v4, v10, s[44:45]
    global_load_dword v5, v10, s[46:47]
    global_load_dword v6, v10, s[48:49]
    global_load_dword v7, v10, s[50:51]
    s_mov_b32 s8, s4
    s_and_b32 s9, s5, 0xffff
    s_mov_b32 s10, 0x400000
    s_mov_b32 s11, 0x20000
    s_mov_b32 s20, s90
    s_and_b32 s21, s91, 0xffff
    s_mov_b32 s22, 0x800
    s_mov_b32 s23, 0x20000
    s_add_u32 m0, s26, 32768
    s_add_u32 s33, s30, 31744
    buffer_load_dwordx4 v20, s[8:11], s30 offen lds
    s_add_u32 s34, s30, 63488
    buffer_load_dwordx4 v20, s[8:11], s33 offen offset:1024 lds
    s_add_u32 s33, s30, 95232
    buffer_load_dwordx4 v20, s[8:11], s34 offen offset:2048 lds
    s_add_u32 s30, s30, 64
    buffer_load_dwordx4 v20, s[8:11], s33 offen offset:3072 lds
    buffer_load_dwordx4 v[60:63], v24, s[20:23], s32 offen
    s_add_u32 s32, s32, 64
    s_add_u32 s4, s6, 58720256
    s_addc_u32 s5, s7, 0
    s_mov_b32 s12, s4
    s_and_b32 s13, s5, 0xffff
    s_mov_b32 s14, 0x800000
    s_mov_b32 s15, 0x20000
    s_add_u32 s4, s6, 25165824
    s_addc_u32 s5, s7, 0
    s_mov_b32 s16, s4
    s_and_b32 s17, s5, 0xffff
    s_mov_b32 s18, 0x400000
    s_mov_b32 s19, 0x20000
    s_add_u32 s4, s6, 20971520
    s_addc_u32 s5, s7, 0
    s_mov_b32 s84, s4
    s_and_b32 s85, s5, 0xffff
    s_mov_b32 s86, 0x2000
    s_mov_b32 s87, 0x20000
    s_add_u32 s4, s6, 22020096
    s_addc_u32 s5, s7, 0
    s_lshl_b32 s36, s3, 2
    s_add_u32 s36, s36, s24
    s_lshl_b32 s37, s36, 10
    v_add_u32 v28, s37, v12
    v_mov_b32 v88, 0
    v_mov_b32 v89, 0
    v_mov_b32 v90, 0
    v_mov_b32 v91, 0
    global_store_dwordx4 v28, v[88:91], s[4:5] sc1
    s_mul_i32 s37, s36, 57344
    v_lshlrev_b32 v25, 7, v0
    s_add_u32 s88, s88, s37
    s_addc_u32 s89, s89, 0
    s_and_b32 s89, s89, 0xffff
    s_mov_b32 s90, 57344
    s_mov_b32 s91, 0x20000
    s_movk_i32 s95, 0x2000

    v_lshlrev_b32 v28, 3, v0
    v_add_u32 v13, s26, v28
    v_and_b32 v29, 7, v27
    v_lshlrev_b32 v29, 1, v29
    v_xor_b32 v29, v29, v26
    v_lshlrev_b32 v28, 9, v27
    v_lshl_add_u32 v28, v29, 4, v28
    v_add_u32 v14, s26, v28
    v_xor_b32 v38, 64, v14
    v_xor_b32 v43, 128, v14
    v_xor_b32 v59, 192, v14
    s_add_u32 s39, s26, 30736
    v_lshrrev_b32 v28, 1, v26
    v_lshlrev_b32 v28, 8, v28
    v_and_b32 v29, 1, v26
    v_lshl_add_u32 v28, v29, 3, v28
    v_lshl_add_u32 v28, v27, 4, v28
    v_add_u32 v15, s39, v28
    v_lshlrev_b32 v28, 7, v26
    v_add_u32 v28, s39, v28
    v_cmp_gt_u32 vcc, 2, v26
    v_lshlrev_b32 v29, 2, v27
    v_lshlrev_b32 v17, 3, v27
    v_cndmask_b32 v29, v29, v17, vcc
    v_add_u32 v16, v28, v29
    v_add_u32 v16, 512, v16
    v_cndmask_b32 v29, 64, 4, vcc
    v_add_u32 v17, v16, v29
    v_and_b32 v29, 1, v26
    v_lshlrev_b32 v29, 8, v29
    v_lshl_add_u32 v18, v27, 1, v29
    v_lshrrev_b32 v29, 1, v26
    v_lshl_add_u32 v18, v29, 5, v18
    v_add_u32 v18, s39, v18
    v_add_u32 v18, 1024, v18
    v_cmp_eq_u32 vcc, 0, v0
    v_mov_b32 v28, s26
    v_mov_b32 v29, 0
    v_cndmask_b32 v19, 0, -1, vcc
    ds_write_b32 v28, v29 offset:30732
    v_mov_b32 v136, 0x3f80
    v_mov_b32 v137, 0x3f80
    ds_write_b64 v13, v[136:137] offset:8192

    s_add_u32 s36, s26, 32768
    v_bfe_u32 v28, v0, 2, 2
    v_lshl_add_u32 v28, v26, 3, v28
    v_lshlrev_b32 v28, 6, v28
    v_and_b32 v29, 1, v0
    v_lshl_add_u32 v28, v29, 3, v28
    v_bfe_u32 v29, v0, 1, 1
    v_lshl_add_u32 v28, v29, 11, v28
    v_add_u32 v21, s36, v28
    v_lshl_add_u32 v28, v27, 6, v24
    v_add_u32 v22, s36, v28
    v_and_b32 v28, 7, v0
    v_lshl_add_u32 v23, v28, 12, v24
    v_bfe_u32 v28, v0, 3, 1
    v_lshl_add_u32 v23, v28, 6, v23
    s_lshl_b32 s31, s24, 20
    s_lshl_b32 s36, s3, 7
    s_add_u32 s31, s31, s36

    s_getpc_b64 s[88:89]
    fused_kernel_pc:
    s_sub_u32 s88, s88, fused_kernel_pc-fused_kernel_loop
    s_subb_u32 s89, s89, 0
    s_lshr_b32 s36, s3, 3
    s_lshl_b32 s36, s36, 2
    s_add_u32 s36, s36, s24
    s_lshl_b32 s36, s36, 12
    v_lshl_add_u32 v28, v0, 6, s36
    v_min_u32 v28, fused_kernel_aux-fused_kernel_loop, v28
    v_mov_b32 v105, s89
    v_add_co_u32 v104, vcc, s88, v28
    v_addc_co_u32 v105, vcc, 0, v105, vcc

    v_xor_b32 v30, 0, v13
    v_xor_b32 v31, 32, v13
    v_xor_b32 v32, 64, v13
    v_xor_b32 v33, 96, v13
    v_xor_b32 v34, 128, v13
    v_xor_b32 v35, 160, v13
    v_xor_b32 v36, 192, v13
    v_xor_b32 v37, 224, v13
    v_accvgpr_write_b32 a128, 0
    v_accvgpr_write_b32 a129, 0
    v_accvgpr_write_b32 a130, 0
    v_accvgpr_write_b32 a131, 0
    v_accvgpr_write_b32 a132, 0
    v_accvgpr_write_b32 a133, 0
    v_accvgpr_write_b32 a134, 0
    v_accvgpr_write_b32 a135, 0
    v_accvgpr_write_b32 a136, 0
    v_accvgpr_write_b32 a137, 0
    v_accvgpr_write_b32 a138, 0
    v_accvgpr_write_b32 a139, 0
    v_accvgpr_write_b32 a140, 0
    v_accvgpr_write_b32 a141, 0
    v_accvgpr_write_b32 a142, 0
    v_accvgpr_write_b32 a143, 0
    v_add_u32 v39, s26, v12
    s_waitcnt vmcnt(12)
    v_lshlrev_b32 v54, 16, v8
    v_mul_f32 v54, s56, v54
    v_exp_f32 v54, v54
    v_lshlrev_b32 v9, 16, v9
    v_cvt_pk_bf16_f32 v54, v54, v54
    v_lshlrev_b32 v54, 16, v54
    v_mul_f32 v55, s56, v54
    v_mul_f32 v56, s57, v54

    s_waitcnt vmcnt(6)
    v_readlane_b32 s59, v55, s27
    v_readlane_b32 s82, v56, s27
    v_readlane_b32 s58, v54, s27
    v_readlane_b32 s83, v9, s27
    v_lshlrev_b32 v152, 16, v2
    v_and_b32 v154, 0xffff0000, v2
    v_lshlrev_b32 v153, 16, v3
    v_and_b32 v155, 0xffff0000, v3
    v_lshlrev_b32 v156, 16, v4
    v_and_b32 v158, 0xffff0000, v4
    v_mul_f32 v152, s59, v152
    v_mul_f32 v153, s82, v153
    v_mul_f32 v154, s59, v154
    v_mul_f32 v155, s82, v155
    v_lshlrev_b32 v157, 16, v5
    v_and_b32 v159, 0xffff0000, v5
    v_lshlrev_b32 v160, 16, v6
    v_and_b32 v162, 0xffff0000, v6
    v_lshlrev_b32 v161, 16, v7
    v_and_b32 v163, 0xffff0000, v7
    s_cmp_eq_u32 s27, 6
    s_cselect_b32 s36, s29, 256
    s_cmp_lt_u32 s27, 7
    s_cselect_b32 s36, s36, 0
    v_add_u32 v10, s36, v10
    v_mul_f32 v156, s58, v156
    v_mul_f32 v157, s58, v157
    v_mul_f32 v158, s58, v158
    v_mul_f32 v159, s58, v159
    v_and_b32 v1, s83, v19
    v_ldexp_f32 v168, v152, 3
    v_ldexp_f32 v169, v153, 3
    global_load_dword v2, v10, s[40:41]
    v_ldexp_f32 v170, v154, 3
    v_ldexp_f32 v171, v155, 3
    global_load_dword v3, v10, s[42:43]
    v_ldexp_f32 v184, v152, 7
    v_ldexp_f32 v185, v153, 7
    global_load_dword v4, v10, s[44:45]
    v_ldexp_f32 v186, v154, 7
    v_ldexp_f32 v187, v155, 7
    global_load_dword v5, v10, s[46:47]
    v_ldexp_f32 v192, v152, 10
    v_ldexp_f32 v193, v153, 10
    global_load_dword v6, v10, s[48:49]
    v_ldexp_f32 v194, v154, 10
    v_ldexp_f32 v195, v155, 10
    global_load_dword v7, v10, s[50:51]
    v_fract_f32 v169, v169
    v_fract_f32 v171, v171
    v_fract_f32 v177, v153
    v_fract_f32 v179, v155
    v_fract_f32 v185, v185
    v_fract_f32 v187, v187
    v_fract_f32 v193, v193
    v_fract_f32 v195, v195
    v_exp_f32 v168, v168
    v_exp_f32 v170, v170
    v_exp_f32 v176, v152
    v_exp_f32 v178, v154
    v_exp_f32 v184, v184
    v_exp_f32 v186, v186
    v_exp_f32 v192, v192
    v_exp_f32 v194, v194
    v_cos_f32 v164, v169
    v_sin_f32 v165, v169
    v_cos_f32 v166, v171
    v_sin_f32 v167, v171
    v_cos_f32 v172, v177
    v_sin_f32 v173, v177
    v_cos_f32 v174, v179
    v_sin_f32 v175, v179
    v_cos_f32 v180, v185
    v_sin_f32 v181, v185
    v_cos_f32 v182, v187
    v_sin_f32 v183, v187
    v_cos_f32 v188, v193
    v_sin_f32 v189, v193
    v_cos_f32 v190, v195
    v_sin_f32 v191, v195
    v_pk_mul_f32 v[196:197], v[156:157], v[160:161] op_sel:[0,0] op_sel_hi:[1,0] neg_hi:[1,0]
    v_pk_mul_f32 v[198:199], v[158:159], v[162:163] op_sel:[0,0] op_sel_hi:[1,0] neg_hi:[1,0]
    v_pk_mul_f32 v[164:165], v[164:165], v[168:169] op_sel_hi:[1,0] neg_hi:[1,0]
    v_pk_mul_f32 v[166:167], v[166:167], v[170:171] op_sel_hi:[1,0] neg_hi:[1,0]
    v_pk_mul_f32 v[172:173], v[172:173], v[176:177] op_sel_hi:[1,0]
    v_pk_mul_f32 v[174:175], v[174:175], v[178:179] op_sel_hi:[1,0]
    v_pk_fma_f32 v[196:197], v[156:157], v[160:161], v[196:197] op_sel:[1,1,0] op_sel_hi:[0,1,1] neg_lo:[1,0,0] neg_hi:[1,0,0]
    v_pk_fma_f32 v[198:199], v[158:159], v[162:163], v[198:199] op_sel:[1,1,0] op_sel_hi:[0,1,1] neg_lo:[1,0,0] neg_hi:[1,0,0]
    v_pk_mul_f32 v[180:181], v[180:181], v[184:185] op_sel_hi:[1,0]
    v_pk_mul_f32 v[182:183], v[182:183], v[186:187] op_sel_hi:[1,0]
    v_pk_mul_f32 v[188:189], v[188:189], v[192:193] op_sel_hi:[1,0]
    v_pk_mul_f32 v[190:191], v[190:191], v[194:195] op_sel_hi:[1,0]
    v_pk_mul_f32 v[200:201], v[164:165], v[164:165] op_sel:[0,0] op_sel_hi:[1,0]
    v_pk_mul_f32 v[202:203], v[166:167], v[166:167] op_sel:[0,0] op_sel_hi:[1,0]
    v_pk_mul_f32 v[204:205], v[172:173], v[172:173] op_sel:[0,0] op_sel_hi:[1,0]
    v_pk_mul_f32 v[206:207], v[174:175], v[174:175] op_sel:[0,0] op_sel_hi:[1,0]
    v_pk_fma_f32 v[200:201], v[164:165], v[164:165], v[200:201] op_sel:[1,1,0] op_sel_hi:[0,1,1] neg_lo:[1,0,0]
    v_pk_fma_f32 v[202:203], v[166:167], v[166:167], v[202:203] op_sel:[1,1,0] op_sel_hi:[0,1,1] neg_lo:[1,0,0]
    v_pk_mul_f32 v[208:209], v[200:201], v[200:201] op_sel:[0,0] op_sel_hi:[1,0]
    v_pk_mul_f32 v[210:211], v[202:203], v[202:203] op_sel:[0,0] op_sel_hi:[1,0]
    v_pk_fma_f32 v[204:205], v[172:173], v[172:173], v[204:205] op_sel:[1,1,0] op_sel_hi:[0,1,1] neg_lo:[1,0,0]
    v_pk_fma_f32 v[206:207], v[174:175], v[174:175], v[206:207] op_sel:[1,1,0] op_sel_hi:[0,1,1] neg_lo:[1,0,0]
    v_pk_mul_f32 v[212:213], v[180:181], v[180:181] op_sel:[0,0] op_sel_hi:[1,0]
    v_pk_mul_f32 v[214:215], v[182:183], v[182:183] op_sel:[0,0] op_sel_hi:[1,0]
    v_pk_fma_f32 v[208:209], v[200:201], v[200:201], v[208:209] op_sel:[1,1,0] op_sel_hi:[0,1,1] neg_lo:[1,0,0]
    v_pk_fma_f32 v[210:211], v[202:203], v[202:203], v[210:211] op_sel:[1,1,0] op_sel_hi:[0,1,1] neg_lo:[1,0,0]
    v_pk_mul_f32 v[216:217], v[208:209], v[208:209] op_sel:[0,0] op_sel_hi:[1,0]
    v_pk_mul_f32 v[218:219], v[210:211], v[210:211] op_sel:[0,0] op_sel_hi:[1,0]
    v_pk_fma_f32 v[212:213], v[180:181], v[180:181], v[212:213] op_sel:[1,1,0] op_sel_hi:[0,1,1] neg_lo:[1,0,0]
    v_pk_fma_f32 v[214:215], v[182:183], v[182:183], v[214:215] op_sel:[1,1,0] op_sel_hi:[0,1,1] neg_lo:[1,0,0]
    v_pk_mul_f32 v[220:221], v[172:173], v[180:181] op_sel:[0,0] op_sel_hi:[1,0]
    v_pk_mul_f32 v[222:223], v[174:175], v[182:183] op_sel:[0,0] op_sel_hi:[1,0]
    v_pk_fma_f32 v[216:217], v[208:209], v[208:209], v[216:217] op_sel:[1,1,0] op_sel_hi:[0,1,1] neg_lo:[1,0,0]
    v_pk_fma_f32 v[218:219], v[210:211], v[210:211], v[218:219] op_sel:[1,1,0] op_sel_hi:[0,1,1] neg_lo:[1,0,0]
    v_pk_mul_f32 v[224:225], v[196:197], v[164:165] op_sel:[0,0] op_sel_hi:[1,0]
    v_pk_mul_f32 v[226:227], v[198:199], v[166:167] op_sel:[0,0] op_sel_hi:[1,0]
    v_pk_fma_f32 v[220:221], v[172:173], v[180:181], v[220:221] op_sel:[1,1,0] op_sel_hi:[0,1,1] neg_lo:[1,0,0]
    v_pk_fma_f32 v[222:223], v[174:175], v[182:183], v[222:223] op_sel:[1,1,0] op_sel_hi:[0,1,1] neg_lo:[1,0,0]
    v_cvt_pk_bf16_f32 v138, v172, v173
    v_cvt_pk_bf16_f32 v139, v174, v175
    v_pk_mul_f32 v[228:229], v[196:197], v[216:217] op_sel:[0,0] op_sel_hi:[1,0]
    v_pk_mul_f32 v[230:231], v[198:199], v[218:219] op_sel:[0,0] op_sel_hi:[1,0]
    v_pk_fma_f32 v[224:225], v[196:197], v[164:165], v[224:225] op_sel:[1,1,0] op_sel_hi:[0,1,1] neg_lo:[1,0,0]
    v_pk_fma_f32 v[226:227], v[198:199], v[166:167], v[226:227] op_sel:[1,1,0] op_sel_hi:[0,1,1] neg_lo:[1,0,0]
    v_cvt_pk_bf16_f32 v136, v220, v221
    v_cvt_pk_bf16_f32 v137, v222, v223
    v_pk_mul_f32 v[232:233], v[204:205], v[204:205] op_sel:[0,0] op_sel_hi:[1,0]
    v_pk_mul_f32 v[234:235], v[206:207], v[206:207] op_sel:[0,0] op_sel_hi:[1,0]
    ds_write2st64_b64 v31, v[136:137], v[138:139] offset0:25 offset1:17
    v_pk_fma_f32 v[228:229], v[196:197], v[216:217], v[228:229] op_sel:[1,1,0] op_sel_hi:[0,1,1] neg_lo:[1,0,0]
    v_pk_fma_f32 v[230:231], v[198:199], v[218:219], v[230:231] op_sel:[1,1,0] op_sel_hi:[0,1,1] neg_lo:[1,0,0]
    v_cvt_pk_bf16_f32 v142, v196, v197
    v_cvt_pk_bf16_f32 v143, v198, v199
    v_pk_mul_f32 v[236:237], v[204:205], v[180:181] op_sel:[0,0] op_sel_hi:[1,0]
    v_pk_mul_f32 v[238:239], v[206:207], v[182:183] op_sel:[0,0] op_sel_hi:[1,0]
    v_pk_fma_f32 v[232:233], v[204:205], v[204:205], v[232:233] op_sel:[1,1,0] op_sel_hi:[0,1,1] neg_lo:[1,0,0]
    v_pk_fma_f32 v[234:235], v[206:207], v[206:207], v[234:235] op_sel:[1,1,0] op_sel_hi:[0,1,1] neg_lo:[1,0,0]
    v_cvt_pk_bf16_f32 v140, v228, v229
    v_cvt_pk_bf16_f32 v141, v230, v231
    v_pk_mul_f32 v[240:241], v[196:197], v[200:201] op_sel:[0,0] op_sel_hi:[1,0]
    v_pk_mul_f32 v[242:243], v[198:199], v[202:203] op_sel:[0,0] op_sel_hi:[1,0]
    ds_write2st64_b64 v30, v[140:141], v[142:143] offset0:8 offset1:0
    v_pk_fma_f32 v[236:237], v[204:205], v[180:181], v[236:237] op_sel:[1,1,0] op_sel_hi:[0,1,1] neg_lo:[1,0,0]
    v_pk_fma_f32 v[238:239], v[206:207], v[182:183], v[238:239] op_sel:[1,1,0] op_sel_hi:[0,1,1] neg_lo:[1,0,0]
    v_cvt_pk_bf16_f32 v146, v204, v205
    v_cvt_pk_bf16_f32 v147, v206, v207
    v_pk_mul_f32 v[244:245], v[224:225], v[216:217] op_sel:[0,0] op_sel_hi:[1,0]
    v_pk_mul_f32 v[246:247], v[226:227], v[218:219] op_sel:[0,0] op_sel_hi:[1,0]
    v_pk_fma_f32 v[240:241], v[196:197], v[200:201], v[240:241] op_sel:[1,1,0] op_sel_hi:[0,1,1] neg_lo:[1,0,0]
    v_pk_fma_f32 v[242:243], v[198:199], v[202:203], v[242:243] op_sel:[1,1,0] op_sel_hi:[0,1,1] neg_lo:[1,0,0]
    v_cvt_pk_bf16_f32 v144, v236, v237
    v_cvt_pk_bf16_f32 v145, v238, v239
    v_pk_mul_f32 v[248:249], v[196:197], v[208:209] op_sel:[0,0] op_sel_hi:[1,0]
    v_pk_mul_f32 v[250:251], v[198:199], v[210:211] op_sel:[0,0] op_sel_hi:[1,0]
    ds_write2st64_b64 v32, v[144:145], v[146:147] offset0:26 offset1:18
    v_pk_fma_f32 v[244:245], v[224:225], v[216:217], v[244:245] op_sel:[1,1,0] op_sel_hi:[0,1,1] neg_lo:[1,0,0]
    v_pk_fma_f32 v[246:247], v[226:227], v[218:219], v[246:247] op_sel:[1,1,0] op_sel_hi:[0,1,1] neg_lo:[1,0,0]
    v_cvt_pk_bf16_f32 v150, v224, v225
    v_cvt_pk_bf16_f32 v151, v226, v227
    v_pk_mul_f32 v[252:253], v[240:241], v[216:217] op_sel:[0,0] op_sel_hi:[1,0]
    v_pk_mul_f32 v[254:255], v[242:243], v[218:219] op_sel:[0,0] op_sel_hi:[1,0]
    v_pk_fma_f32 v[248:249], v[196:197], v[208:209], v[248:249] op_sel:[1,1,0] op_sel_hi:[0,1,1] neg_lo:[1,0,0]
    v_pk_fma_f32 v[250:251], v[198:199], v[210:211], v[250:251] op_sel:[1,1,0] op_sel_hi:[0,1,1] neg_lo:[1,0,0]
    v_cvt_pk_bf16_f32 v148, v244, v245
    v_cvt_pk_bf16_f32 v149, v246, v247
    v_pk_mul_f32 v[152:153], v[224:225], v[200:201] op_sel:[0,0] op_sel_hi:[1,0]
    v_pk_mul_f32 v[154:155], v[226:227], v[202:203] op_sel:[0,0] op_sel_hi:[1,0]
    ds_write2st64_b64 v31, v[148:149], v[150:151] offset0:9 offset1:1
    v_pk_fma_f32 v[252:253], v[240:241], v[216:217], v[252:253] op_sel:[1,1,0] op_sel_hi:[0,1,1] neg_lo:[1,0,0]
    v_pk_fma_f32 v[254:255], v[242:243], v[218:219], v[254:255] op_sel:[1,1,0] op_sel_hi:[0,1,1] neg_lo:[1,0,0]
    v_cvt_pk_bf16_f32 v138, v240, v241
    v_cvt_pk_bf16_f32 v139, v242, v243
    v_pk_mul_f32 v[156:157], v[248:249], v[216:217] op_sel:[0,0] op_sel_hi:[1,0]
    v_pk_mul_f32 v[158:159], v[250:251], v[218:219] op_sel:[0,0] op_sel_hi:[1,0]
    v_pk_fma_f32 v[152:153], v[224:225], v[200:201], v[152:153] op_sel:[1,1,0] op_sel_hi:[0,1,1] neg_lo:[1,0,0]
    v_pk_fma_f32 v[154:155], v[226:227], v[202:203], v[154:155] op_sel:[1,1,0] op_sel_hi:[0,1,1] neg_lo:[1,0,0]
    v_cvt_pk_bf16_f32 v136, v252, v253
    v_cvt_pk_bf16_f32 v137, v254, v255
    v_pk_mul_f32 v[160:161], v[224:225], v[208:209] op_sel:[0,0] op_sel_hi:[1,0]
    v_pk_mul_f32 v[162:163], v[226:227], v[210:211] op_sel:[0,0] op_sel_hi:[1,0]
    ds_write2st64_b64 v32, v[136:137], v[138:139] offset0:10 offset1:2
    v_pk_fma_f32 v[156:157], v[248:249], v[216:217], v[156:157] op_sel:[1,1,0] op_sel_hi:[0,1,1] neg_lo:[1,0,0]
    v_pk_fma_f32 v[158:159], v[250:251], v[218:219], v[158:159] op_sel:[1,1,0] op_sel_hi:[0,1,1] neg_lo:[1,0,0]
    v_cvt_pk_bf16_f32 v142, v248, v249
    v_cvt_pk_bf16_f32 v143, v250, v251
    v_pk_mul_f32 v[168:169], v[152:153], v[216:217] op_sel:[0,0] op_sel_hi:[1,0]
    v_pk_mul_f32 v[170:171], v[154:155], v[218:219] op_sel:[0,0] op_sel_hi:[1,0]
    v_pk_fma_f32 v[160:161], v[224:225], v[208:209], v[160:161] op_sel:[1,1,0] op_sel_hi:[0,1,1] neg_lo:[1,0,0]
    v_pk_fma_f32 v[162:163], v[226:227], v[210:211], v[162:163] op_sel:[1,1,0] op_sel_hi:[0,1,1] neg_lo:[1,0,0]
    v_cvt_pk_bf16_f32 v140, v156, v157
    v_cvt_pk_bf16_f32 v141, v158, v159
    v_pk_mul_f32 v[176:177], v[240:241], v[208:209] op_sel:[0,0] op_sel_hi:[1,0]
    v_pk_mul_f32 v[178:179], v[242:243], v[210:211] op_sel:[0,0] op_sel_hi:[1,0]
    ds_write2st64_b64 v34, v[140:141], v[142:143] offset0:12 offset1:4
    v_pk_fma_f32 v[168:169], v[152:153], v[216:217], v[168:169] op_sel:[1,1,0] op_sel_hi:[0,1,1] neg_lo:[1,0,0]
    v_pk_fma_f32 v[170:171], v[154:155], v[218:219], v[170:171] op_sel:[1,1,0] op_sel_hi:[0,1,1] neg_lo:[1,0,0]
    v_cvt_pk_bf16_f32 v146, v152, v153
    v_cvt_pk_bf16_f32 v147, v154, v155
    v_pk_mul_f32 v[184:185], v[160:161], v[216:217] op_sel:[0,0] op_sel_hi:[1,0]
    v_pk_mul_f32 v[186:187], v[162:163], v[218:219] op_sel:[0,0] op_sel_hi:[1,0]
    v_pk_fma_f32 v[176:177], v[240:241], v[208:209], v[176:177] op_sel:[1,1,0] op_sel_hi:[0,1,1] neg_lo:[1,0,0]
    v_pk_fma_f32 v[178:179], v[242:243], v[210:211], v[178:179] op_sel:[1,1,0] op_sel_hi:[0,1,1] neg_lo:[1,0,0]
    v_cvt_pk_bf16_f32 v144, v168, v169
    v_cvt_pk_bf16_f32 v145, v170, v171
    v_pk_mul_f32 v[192:193], v[152:153], v[208:209] op_sel:[0,0] op_sel_hi:[1,0]
    v_pk_mul_f32 v[194:195], v[154:155], v[210:211] op_sel:[0,0] op_sel_hi:[1,0]
    ds_write2st64_b64 v33, v[144:145], v[146:147] offset0:11 offset1:3
    v_pk_fma_f32 v[184:185], v[160:161], v[216:217], v[184:185] op_sel:[1,1,0] op_sel_hi:[0,1,1] neg_lo:[1,0,0]
    v_pk_fma_f32 v[186:187], v[162:163], v[218:219], v[186:187] op_sel:[1,1,0] op_sel_hi:[0,1,1] neg_lo:[1,0,0]
    v_cvt_pk_bf16_f32 v150, v160, v161
    v_cvt_pk_bf16_f32 v151, v162, v163
    v_pk_mul_f32 v[164:165], v[176:177], v[216:217] op_sel:[0,0] op_sel_hi:[1,0]
    v_pk_mul_f32 v[166:167], v[178:179], v[218:219] op_sel:[0,0] op_sel_hi:[1,0]
    v_pk_fma_f32 v[192:193], v[152:153], v[208:209], v[192:193] op_sel:[1,1,0] op_sel_hi:[0,1,1] neg_lo:[1,0,0]
    v_pk_fma_f32 v[194:195], v[154:155], v[210:211], v[194:195] op_sel:[1,1,0] op_sel_hi:[0,1,1] neg_lo:[1,0,0]
    v_cvt_pk_bf16_f32 v148, v184, v185
    v_cvt_pk_bf16_f32 v149, v186, v187
    v_pk_mul_f32 v[220:221], v[204:205], v[172:173] op_sel:[0,0] op_sel_hi:[1,0]
    v_pk_mul_f32 v[222:223], v[206:207], v[174:175] op_sel:[0,0] op_sel_hi:[1,0]
    ds_write2st64_b64 v35, v[148:149], v[150:151] offset0:13 offset1:5
    v_pk_fma_f32 v[164:165], v[176:177], v[216:217], v[164:165] op_sel:[1,1,0] op_sel_hi:[0,1,1] neg_lo:[1,0,0]
    v_pk_fma_f32 v[166:167], v[178:179], v[218:219], v[166:167] op_sel:[1,1,0] op_sel_hi:[0,1,1] neg_lo:[1,0,0]
    v_cvt_pk_bf16_f32 v138, v176, v177
    v_cvt_pk_bf16_f32 v139, v178, v179
    v_pk_mul_f32 v[228:229], v[192:193], v[216:217] op_sel:[0,0] op_sel_hi:[1,0]
    v_pk_mul_f32 v[230:231], v[194:195], v[218:219] op_sel:[0,0] op_sel_hi:[1,0]
    v_pk_fma_f32 v[220:221], v[204:205], v[172:173], v[220:221] op_sel:[1,1,0] op_sel_hi:[0,1,1] neg_lo:[1,0,0]
    v_pk_fma_f32 v[222:223], v[206:207], v[174:175], v[222:223] op_sel:[1,1,0] op_sel_hi:[0,1,1] neg_lo:[1,0,0]
    v_cvt_pk_bf16_f32 v136, v164, v165
    v_cvt_pk_bf16_f32 v137, v166, v167
    v_pk_mul_f32 v[236:237], v[232:233], v[172:173] op_sel:[0,0] op_sel_hi:[1,0]
    v_pk_mul_f32 v[238:239], v[234:235], v[174:175] op_sel:[0,0] op_sel_hi:[1,0]
    ds_write2st64_b64 v36, v[136:137], v[138:139] offset0:14 offset1:6
    v_pk_fma_f32 v[228:229], v[192:193], v[216:217], v[228:229] op_sel:[1,1,0] op_sel_hi:[0,1,1] neg_lo:[1,0,0]
    v_pk_fma_f32 v[230:231], v[194:195], v[218:219], v[230:231] op_sel:[1,1,0] op_sel_hi:[0,1,1] neg_lo:[1,0,0]
    v_cvt_pk_bf16_f32 v142, v192, v193
    v_cvt_pk_bf16_f32 v143, v194, v195
    v_pk_mul_f32 v[196:197], v[232:233], v[180:181] op_sel:[0,0] op_sel_hi:[1,0]
    v_pk_mul_f32 v[198:199], v[234:235], v[182:183] op_sel:[0,0] op_sel_hi:[1,0]
    v_pk_fma_f32 v[236:237], v[232:233], v[172:173], v[236:237] op_sel:[1,1,0] op_sel_hi:[0,1,1] neg_lo:[1,0,0]
    v_pk_fma_f32 v[238:239], v[234:235], v[174:175], v[238:239] op_sel:[1,1,0] op_sel_hi:[0,1,1] neg_lo:[1,0,0]
    v_cvt_pk_bf16_f32 v140, v228, v229
    v_cvt_pk_bf16_f32 v141, v230, v231
    v_pk_mul_f32 v[244:245], v[232:233], v[204:205] op_sel:[0,0] op_sel_hi:[1,0]
    v_pk_mul_f32 v[246:247], v[234:235], v[206:207] op_sel:[0,0] op_sel_hi:[1,0]
    ds_write2st64_b64 v37, v[140:141], v[142:143] offset0:15 offset1:7
    v_pk_fma_f32 v[196:197], v[232:233], v[180:181], v[196:197] op_sel:[1,1,0] op_sel_hi:[0,1,1] neg_lo:[1,0,0]
    s_waitcnt vmcnt(7)
    v_pk_fma_f32 v[198:199], v[234:235], v[182:183], v[198:199] op_sel:[1,1,0] op_sel_hi:[0,1,1] neg_lo:[1,0,0]
    v_cvt_pk_bf16_f32 v146, v232, v233
    v_cvt_pk_bf16_f32 v147, v234, v235
    ds_read_b128 a[0:3], v14 offset:0
    v_pk_mul_f32 v[200:201], v[220:221], v[180:181] op_sel:[0,0] op_sel_hi:[1,0]
    ds_read_b64_tr_b16 a[144:145], v21 offset:0
    v_pk_mul_f32 v[202:203], v[222:223], v[182:183] op_sel:[0,0] op_sel_hi:[1,0]
    v_pk_fma_f32 v[244:245], v[232:233], v[204:205], v[244:245] op_sel:[1,1,0] op_sel_hi:[0,1,1] neg_lo:[1,0,0]
    v_pk_fma_f32 v[246:247], v[234:235], v[206:207], v[246:247] op_sel:[1,1,0] op_sel_hi:[0,1,1] neg_lo:[1,0,0]
    v_cvt_pk_bf16_f32 v144, v196, v197
    v_cvt_pk_bf16_f32 v145, v198, v199
    ds_read_b128 a[4:7], v38 offset:0
    ds_read_b64_tr_b16 a[146:147], v21 offset:256
    v_pk_mul_f32 v[252:253], v[232:233], v[220:221] op_sel:[0,0] op_sel_hi:[1,0]
    v_pk_mul_f32 v[254:255], v[234:235], v[222:223] op_sel:[0,0] op_sel_hi:[1,0]
    ds_write2st64_b64 v34, v[144:145], v[146:147] offset0:28 offset1:20
    v_pk_fma_f32 v[200:201], v[220:221], v[180:181], v[200:201] op_sel:[1,1,0] op_sel_hi:[0,1,1] neg_lo:[1,0,0]
    v_pk_fma_f32 v[202:203], v[222:223], v[182:183], v[202:203] op_sel:[1,1,0] op_sel_hi:[0,1,1] neg_lo:[1,0,0]
    ds_read_b64_tr_b16 a[148:149], v21 offset:16
    v_cvt_pk_bf16_f32 v150, v220, v221
    v_cvt_pk_bf16_f32 v151, v222, v223
    ds_read_b128 a[8:11], v43 offset:0
    v_pk_mul_f32 v[248:249], v[236:237], v[180:181] op_sel:[0,0] op_sel_hi:[1,0]
    v_pk_mul_f32 v[250:251], v[238:239], v[182:183] op_sel:[0,0] op_sel_hi:[1,0]
    v_pk_fma_f32 v[252:253], v[232:233], v[220:221], v[252:253] op_sel:[1,1,0] op_sel_hi:[0,1,1] neg_lo:[1,0,0]
    ds_read_b64_tr_b16 a[150:151], v21 offset:272
    v_pk_fma_f32 v[254:255], v[234:235], v[222:223], v[254:255] op_sel:[1,1,0] op_sel_hi:[0,1,1] neg_lo:[1,0,0]
    v_cvt_pk_bf16_f32 v148, v200, v201
    v_cvt_pk_bf16_f32 v149, v202, v203
    ds_read_b128 a[12:15], v59 offset:0
    v_pk_mul_f32 v[224:225], v[212:213], v[180:181] op_sel:[0,0] op_sel_hi:[1,0]
    ds_read_b64_tr_b16 a[152:153], v21 offset:32
    v_pk_mul_f32 v[226:227], v[214:215], v[182:183] op_sel:[0,0] op_sel_hi:[1,0]
    ds_write2st64_b64 v33, v[148:149], v[150:151] offset0:27 offset1:19
    v_pk_fma_f32 v[248:249], v[236:237], v[180:181], v[248:249] op_sel:[1,1,0] op_sel_hi:[0,1,1] neg_lo:[1,0,0]
    v_pk_fma_f32 v[250:251], v[238:239], v[182:183], v[250:251] op_sel:[1,1,0] op_sel_hi:[0,1,1] neg_lo:[1,0,0]
    v_cvt_pk_bf16_f32 v138, v236, v237
    v_cvt_pk_bf16_f32 v139, v238, v239
    ds_read_b64_tr_b16 a[154:155], v21 offset:288
    ds_read_b128 a[16:19], v14 offset:256
    v_pk_mul_f32 v[156:157], v[244:245], v[180:181] op_sel:[0,0] op_sel_hi:[1,0]
    v_pk_mul_f32 v[158:159], v[246:247], v[182:183] op_sel:[0,0] op_sel_hi:[1,0]
    v_pk_fma_f32 v[224:225], v[212:213], v[180:181], v[224:225] op_sel:[1,1,0] op_sel_hi:[0,1,1] neg_lo:[1,0,0]
    v_pk_fma_f32 v[226:227], v[214:215], v[182:183], v[226:227] op_sel:[1,1,0] op_sel_hi:[0,1,1] neg_lo:[1,0,0]
    ds_read_b64_tr_b16 a[156:157], v21 offset:48
    v_cvt_pk_bf16_f32 v136, v248, v249
    v_cvt_pk_bf16_f32 v137, v250, v251
    ds_read_b128 a[20:23], v38 offset:256
    ds_write2st64_b64 v35, v[136:137], v[138:139] offset0:29 offset1:21
    v_pk_fma_f32 v[156:157], v[244:245], v[180:181], v[156:157] op_sel:[1,1,0] op_sel_hi:[0,1,1] neg_lo:[1,0,0]
    v_pk_fma_f32 v[158:159], v[246:247], v[182:183], v[158:159] op_sel:[1,1,0] op_sel_hi:[0,1,1] neg_lo:[1,0,0]
    ds_read_b64_tr_b16 a[158:159], v21 offset:304
    v_cvt_pk_bf16_f32 v142, v244, v245
    v_cvt_pk_bf16_f32 v143, v246, v247
    ds_read_b128 a[24:27], v43 offset:256
    v_pk_mul_f32 v[240:241], v[252:253], v[180:181] op_sel:[0,0] op_sel_hi:[1,0]
    v_pk_mul_f32 v[242:243], v[254:255], v[182:183] op_sel:[0,0] op_sel_hi:[1,0]
    v_cvt_pk_bf16_f32 v140, v156, v157
    v_cvt_pk_bf16_f32 v141, v158, v159
    ds_read_b128 a[28:31], v59 offset:256
    v_pk_mul_f32 v[168:169], v[212:213], v[204:205] op_sel:[0,0] op_sel_hi:[1,0]
    v_pk_mul_f32 v[170:171], v[214:215], v[206:207] op_sel:[0,0] op_sel_hi:[1,0]
    ds_write2st64_b64 v36, v[140:141], v[142:143] offset0:30 offset1:22
    ds_read_b128 v[72:75], v22 offset:0
    v_pk_fma_f32 v[240:241], v[252:253], v[180:181], v[240:241] op_sel:[1,1,0] op_sel_hi:[0,1,1] neg_lo:[1,0,0]
    v_pk_fma_f32 v[242:243], v[254:255], v[182:183], v[242:243] op_sel:[1,1,0] op_sel_hi:[0,1,1] neg_lo:[1,0,0]
    v_cvt_pk_bf16_f32 v150, v252, v253
    v_cvt_pk_bf16_f32 v151, v254, v255
    v_cvt_pk_bf16_f32 v144, v180, v181
    ds_read_b128 v[76:79], v22 offset:1024
    v_cvt_pk_bf16_f32 v145, v182, v183
    v_pk_mul_f32 v[160:161], v[212:213], v[212:213] op_sel:[0,0] op_sel_hi:[1,0]
    v_pk_mul_f32 v[162:163], v[214:215], v[214:215] op_sel:[0,0] op_sel_hi:[1,0]
    ds_write_b64 v30, v[144:145] offset:12288
    v_pk_fma_f32 v[168:169], v[212:213], v[204:205], v[168:169] op_sel:[1,1,0] op_sel_hi:[0,1,1] neg_lo:[1,0,0]
    v_pk_fma_f32 v[170:171], v[214:215], v[206:207], v[170:171] op_sel:[1,1,0] op_sel_hi:[0,1,1] neg_lo:[1,0,0]
    ds_read_b128 v[80:83], v22 offset:2048
    v_cvt_pk_bf16_f32 v148, v240, v241
    v_cvt_pk_bf16_f32 v149, v242, v243
    v_pk_mul_f32 v[208:209], v[188:189], v[188:189] op_sel:[0,0] op_sel_hi:[1,0]
    v_pk_mul_f32 v[210:211], v[190:191], v[190:191] op_sel:[0,0] op_sel_hi:[1,0]
    ds_write2st64_b64 v37, v[148:149], v[150:151] offset0:31 offset1:23
    ds_read_b128 v[84:87], v22 offset:3072
    v_pk_fma_f32 v[160:161], v[212:213], v[212:213], v[160:161] op_sel:[1,1,0] op_sel_hi:[0,1,1] neg_lo:[1,0,0]
    v_pk_fma_f32 v[162:163], v[214:215], v[214:215], v[162:163] op_sel:[1,1,0] op_sel_hi:[0,1,1] neg_lo:[1,0,0]
    v_cvt_pk_bf16_f32 v138, v212, v213
    v_cvt_pk_bf16_f32 v139, v214, v215
    ds_read_b128 a[32:35], v14 offset:8192
    v_pk_mul_f32 v[152:153], v[160:161], v[232:233] op_sel:[0,0] op_sel_hi:[1,0]
    v_pk_mul_f32 v[154:155], v[162:163], v[234:235] op_sel:[0,0] op_sel_hi:[1,0]
    v_pk_fma_f32 v[208:209], v[188:189], v[188:189], v[208:209] op_sel:[1,1,0] op_sel_hi:[0,1,1] neg_lo:[1,0,0]
    v_pk_fma_f32 v[210:211], v[190:191], v[190:191], v[210:211] op_sel:[1,1,0] op_sel_hi:[0,1,1] neg_lo:[1,0,0]
    v_cvt_pk_bf16_f32 v136, v160, v161
    v_cvt_pk_bf16_f32 v137, v162, v163
    ds_read_b128 a[36:39], v38 offset:8192
    v_pk_mul_f32 v[184:185], v[160:161], v[180:181] op_sel:[0,0] op_sel_hi:[1,0]
    v_pk_mul_f32 v[186:187], v[162:163], v[182:183] op_sel:[0,0] op_sel_hi:[1,0]
    ds_write2st64_b64 v30, v[136:137], v[138:139] offset0:40 offset1:32
    v_pk_fma_f32 v[152:153], v[160:161], v[232:233], v[152:153] op_sel:[1,1,0] op_sel_hi:[0,1,1] neg_lo:[1,0,0]
    v_pk_fma_f32 v[154:155], v[162:163], v[234:235], v[154:155] op_sel:[1,1,0] op_sel_hi:[0,1,1] neg_lo:[1,0,0]
    v_cvt_pk_bf16_f32 v146, v168, v169
    v_cvt_pk_bf16_f32 v147, v170, v171
    v_cvt_pk_bf16_f32 v140, v208, v209
    v_cvt_pk_bf16_f32 v141, v210, v211
    ds_read_b128 a[40:43], v43 offset:8192
    s_waitcnt lgkmcnt(3)
    v_pk_mul_f32 v[176:177], v[160:161], v[212:213] op_sel:[0,0] op_sel_hi:[1,0]
    v_pk_mul_f32 v[178:179], v[162:163], v[214:215] op_sel:[0,0] op_sel_hi:[1,0]
    ds_write_b64 v34, v[140:141] offset:26624
    v_pk_fma_f32 v[184:185], v[160:161], v[180:181], v[184:185] op_sel:[1,1,0] op_sel_hi:[0,1,1] neg_lo:[1,0,0]
    v_pk_fma_f32 v[186:187], v[162:163], v[182:183], v[186:187] op_sel:[1,1,0] op_sel_hi:[0,1,1] neg_lo:[1,0,0]
    v_cvt_pk_bf16_f32 v144, v152, v153
    v_mfma_f32_16x16x32_bf16 a[128:131], v[72:75], v[60:63], a[128:131]
    v_cvt_pk_bf16_f32 v145, v154, v155
    ds_read_b128 a[44:47], v59 offset:8192
    v_pk_mul_f32 v[164:165], v[212:213], v[232:233] op_sel:[0,0] op_sel_hi:[1,0]
    v_pk_mul_f32 v[166:167], v[214:215], v[234:235] op_sel:[0,0] op_sel_hi:[1,0]
    ds_write2st64_b64 v31, v[144:145], v[146:147] offset0:41 offset1:33
    v_mfma_f32_16x16x32_bf16 a[132:135], v[76:79], v[60:63], a[132:135]
    v_pk_fma_f32 v[176:177], v[160:161], v[212:213], v[176:177] op_sel:[1,1,0] op_sel_hi:[0,1,1] neg_lo:[1,0,0]
    v_pk_fma_f32 v[178:179], v[162:163], v[214:215], v[178:179] op_sel:[1,1,0] op_sel_hi:[0,1,1] neg_lo:[1,0,0]
    v_cvt_pk_bf16_f32 v150, v224, v225
    v_cvt_pk_bf16_f32 v151, v226, v227
    ds_read_b128 a[48:51], v14 offset:8448
    v_pk_mul_f32 v[216:217], v[184:185], v[232:233] op_sel:[0,0] op_sel_hi:[1,0]
    v_mfma_f32_16x16x32_bf16 a[136:139], v[80:83], v[60:63], a[136:139]
    v_pk_mul_f32 v[218:219], v[186:187], v[234:235] op_sel:[0,0] op_sel_hi:[1,0]
    v_pk_fma_f32 v[164:165], v[212:213], v[232:233], v[164:165] op_sel:[1,1,0] op_sel_hi:[0,1,1] neg_lo:[1,0,0]
    v_pk_fma_f32 v[166:167], v[214:215], v[234:235], v[166:167] op_sel:[1,1,0] op_sel_hi:[0,1,1] neg_lo:[1,0,0]
    v_cvt_pk_bf16_f32 v138, v184, v185
    v_cvt_pk_bf16_f32 v139, v186, v187
    v_cvt_pk_bf16_f32 v148, v176, v177
    v_mfma_f32_16x16x32_bf16 a[140:143], v[84:87], v[60:63], a[140:143]
    v_cvt_pk_bf16_f32 v149, v178, v179
    ds_read_b128 a[52:55], v38 offset:8448
    v_pk_mul_f32 v[192:193], v[212:213], v[244:245] op_sel:[0,0] op_sel_hi:[1,0]
    v_pk_mul_f32 v[194:195], v[214:215], v[246:247] op_sel:[0,0] op_sel_hi:[1,0]
    ds_write2st64_b64 v34, v[148:149], v[150:151] offset0:44 offset1:36
    s_add_u32 m0, s26, 32768
    v_pk_fma_f32 v[216:217], v[184:185], v[232:233], v[216:217] op_sel:[1,1,0] op_sel_hi:[0,1,1] neg_lo:[1,0,0]
    v_pk_fma_f32 v[218:219], v[186:187], v[234:235], v[218:219] op_sel:[1,1,0] op_sel_hi:[0,1,1] neg_lo:[1,0,0]
    v_cvt_pk_bf16_f32 v136, v164, v165
    v_cvt_pk_bf16_f32 v137, v166, v167
    ds_read_b128 a[56:59], v43 offset:8448
    v_pk_mul_f32 v[172:173], v[224:225], v[204:205] op_sel:[0,0] op_sel_hi:[1,0]
    s_add_u32 s33, s30, 31744
    v_pk_mul_f32 v[174:175], v[226:227], v[206:207] op_sel:[0,0] op_sel_hi:[1,0]
    ds_write2st64_b64 v32, v[136:137], v[138:139] offset0:34 offset1:42
    v_pk_fma_f32 v[192:193], v[212:213], v[244:245], v[192:193] op_sel:[1,1,0] op_sel_hi:[0,1,1] neg_lo:[1,0,0]
    v_pk_fma_f32 v[194:195], v[214:215], v[246:247], v[194:195] op_sel:[1,1,0] op_sel_hi:[0,1,1] neg_lo:[1,0,0]
    v_cvt_pk_bf16_f32 v142, v216, v217
    buffer_load_dwordx4 v20, s[8:11], s30 offen lds
    v_cvt_pk_bf16_f32 v143, v218, v219
    ds_read_b128 a[60:63], v59 offset:8448
    v_pk_mul_f32 v[228:229], v[176:177], v[232:233] op_sel:[0,0] op_sel_hi:[1,0]
    v_pk_mul_f32 v[230:231], v[178:179], v[234:235] op_sel:[0,0] op_sel_hi:[1,0]
    v_pk_fma_f32 v[172:173], v[224:225], v[204:205], v[172:173] op_sel:[1,1,0] op_sel_hi:[0,1,1] neg_lo:[1,0,0]
    v_pk_fma_f32 v[174:175], v[226:227], v[206:207], v[174:175] op_sel:[1,1,0] op_sel_hi:[0,1,1] neg_lo:[1,0,0]
    s_add_u32 s34, s30, 63488
    v_cvt_pk_bf16_f32 v140, v192, v193
    v_cvt_pk_bf16_f32 v141, v194, v195
    v_pk_mul_f32 v[196:197], v[160:161], v[224:225] op_sel:[0,0] op_sel_hi:[1,0]
    v_pk_mul_f32 v[198:199], v[162:163], v[226:227] op_sel:[0,0] op_sel_hi:[1,0]
    ds_write2st64_b64 v33, v[140:141], v[142:143] offset0:35 offset1:43
    buffer_load_dwordx4 v20, s[8:11], s33 offen offset:1024 lds
    v_pk_fma_f32 v[228:229], v[176:177], v[232:233], v[228:229] op_sel:[1,1,0] op_sel_hi:[0,1,1] neg_lo:[1,0,0]
    v_pk_fma_f32 v[230:231], v[178:179], v[234:235], v[230:231] op_sel:[1,1,0] op_sel_hi:[0,1,1] neg_lo:[1,0,0]
    v_cvt_pk_bf16_f32 v146, v172, v173
    v_cvt_pk_bf16_f32 v147, v174, v175
    v_pk_mul_f32 v[220:221], v[224:225], v[232:233] op_sel:[0,0] op_sel_hi:[1,0]
    v_pk_mul_f32 v[222:223], v[226:227], v[234:235] op_sel:[0,0] op_sel_hi:[1,0]
    s_add_u32 s33, s30, 95232
    v_pk_fma_f32 v[196:197], v[160:161], v[224:225], v[196:197] op_sel:[1,1,0] op_sel_hi:[0,1,1] neg_lo:[1,0,0]
    v_pk_fma_f32 v[198:199], v[162:163], v[226:227], v[198:199] op_sel:[1,1,0] op_sel_hi:[0,1,1] neg_lo:[1,0,0]
    v_cvt_pk_bf16_f32 v144, v228, v229
    v_cvt_pk_bf16_f32 v145, v230, v231
    v_pk_mul_f32 v[200:201], v[196:197], v[232:233] op_sel:[0,0] op_sel_hi:[1,0]
    buffer_load_dwordx4 v20, s[8:11], s34 offen offset:2048 lds
    v_pk_mul_f32 v[202:203], v[198:199], v[234:235] op_sel:[0,0] op_sel_hi:[1,0]
    ds_write2st64_b64 v35, v[144:145], v[146:147] offset0:45 offset1:37
    v_pk_fma_f32 v[220:221], v[224:225], v[232:233], v[220:221] op_sel:[1,1,0] op_sel_hi:[0,1,1] neg_lo:[1,0,0]
    v_pk_fma_f32 v[222:223], v[226:227], v[234:235], v[222:223] op_sel:[1,1,0] op_sel_hi:[0,1,1] neg_lo:[1,0,0]
    v_cvt_pk_bf16_f32 v150, v196, v197
    v_cvt_pk_bf16_f32 v151, v198, v199
    s_add_u32 s30, s30, 64
    v_pk_mul_f32 v[236:237], v[224:225], v[244:245] op_sel:[0,0] op_sel_hi:[1,0]
    v_pk_mul_f32 v[238:239], v[226:227], v[246:247] op_sel:[0,0] op_sel_hi:[1,0]
    v_pk_fma_f32 v[200:201], v[196:197], v[232:233], v[200:201] op_sel:[1,1,0] op_sel_hi:[0,1,1] neg_lo:[1,0,0]
    v_pk_fma_f32 v[202:203], v[198:199], v[234:235], v[202:203] op_sel:[1,1,0] op_sel_hi:[0,1,1] neg_lo:[1,0,0]
    v_cvt_pk_bf16_f32 v148, v220, v221
    buffer_load_dwordx4 v20, s[8:11], s33 offen offset:3072 lds
    v_cvt_pk_bf16_f32 v149, v222, v223
    v_pk_mul_f32 v[248:249], v[188:189], v[212:213] op_sel:[0,0] op_sel_hi:[1,0]
    v_pk_mul_f32 v[250:251], v[190:191], v[214:215] op_sel:[0,0] op_sel_hi:[1,0]
    ds_write2st64_b64 v36, v[148:149], v[150:151] offset0:38 offset1:46
    v_pk_fma_f32 v[236:237], v[224:225], v[244:245], v[236:237] op_sel:[1,1,0] op_sel_hi:[0,1,1] neg_lo:[1,0,0]
    v_pk_fma_f32 v[238:239], v[226:227], v[246:247], v[238:239] op_sel:[1,1,0] op_sel_hi:[0,1,1] neg_lo:[1,0,0]
    buffer_load_dwordx4 v[60:63], v24, s[20:23], s32 offen
    v_cvt_pk_bf16_f32 v138, v200, v201
    v_cvt_pk_bf16_f32 v139, v202, v203
    v_pk_mul_f32 v[156:157], v[188:189], v[180:181] op_sel:[0,0] op_sel_hi:[1,0]
    v_pk_mul_f32 v[158:159], v[190:191], v[182:183] op_sel:[0,0] op_sel_hi:[1,0]
    v_pk_fma_f32 v[248:249], v[188:189], v[212:213], v[248:249] op_sel:[1,1,0] op_sel_hi:[0,1,1] neg_lo:[1,0,0]
    s_add_u32 s32, s32, 64
    v_pk_fma_f32 v[250:251], v[190:191], v[214:215], v[250:251] op_sel:[1,1,0] op_sel_hi:[0,1,1] neg_lo:[1,0,0]
    v_cvt_pk_bf16_f32 v136, v236, v237
    v_cvt_pk_bf16_f32 v137, v238, v239
    v_pk_mul_f32 v[252:253], v[188:189], v[224:225] op_sel:[0,0] op_sel_hi:[1,0]
    v_pk_mul_f32 v[254:255], v[190:191], v[226:227] op_sel:[0,0] op_sel_hi:[1,0]
    ds_write2st64_b64 v37, v[136:137], v[138:139] offset0:39 offset1:47
    buffer_store_dwordx4 a[144:147], v23, s[16:19], s31 offen sc1
    v_pk_fma_f32 v[156:157], v[188:189], v[180:181], v[156:157] op_sel:[1,1,0] op_sel_hi:[0,1,1] neg_lo:[1,0,0]
    v_pk_fma_f32 v[158:159], v[190:191], v[182:183], v[158:159] op_sel:[1,1,0] op_sel_hi:[0,1,1] neg_lo:[1,0,0]
    v_cvt_pk_bf16_f32 v142, v188, v189
    v_cvt_pk_bf16_f32 v143, v190, v191
    ds_read_b128 a[64:67], v14 offset:16384
    s_add_u32 s31, s31, 32768
    ds_read_b128 a[68:71], v38 offset:16384
    v_pk_mul_f32 v[240:241], v[188:189], v[160:161] op_sel:[0,0] op_sel_hi:[1,0]
    v_pk_mul_f32 v[242:243], v[190:191], v[162:163] op_sel:[0,0] op_sel_hi:[1,0]
    v_pk_fma_f32 v[252:253], v[188:189], v[224:225], v[252:253] op_sel:[1,1,0] op_sel_hi:[0,1,1] neg_lo:[1,0,0]
    v_pk_fma_f32 v[254:255], v[190:191], v[226:227], v[254:255] op_sel:[1,1,0] op_sel_hi:[0,1,1] neg_lo:[1,0,0]
    v_cvt_pk_bf16_f32 v146, v248, v249
    buffer_store_dwordx4 a[148:151], v23, s[16:19], s31 offen sc1
    v_cvt_pk_bf16_f32 v147, v250, v251
    v_cvt_pk_bf16_f32 v140, v156, v157
    v_cvt_pk_bf16_f32 v141, v158, v159
    ds_read_b128 a[72:75], v43 offset:16384
    ds_read_b128 a[76:79], v59 offset:16384
    s_add_u32 s31, s31, 32768
    v_pk_mul_f32 v[168:169], v[188:189], v[184:185] op_sel:[0,0] op_sel_hi:[1,0]
    v_pk_mul_f32 v[170:171], v[190:191], v[186:187] op_sel:[0,0] op_sel_hi:[1,0]
    ds_write2st64_b64 v30, v[140:141], v[142:143] offset0:56 offset1:48
    v_pk_fma_f32 v[240:241], v[188:189], v[160:161], v[240:241] op_sel:[1,1,0] op_sel_hi:[0,1,1] neg_lo:[1,0,0]
    v_pk_fma_f32 v[242:243], v[190:191], v[162:163], v[242:243] op_sel:[1,1,0] op_sel_hi:[0,1,1] neg_lo:[1,0,0]
    v_cvt_pk_bf16_f32 v144, v252, v253
    buffer_store_dwordx4 a[152:155], v23, s[16:19], s31 offen sc1
    v_cvt_pk_bf16_f32 v145, v254, v255
    ds_read_b128 a[80:83], v14 offset:16640
    ds_read_b128 a[84:87], v38 offset:16640
    v_pk_mul_f32 v[208:209], v[188:189], v[176:177] op_sel:[0,0] op_sel_hi:[1,0]
    v_pk_mul_f32 v[210:211], v[190:191], v[178:179] op_sel:[0,0] op_sel_hi:[1,0]
    s_add_u32 s31, s31, 32768
    ds_write2st64_b64 v31, v[144:145], v[146:147] offset0:57 offset1:49
    v_pk_fma_f32 v[168:169], v[188:189], v[184:185], v[168:169] op_sel:[1,1,0] op_sel_hi:[0,1,1] neg_lo:[1,0,0]
    v_pk_fma_f32 v[170:171], v[190:191], v[186:187], v[170:171] op_sel:[1,1,0] op_sel_hi:[0,1,1] neg_lo:[1,0,0]
    v_cvt_pk_bf16_f32 v150, v240, v241
    v_cvt_pk_bf16_f32 v151, v242, v243
    ds_read_b128 a[88:91], v43 offset:16640
    buffer_store_dwordx4 a[156:159], v23, s[16:19], s31 offen sc1
    ds_read_b128 a[92:95], v59 offset:16640
    v_pk_mul_f32 v[152:153], v[188:189], v[196:197] op_sel:[0,0] op_sel_hi:[1,0]
    v_pk_mul_f32 v[154:155], v[190:191], v[198:199] op_sel:[0,0] op_sel_hi:[1,0]
    v_pk_fma_f32 v[208:209], v[188:189], v[176:177], v[208:209] op_sel:[1,1,0] op_sel_hi:[0,1,1] neg_lo:[1,0,0]
    v_pk_fma_f32 v[210:211], v[190:191], v[178:179], v[210:211] op_sel:[1,1,0] op_sel_hi:[0,1,1] neg_lo:[1,0,0]
    s_add_u32 s31, s31, 32768
    v_cvt_pk_bf16_f32 v148, v168, v169
    v_cvt_pk_bf16_f32 v149, v170, v171
    ds_write2st64_b64 v32, v[148:149], v[150:151] offset0:58 offset1:50
    v_pk_fma_f32 v[152:153], v[188:189], v[196:197], v[152:153] op_sel:[1,1,0] op_sel_hi:[0,1,1] neg_lo:[1,0,0]
    v_pk_fma_f32 v[154:155], v[190:191], v[198:199], v[154:155] op_sel:[1,1,0] op_sel_hi:[0,1,1] neg_lo:[1,0,0]
    v_cvt_pk_bf16_f32 v138, v208, v209
    global_load_dword v25, v[104:105], off
    v_cvt_pk_bf16_f32 v139, v210, v211
    v_cvt_pk_bf16_f32 v136, v152, v153
    v_cvt_pk_bf16_f32 v137, v154, v155
    ds_write2st64_b64 v33, v[136:137], v[138:139] offset0:59 offset1:51
    ds_read_b128 a[96:99], v14 offset:24576
    ds_read_b128 a[100:103], v38 offset:24576
    ds_read_b128 a[104:107], v43 offset:24576
    ds_read_b128 a[108:111], v59 offset:24576
    ds_read_b128 a[112:115], v14 offset:24832
    ds_read_b128 a[116:119], v38 offset:24832
    ds_read_b128 a[120:123], v43 offset:24832
    ds_read_b128 a[124:127], v59 offset:24832
    v_mov_b32 v92, v1
    v_mov_b32 v93, 0
    v_mov_b32 v94, 0
    v_mov_b32 v95, 0
    s_mov_b32 s27, 1
    s_waitcnt vmcnt(10)
    v_mov_b32 v58, 128
    v_mov_b32 v57, 1
    s_mov_b64 exec, 1
    global_atomic_add v58, v57, s[98:99] sc1
    s_mov_b64 exec, -1
fused_kernel_aloop:
    s_waitcnt vmcnt(11)
    v_readlane_b32 s59, v55, s27
    v_readlane_b32 s82, v56, s27
    v_readlane_b32 s58, v54, s27
    v_readlane_b32 s83, v9, s27
    v_lshlrev_b32 v152, 16, v2
    s_waitcnt lgkmcnt(8)
    v_and_b32 v154, 0xffff0000, v2
    v_lshlrev_b32 v153, 16, v3
    v_mfma_f32_16x16x32_bf16 v[92:95], a[32:35], a[0:3], v[92:95]
    v_and_b32 v155, 0xffff0000, v3
    v_lshlrev_b32 v156, 16, v4
    v_and_b32 v158, 0xffff0000, v4
    v_mfma_f32_16x16x32_bf16 v[96:99], a[64:67], a[0:3], 0
    v_mul_f32 v152, s59, v152
    v_mul_f32 v153, s82, v153
    v_mul_f32 v154, s59, v154
    v_mfma_f32_16x16x32_bf16 v[92:95], a[36:39], a[4:7], v[92:95]
    v_mul_f32 v155, s82, v155
    v_lshlrev_b32 v157, 16, v5
    v_and_b32 v159, 0xffff0000, v5
    v_mfma_f32_16x16x32_bf16 v[96:99], a[68:71], a[4:7], v[96:99]
    v_lshlrev_b32 v160, 16, v6
    v_and_b32 v162, 0xffff0000, v6
    v_lshlrev_b32 v161, 16, v7
    v_mfma_f32_16x16x32_bf16 v[92:95], a[40:43], a[8:11], v[92:95]
    v_and_b32 v163, 0xffff0000, v7
    s_cmp_eq_u32 s27, 6
    s_cselect_b32 s36, s29, 256
    v_mfma_f32_16x16x32_bf16 v[96:99], a[72:75], a[8:11], v[96:99]
    s_cmp_lt_u32 s27, 7
    s_cselect_b32 s36, s36, 0
    v_mfma_f32_16x16x32_bf16 v[92:95], a[44:47], a[12:15], v[92:95]
    v_add_u32 v10, s36, v10
    v_mul_f32 v156, s58, v156
    v_mul_f32 v157, s58, v157
    v_mfma_f32_16x16x32_bf16 v[96:99], a[76:79], a[12:15], v[96:99]
    v_mul_f32 v158, s58, v158
    v_mul_f32 v159, s58, v159
    v_and_b32 v1, s83, v19
    s_waitcnt lgkmcnt(0)
    v_ldexp_f32 v168, v152, 3
    v_ldexp_f32 v169, v153, 3
    global_load_dword v2, v10, s[40:41]
    v_mfma_f32_16x16x32_bf16 v[100:103], a[96:99], a[0:3], 0
    v_ldexp_f32 v170, v154, 3
    v_ldexp_f32 v171, v155, 3
    global_load_dword v3, v10, s[42:43]
    v_mfma_f32_16x16x32_bf16 v[92:95], a[48:51], a[16:19], v[92:95]
    v_ldexp_f32 v184, v152, 7
    v_ldexp_f32 v185, v153, 7
    global_load_dword v4, v10, s[44:45]
    v_mfma_f32_16x16x32_bf16 v[100:103], a[100:103], a[4:7], v[100:103]
    v_ldexp_f32 v186, v154, 7
    v_ldexp_f32 v187, v155, 7
    global_load_dword v5, v10, s[46:47]
    v_mfma_f32_16x16x32_bf16 v[96:99], a[80:83], a[16:19], v[96:99]
    v_ldexp_f32 v192, v152, 10
    v_ldexp_f32 v193, v153, 10
    v_mfma_f32_16x16x32_bf16 v[100:103], a[104:107], a[8:11], v[100:103]
    global_load_dword v6, v10, s[48:49]
    v_ldexp_f32 v194, v154, 10
    v_ldexp_f32 v195, v155, 10
    v_mfma_f32_16x16x32_bf16 v[92:95], a[52:55], a[20:23], v[92:95]
    global_load_dword v7, v10, s[50:51]
    v_fract_f32 v169, v169
    v_fract_f32 v171, v171
    v_mfma_f32_16x16x32_bf16 v[100:103], a[108:111], a[12:15], v[100:103]
    v_fract_f32 v177, v153
    v_fract_f32 v179, v155
    v_fract_f32 v185, v185
    v_mfma_f32_16x16x32_bf16 v[96:99], a[84:87], a[20:23], v[96:99]
    v_fract_f32 v187, v187
    v_fract_f32 v193, v193
    v_fract_f32 v195, v195
    v_mfma_f32_16x16x32_bf16 v[100:103], a[112:115], a[16:19], v[100:103]
    v_exp_f32 v168, v168
    v_exp_f32 v170, v170
    v_exp_f32 v176, v152
    v_mfma_f32_16x16x32_bf16 v[92:95], a[56:59], a[24:27], v[92:95]
    v_exp_f32 v178, v154
    v_exp_f32 v184, v184
    v_mfma_f32_16x16x32_bf16 v[100:103], a[116:119], a[20:23], v[100:103]
    v_exp_f32 v186, v186
    v_exp_f32 v192, v192
    v_exp_f32 v194, v194
    v_mfma_f32_16x16x32_bf16 v[96:99], a[88:91], a[24:27], v[96:99]
    v_cos_f32 v164, v169
    v_sin_f32 v165, v169
    v_cos_f32 v166, v171
    v_mfma_f32_16x16x32_bf16 v[100:103], a[120:123], a[24:27], v[100:103]
    v_sin_f32 v167, v171
    v_cos_f32 v172, v177
    v_sin_f32 v173, v177
    v_mfma_f32_16x16x32_bf16 v[92:95], a[60:63], a[28:31], v[92:95]
    v_cos_f32 v174, v179
    v_sin_f32 v175, v179
    v_cos_f32 v180, v185
    v_mfma_f32_16x16x32_bf16 v[100:103], a[124:127], a[28:31], v[100:103]
    v_sin_f32 v181, v185
    v_cos_f32 v182, v187
    v_sin_f32 v183, v187
    v_mfma_f32_16x16x32_bf16 v[96:99], a[92:95], a[28:31], v[96:99]
    v_cos_f32 v188, v193
    v_sin_f32 v189, v193
    v_cos_f32 v190, v195
    v_sin_f32 v191, v195
    v_pk_mul_f32 v[196:197], v[156:157], v[160:161] op_sel:[0,0] op_sel_hi:[1,0] neg_hi:[1,0]
    v_pk_mul_f32 v[198:199], v[158:159], v[162:163] op_sel:[0,0] op_sel_hi:[1,0] neg_hi:[1,0]
    v_pk_mul_f32 v[164:165], v[164:165], v[168:169] op_sel_hi:[1,0] neg_hi:[1,0]
    v_pk_mul_f32 v[166:167], v[166:167], v[170:171] op_sel_hi:[1,0] neg_hi:[1,0]
    v_pk_mul_f32 v[172:173], v[172:173], v[176:177] op_sel_hi:[1,0]
    v_pk_mul_f32 v[174:175], v[174:175], v[178:179] op_sel_hi:[1,0]
    v_pk_fma_f32 v[196:197], v[156:157], v[160:161], v[196:197] op_sel:[1,1,0] op_sel_hi:[0,1,1] neg_lo:[1,0,0] neg_hi:[1,0,0]
    v_pk_fma_f32 v[198:199], v[158:159], v[162:163], v[198:199] op_sel:[1,1,0] op_sel_hi:[0,1,1] neg_lo:[1,0,0] neg_hi:[1,0,0]
    v_pk_mul_f32 v[180:181], v[180:181], v[184:185] op_sel_hi:[1,0]
    v_pk_mul_f32 v[182:183], v[182:183], v[186:187] op_sel_hi:[1,0]
    v_pk_mul_f32 v[188:189], v[188:189], v[192:193] op_sel_hi:[1,0]
    v_pk_mul_f32 v[190:191], v[190:191], v[194:195] op_sel_hi:[1,0]
    v_pk_mul_f32 v[200:201], v[164:165], v[164:165] op_sel:[0,0] op_sel_hi:[1,0]
    v_pk_mul_f32 v[202:203], v[166:167], v[166:167] op_sel:[0,0] op_sel_hi:[1,0]
    v_pk_mul_f32 v[204:205], v[172:173], v[172:173] op_sel:[0,0] op_sel_hi:[1,0]
    v_pk_mul_f32 v[206:207], v[174:175], v[174:175] op_sel:[0,0] op_sel_hi:[1,0]
    v_cvt_pk_bf16_f32 v96, v96, v97
    v_pk_fma_f32 v[200:201], v[164:165], v[164:165], v[200:201] op_sel:[1,1,0] op_sel_hi:[0,1,1] neg_lo:[1,0,0]
    v_pk_fma_f32 v[202:203], v[166:167], v[166:167], v[202:203] op_sel:[1,1,0] op_sel_hi:[0,1,1] neg_lo:[1,0,0]
    v_pk_mul_f32 v[208:209], v[200:201], v[200:201] op_sel:[0,0] op_sel_hi:[1,0]
    v_pk_mul_f32 v[210:211], v[202:203], v[202:203] op_sel:[0,0] op_sel_hi:[1,0]
    v_cvt_pk_bf16_f32 v98, v98, v99
    v_pk_fma_f32 v[204:205], v[172:173], v[172:173], v[204:205] op_sel:[1,1,0] op_sel_hi:[0,1,1] neg_lo:[1,0,0]
    v_pk_fma_f32 v[206:207], v[174:175], v[174:175], v[206:207] op_sel:[1,1,0] op_sel_hi:[0,1,1] neg_lo:[1,0,0]
    v_pk_mul_f32 v[212:213], v[180:181], v[180:181] op_sel:[0,0] op_sel_hi:[1,0]
    v_cvt_pk_bf16_f32 v100, v100, v101
    v_pk_mul_f32 v[214:215], v[182:183], v[182:183] op_sel:[0,0] op_sel_hi:[1,0]
    v_pk_fma_f32 v[208:209], v[200:201], v[200:201], v[208:209] op_sel:[1,1,0] op_sel_hi:[0,1,1] neg_lo:[1,0,0]
    v_pk_fma_f32 v[210:211], v[202:203], v[202:203], v[210:211] op_sel:[1,1,0] op_sel_hi:[0,1,1] neg_lo:[1,0,0]
    v_pk_mul_f32 v[216:217], v[208:209], v[208:209] op_sel:[0,0] op_sel_hi:[1,0]
    v_cvt_pk_bf16_f32 v102, v102, v103
    v_pk_mul_f32 v[218:219], v[210:211], v[210:211] op_sel:[0,0] op_sel_hi:[1,0]
    v_pk_fma_f32 v[212:213], v[180:181], v[180:181], v[212:213] op_sel:[1,1,0] op_sel_hi:[0,1,1] neg_lo:[1,0,0]
    v_pk_fma_f32 v[214:215], v[182:183], v[182:183], v[214:215] op_sel:[1,1,0] op_sel_hi:[0,1,1] neg_lo:[1,0,0]
    v_pk_mul_f32 v[220:221], v[172:173], v[180:181] op_sel:[0,0] op_sel_hi:[1,0]
    v_cvt_pk_bf16_f32 v92, v92, v93
    v_pk_mul_f32 v[222:223], v[174:175], v[182:183] op_sel:[0,0] op_sel_hi:[1,0]
    v_pk_fma_f32 v[216:217], v[208:209], v[208:209], v[216:217] op_sel:[1,1,0] op_sel_hi:[0,1,1] neg_lo:[1,0,0]
    v_pk_fma_f32 v[218:219], v[210:211], v[210:211], v[218:219] op_sel:[1,1,0] op_sel_hi:[0,1,1] neg_lo:[1,0,0]
    v_cvt_pk_bf16_f32 v93, v94, v95
    v_pk_mul_f32 v[224:225], v[196:197], v[164:165] op_sel:[0,0] op_sel_hi:[1,0]
    v_pk_mul_f32 v[226:227], v[198:199], v[166:167] op_sel:[0,0] op_sel_hi:[1,0]
    v_pk_fma_f32 v[220:221], v[172:173], v[180:181], v[220:221] op_sel:[1,1,0] op_sel_hi:[0,1,1] neg_lo:[1,0,0]
    v_pk_fma_f32 v[222:223], v[174:175], v[182:183], v[222:223] op_sel:[1,1,0] op_sel_hi:[0,1,1] neg_lo:[1,0,0]
    ds_write_b32 v16, v96
    v_cvt_pk_bf16_f32 v138, v172, v173
    v_cvt_pk_bf16_f32 v139, v174, v175
    v_pk_mul_f32 v[228:229], v[196:197], v[216:217] op_sel:[0,0] op_sel_hi:[1,0]
    ds_write_b32 v17, v98
    v_pk_mul_f32 v[230:231], v[198:199], v[218:219] op_sel:[0,0] op_sel_hi:[1,0]
    v_pk_fma_f32 v[224:225], v[196:197], v[164:165], v[224:225] op_sel:[1,1,0] op_sel_hi:[0,1,1] neg_lo:[1,0,0]
    v_pk_fma_f32 v[226:227], v[198:199], v[166:167], v[226:227] op_sel:[1,1,0] op_sel_hi:[0,1,1] neg_lo:[1,0,0]
    v_cvt_pk_bf16_f32 v136, v220, v221
    ds_write_b16 v18, v100
    v_cvt_pk_bf16_f32 v137, v222, v223
    v_pk_mul_f32 v[232:233], v[204:205], v[204:205] op_sel:[0,0] op_sel_hi:[1,0]
    v_pk_mul_f32 v[234:235], v[206:207], v[206:207] op_sel:[0,0] op_sel_hi:[1,0]
    ds_write2st64_b64 v31, v[136:137], v[138:139] offset0:25 offset1:17
    ds_write_b16_d16_hi v18, v100 offset:64
    v_pk_fma_f32 v[228:229], v[196:197], v[216:217], v[228:229] op_sel:[1,1,0] op_sel_hi:[0,1,1] neg_lo:[1,0,0]
    v_pk_fma_f32 v[230:231], v[198:199], v[218:219], v[230:231] op_sel:[1,1,0] op_sel_hi:[0,1,1] neg_lo:[1,0,0]
    v_cvt_pk_bf16_f32 v142, v196, v197
    ds_write_b16 v18, v102 offset:128
    v_cvt_pk_bf16_f32 v143, v198, v199
    v_pk_mul_f32 v[236:237], v[204:205], v[180:181] op_sel:[0,0] op_sel_hi:[1,0]
    v_pk_mul_f32 v[238:239], v[206:207], v[182:183] op_sel:[0,0] op_sel_hi:[1,0]
    v_pk_fma_f32 v[232:233], v[204:205], v[204:205], v[232:233] op_sel:[1,1,0] op_sel_hi:[0,1,1] neg_lo:[1,0,0]
    ds_write_b16_d16_hi v18, v102 offset:192
    v_pk_fma_f32 v[234:235], v[206:207], v[206:207], v[234:235] op_sel:[1,1,0] op_sel_hi:[0,1,1] neg_lo:[1,0,0]
    v_cvt_pk_bf16_f32 v140, v228, v229
    v_cvt_pk_bf16_f32 v141, v230, v231
    v_pk_mul_f32 v[240:241], v[196:197], v[200:201] op_sel:[0,0] op_sel_hi:[1,0]
    ds_write_b64 v15, v[92:93]
    v_pk_mul_f32 v[242:243], v[198:199], v[202:203] op_sel:[0,0] op_sel_hi:[1,0]
    ds_write2st64_b64 v30, v[140:141], v[142:143] offset0:8 offset1:0
    v_pk_fma_f32 v[236:237], v[204:205], v[180:181], v[236:237] op_sel:[1,1,0] op_sel_hi:[0,1,1] neg_lo:[1,0,0]
    ds_read_b128 v[116:119], v39 offset:30720
    v_pk_fma_f32 v[238:239], v[206:207], v[182:183], v[238:239] op_sel:[1,1,0] op_sel_hi:[0,1,1] neg_lo:[1,0,0]
    v_cvt_pk_bf16_f32 v146, v204, v205
    v_cvt_pk_bf16_f32 v147, v206, v207
    v_pk_mul_f32 v[244:245], v[224:225], v[216:217] op_sel:[0,0] op_sel_hi:[1,0]
    ds_read_b128 v[120:123], v39 offset:31744
    v_pk_mul_f32 v[246:247], v[226:227], v[218:219] op_sel:[0,0] op_sel_hi:[1,0]
    v_pk_fma_f32 v[240:241], v[196:197], v[200:201], v[240:241] op_sel:[1,1,0] op_sel_hi:[0,1,1] neg_lo:[1,0,0]
    v_pk_fma_f32 v[242:243], v[198:199], v[202:203], v[242:243] op_sel:[1,1,0] op_sel_hi:[0,1,1] neg_lo:[1,0,0]
    v_cvt_pk_bf16_f32 v144, v236, v237
    v_cvt_pk_bf16_f32 v145, v238, v239
    v_pk_mul_f32 v[248:249], v[196:197], v[208:209] op_sel:[0,0] op_sel_hi:[1,0]
    v_pk_mul_f32 v[250:251], v[198:199], v[210:211] op_sel:[0,0] op_sel_hi:[1,0]
    ds_write2st64_b64 v32, v[144:145], v[146:147] offset0:26 offset1:18
    v_pk_fma_f32 v[244:245], v[224:225], v[216:217], v[244:245] op_sel:[1,1,0] op_sel_hi:[0,1,1] neg_lo:[1,0,0]
    v_pk_fma_f32 v[246:247], v[226:227], v[218:219], v[246:247] op_sel:[1,1,0] op_sel_hi:[0,1,1] neg_lo:[1,0,0]
    v_cvt_pk_bf16_f32 v150, v224, v225
    v_cvt_pk_bf16_f32 v151, v226, v227
    v_pk_mul_f32 v[252:253], v[240:241], v[216:217] op_sel:[0,0] op_sel_hi:[1,0]
    v_pk_mul_f32 v[254:255], v[242:243], v[218:219] op_sel:[0,0] op_sel_hi:[1,0]
    s_waitcnt lgkmcnt(1)
    v_pk_fma_f32 v[248:249], v[196:197], v[208:209], v[248:249] op_sel:[1,1,0] op_sel_hi:[0,1,1] neg_lo:[1,0,0]
    v_pk_fma_f32 v[250:251], v[198:199], v[210:211], v[250:251] op_sel:[1,1,0] op_sel_hi:[0,1,1] neg_lo:[1,0,0]
    v_cvt_pk_bf16_f32 v148, v244, v245
    v_cvt_pk_bf16_f32 v149, v246, v247
    s_waitcnt vmcnt(12)
    v_pk_mul_f32 v[152:153], v[224:225], v[200:201] op_sel:[0,0] op_sel_hi:[1,0]
    v_pk_mul_f32 v[154:155], v[226:227], v[202:203] op_sel:[0,0] op_sel_hi:[1,0]
    ds_write2st64_b64 v31, v[148:149], v[150:151] offset0:9 offset1:1
    ds_read_b64_tr_b16 a[144:145], v21 offset:0
    v_pk_fma_f32 v[252:253], v[240:241], v[216:217], v[252:253] op_sel:[1,1,0] op_sel_hi:[0,1,1] neg_lo:[1,0,0]
    v_pk_fma_f32 v[254:255], v[242:243], v[218:219], v[254:255] op_sel:[1,1,0] op_sel_hi:[0,1,1] neg_lo:[1,0,0]
    v_cvt_pk_bf16_f32 v138, v240, v241
    v_cvt_pk_bf16_f32 v139, v242, v243
    ds_read_b64_tr_b16 a[146:147], v21 offset:256
    v_pk_mul_f32 v[156:157], v[248:249], v[216:217] op_sel:[0,0] op_sel_hi:[1,0]
    v_pk_mul_f32 v[158:159], v[250:251], v[218:219] op_sel:[0,0] op_sel_hi:[1,0]
    v_pk_fma_f32 v[152:153], v[224:225], v[200:201], v[152:153] op_sel:[1,1,0] op_sel_hi:[0,1,1] neg_lo:[1,0,0]
    v_pk_fma_f32 v[154:155], v[226:227], v[202:203], v[154:155] op_sel:[1,1,0] op_sel_hi:[0,1,1] neg_lo:[1,0,0]
    ds_read_b64_tr_b16 a[148:149], v21 offset:16
    v_cvt_pk_bf16_f32 v136, v252, v253
    v_cvt_pk_bf16_f32 v137, v254, v255
    v_pk_mul_f32 v[160:161], v[224:225], v[208:209] op_sel:[0,0] op_sel_hi:[1,0]
    ds_read_b64_tr_b16 a[150:151], v21 offset:272
    v_pk_mul_f32 v[162:163], v[226:227], v[210:211] op_sel:[0,0] op_sel_hi:[1,0]
    ds_write2st64_b64 v32, v[136:137], v[138:139] offset0:10 offset1:2
    v_pk_fma_f32 v[156:157], v[248:249], v[216:217], v[156:157] op_sel:[1,1,0] op_sel_hi:[0,1,1] neg_lo:[1,0,0]
    v_pk_fma_f32 v[158:159], v[250:251], v[218:219], v[158:159] op_sel:[1,1,0] op_sel_hi:[0,1,1] neg_lo:[1,0,0]
    ds_read_b64_tr_b16 a[152:153], v21 offset:32
    v_cvt_pk_bf16_f32 v142, v248, v249
    v_cvt_pk_bf16_f32 v143, v250, v251
    v_pk_mul_f32 v[168:169], v[152:153], v[216:217] op_sel:[0,0] op_sel_hi:[1,0]
    v_pk_mul_f32 v[170:171], v[154:155], v[218:219] op_sel:[0,0] op_sel_hi:[1,0]
    ds_read_b64_tr_b16 a[154:155], v21 offset:288
    v_pk_fma_f32 v[160:161], v[224:225], v[208:209], v[160:161] op_sel:[1,1,0] op_sel_hi:[0,1,1] neg_lo:[1,0,0]
    v_pk_fma_f32 v[162:163], v[226:227], v[210:211], v[162:163] op_sel:[1,1,0] op_sel_hi:[0,1,1] neg_lo:[1,0,0]
    v_cvt_pk_bf16_f32 v140, v156, v157
    ds_read_b64_tr_b16 a[156:157], v21 offset:48
    v_cvt_pk_bf16_f32 v141, v158, v159
    v_pk_mul_f32 v[176:177], v[240:241], v[208:209] op_sel:[0,0] op_sel_hi:[1,0]
    v_pk_mul_f32 v[178:179], v[242:243], v[210:211] op_sel:[0,0] op_sel_hi:[1,0]
    ds_write2st64_b64 v34, v[140:141], v[142:143] offset0:12 offset1:4
    ds_read_b64_tr_b16 a[158:159], v21 offset:304
    v_pk_fma_f32 v[168:169], v[152:153], v[216:217], v[168:169] op_sel:[1,1,0] op_sel_hi:[0,1,1] neg_lo:[1,0,0]
    v_pk_fma_f32 v[170:171], v[154:155], v[218:219], v[170:171] op_sel:[1,1,0] op_sel_hi:[0,1,1] neg_lo:[1,0,0]
    v_cvt_pk_bf16_f32 v146, v152, v153
    v_cvt_pk_bf16_f32 v147, v154, v155
    v_pk_mul_f32 v[184:185], v[160:161], v[216:217] op_sel:[0,0] op_sel_hi:[1,0]
    v_pk_mul_f32 v[186:187], v[162:163], v[218:219] op_sel:[0,0] op_sel_hi:[1,0]
    v_pk_fma_f32 v[176:177], v[240:241], v[208:209], v[176:177] op_sel:[1,1,0] op_sel_hi:[0,1,1] neg_lo:[1,0,0]
    ds_read_b128 v[72:75], v22 offset:0
    v_pk_fma_f32 v[178:179], v[242:243], v[210:211], v[178:179] op_sel:[1,1,0] op_sel_hi:[0,1,1] neg_lo:[1,0,0]
    v_cvt_pk_bf16_f32 v144, v168, v169
    v_cvt_pk_bf16_f32 v145, v170, v171
    v_pk_mul_f32 v[192:193], v[152:153], v[208:209] op_sel:[0,0] op_sel_hi:[1,0]
    ds_read_b128 v[76:79], v22 offset:1024
    v_pk_mul_f32 v[194:195], v[154:155], v[210:211] op_sel:[0,0] op_sel_hi:[1,0]
    ds_write2st64_b64 v33, v[144:145], v[146:147] offset0:11 offset1:3
    v_pk_fma_f32 v[184:185], v[160:161], v[216:217], v[184:185] op_sel:[1,1,0] op_sel_hi:[0,1,1] neg_lo:[1,0,0]
    ds_read_b128 v[80:83], v22 offset:2048
    v_pk_fma_f32 v[186:187], v[162:163], v[218:219], v[186:187] op_sel:[1,1,0] op_sel_hi:[0,1,1] neg_lo:[1,0,0]
    v_cvt_pk_bf16_f32 v150, v160, v161
    v_cvt_pk_bf16_f32 v151, v162, v163
    v_pk_mul_f32 v[164:165], v[176:177], v[216:217] op_sel:[0,0] op_sel_hi:[1,0]
    ds_read_b128 v[84:87], v22 offset:3072
    v_pk_mul_f32 v[166:167], v[178:179], v[218:219] op_sel:[0,0] op_sel_hi:[1,0]
    v_pk_fma_f32 v[192:193], v[152:153], v[208:209], v[192:193] op_sel:[1,1,0] op_sel_hi:[0,1,1] neg_lo:[1,0,0]
    v_pk_fma_f32 v[194:195], v[154:155], v[210:211], v[194:195] op_sel:[1,1,0] op_sel_hi:[0,1,1] neg_lo:[1,0,0]
    v_cvt_pk_bf16_f32 v148, v184, v185
    v_cvt_pk_bf16_f32 v149, v186, v187
    v_pk_mul_f32 v[220:221], v[204:205], v[172:173] op_sel:[0,0] op_sel_hi:[1,0]
    v_pk_mul_f32 v[222:223], v[206:207], v[174:175] op_sel:[0,0] op_sel_hi:[1,0]
    ds_write2st64_b64 v35, v[148:149], v[150:151] offset0:13 offset1:5
    v_pk_fma_f32 v[164:165], v[176:177], v[216:217], v[164:165] op_sel:[1,1,0] op_sel_hi:[0,1,1] neg_lo:[1,0,0]
    v_pk_fma_f32 v[166:167], v[178:179], v[218:219], v[166:167] op_sel:[1,1,0] op_sel_hi:[0,1,1] neg_lo:[1,0,0]
    v_cvt_pk_bf16_f32 v138, v176, v177
    v_cvt_pk_bf16_f32 v139, v178, v179
    v_pk_mul_f32 v[228:229], v[192:193], v[216:217] op_sel:[0,0] op_sel_hi:[1,0]
    v_pk_mul_f32 v[230:231], v[194:195], v[218:219] op_sel:[0,0] op_sel_hi:[1,0]
    s_waitcnt lgkmcnt(1)
    v_pk_fma_f32 v[220:221], v[204:205], v[172:173], v[220:221] op_sel:[1,1,0] op_sel_hi:[0,1,1] neg_lo:[1,0,0]
    v_pk_fma_f32 v[222:223], v[206:207], v[174:175], v[222:223] op_sel:[1,1,0] op_sel_hi:[0,1,1] neg_lo:[1,0,0]
    v_cvt_pk_bf16_f32 v136, v164, v165
    v_cvt_pk_bf16_f32 v137, v166, v167
    v_mfma_f32_16x16x32_bf16 a[128:131], v[72:75], v[60:63], a[128:131]
    v_pk_mul_f32 v[236:237], v[232:233], v[172:173] op_sel:[0,0] op_sel_hi:[1,0]
    v_pk_mul_f32 v[238:239], v[234:235], v[174:175] op_sel:[0,0] op_sel_hi:[1,0]
    ds_write2st64_b64 v36, v[136:137], v[138:139] offset0:14 offset1:6
    v_pk_fma_f32 v[228:229], v[192:193], v[216:217], v[228:229] op_sel:[1,1,0] op_sel_hi:[0,1,1] neg_lo:[1,0,0]
    v_mfma_f32_16x16x32_bf16 a[132:135], v[76:79], v[60:63], a[132:135]
    v_pk_fma_f32 v[230:231], v[194:195], v[218:219], v[230:231] op_sel:[1,1,0] op_sel_hi:[0,1,1] neg_lo:[1,0,0]
    v_cvt_pk_bf16_f32 v142, v192, v193
    v_cvt_pk_bf16_f32 v143, v194, v195
    v_mfma_f32_16x16x32_bf16 a[136:139], v[80:83], v[60:63], a[136:139]
    v_pk_mul_f32 v[196:197], v[232:233], v[180:181] op_sel:[0,0] op_sel_hi:[1,0]
    v_pk_mul_f32 v[198:199], v[234:235], v[182:183] op_sel:[0,0] op_sel_hi:[1,0]
    v_pk_fma_f32 v[236:237], v[232:233], v[172:173], v[236:237] op_sel:[1,1,0] op_sel_hi:[0,1,1] neg_lo:[1,0,0]
    v_pk_fma_f32 v[238:239], v[234:235], v[174:175], v[238:239] op_sel:[1,1,0] op_sel_hi:[0,1,1] neg_lo:[1,0,0]
    v_mfma_f32_16x16x32_bf16 a[140:143], v[84:87], v[60:63], a[140:143]
    v_cvt_pk_bf16_f32 v140, v228, v229
    v_cvt_pk_bf16_f32 v141, v230, v231
    v_pk_mul_f32 v[244:245], v[232:233], v[204:205] op_sel:[0,0] op_sel_hi:[1,0]
    s_add_u32 m0, s26, 32768
    v_pk_mul_f32 v[246:247], v[234:235], v[206:207] op_sel:[0,0] op_sel_hi:[1,0]
    ds_write2st64_b64 v37, v[140:141], v[142:143] offset0:15 offset1:7
    v_pk_fma_f32 v[196:197], v[232:233], v[180:181], v[196:197] op_sel:[1,1,0] op_sel_hi:[0,1,1] neg_lo:[1,0,0]
    v_pk_fma_f32 v[198:199], v[234:235], v[182:183], v[198:199] op_sel:[1,1,0] op_sel_hi:[0,1,1] neg_lo:[1,0,0]
    s_add_u32 s33, s30, 31744
    v_cvt_pk_bf16_f32 v146, v232, v233
    v_cvt_pk_bf16_f32 v147, v234, v235
    ds_read_b128 a[0:3], v14 offset:0
    v_pk_mul_f32 v[200:201], v[220:221], v[180:181] op_sel:[0,0] op_sel_hi:[1,0]
    buffer_load_dwordx4 v20, s[8:11], s30 offen lds
    v_pk_mul_f32 v[202:203], v[222:223], v[182:183] op_sel:[0,0] op_sel_hi:[1,0]
    v_pk_fma_f32 v[244:245], v[232:233], v[204:205], v[244:245] op_sel:[1,1,0] op_sel_hi:[0,1,1] neg_lo:[1,0,0]
    v_pk_fma_f32 v[246:247], v[234:235], v[206:207], v[246:247] op_sel:[1,1,0] op_sel_hi:[0,1,1] neg_lo:[1,0,0]
    s_add_u32 s34, s30, 63488
    v_cvt_pk_bf16_f32 v144, v196, v197
    v_cvt_pk_bf16_f32 v145, v198, v199
    ds_read_b128 a[4:7], v38 offset:0
    v_pk_mul_f32 v[252:253], v[232:233], v[220:221] op_sel:[0,0] op_sel_hi:[1,0]
    buffer_load_dwordx4 v20, s[8:11], s33 offen offset:1024 lds
    v_pk_mul_f32 v[254:255], v[234:235], v[222:223] op_sel:[0,0] op_sel_hi:[1,0]
    ds_write2st64_b64 v34, v[144:145], v[146:147] offset0:28 offset1:20
    v_pk_fma_f32 v[200:201], v[220:221], v[180:181], v[200:201] op_sel:[1,1,0] op_sel_hi:[0,1,1] neg_lo:[1,0,0]
    v_pk_fma_f32 v[202:203], v[222:223], v[182:183], v[202:203] op_sel:[1,1,0] op_sel_hi:[0,1,1] neg_lo:[1,0,0]
    s_add_u32 s33, s30, 95232
    v_cvt_pk_bf16_f32 v150, v220, v221
    v_cvt_pk_bf16_f32 v151, v222, v223
    ds_read_b128 a[8:11], v43 offset:0
    buffer_load_dwordx4 v20, s[8:11], s34 offen offset:2048 lds
    v_pk_mul_f32 v[248:249], v[236:237], v[180:181] op_sel:[0,0] op_sel_hi:[1,0]
    v_pk_mul_f32 v[250:251], v[238:239], v[182:183] op_sel:[0,0] op_sel_hi:[1,0]
    v_pk_fma_f32 v[252:253], v[232:233], v[220:221], v[252:253] op_sel:[1,1,0] op_sel_hi:[0,1,1] neg_lo:[1,0,0]
    v_pk_fma_f32 v[254:255], v[234:235], v[222:223], v[254:255] op_sel:[1,1,0] op_sel_hi:[0,1,1] neg_lo:[1,0,0]
    s_add_u32 s30, s30, 64
    v_cvt_pk_bf16_f32 v148, v200, v201
    v_cvt_pk_bf16_f32 v149, v202, v203
    ds_read_b128 a[12:15], v59 offset:0
    buffer_load_dwordx4 v20, s[8:11], s33 offen offset:3072 lds
    v_pk_mul_f32 v[224:225], v[212:213], v[180:181] op_sel:[0,0] op_sel_hi:[1,0]
    v_pk_mul_f32 v[226:227], v[214:215], v[182:183] op_sel:[0,0] op_sel_hi:[1,0]
    ds_write2st64_b64 v33, v[148:149], v[150:151] offset0:27 offset1:19
    v_pk_fma_f32 v[248:249], v[236:237], v[180:181], v[248:249] op_sel:[1,1,0] op_sel_hi:[0,1,1] neg_lo:[1,0,0]
    buffer_load_dwordx4 v[60:63], v24, s[20:23], s32 offen
    v_pk_fma_f32 v[250:251], v[238:239], v[182:183], v[250:251] op_sel:[1,1,0] op_sel_hi:[0,1,1] neg_lo:[1,0,0]
    v_cvt_pk_bf16_f32 v138, v236, v237
    v_cvt_pk_bf16_f32 v139, v238, v239
    ds_read_b128 a[16:19], v14 offset:256
    s_add_u32 s32, s32, 64
    v_pk_mul_f32 v[156:157], v[244:245], v[180:181] op_sel:[0,0] op_sel_hi:[1,0]
    v_pk_mul_f32 v[158:159], v[246:247], v[182:183] op_sel:[0,0] op_sel_hi:[1,0]
    v_pk_fma_f32 v[224:225], v[212:213], v[180:181], v[224:225] op_sel:[1,1,0] op_sel_hi:[0,1,1] neg_lo:[1,0,0]
    buffer_store_dwordx4 v[116:119], v12, s[12:15], s28 offen offset:0 sc1
    v_pk_fma_f32 v[226:227], v[214:215], v[182:183], v[226:227] op_sel:[1,1,0] op_sel_hi:[0,1,1] neg_lo:[1,0,0]
    v_cvt_pk_bf16_f32 v136, v248, v249
    v_cvt_pk_bf16_f32 v137, v250, v251
    ds_read_b128 a[20:23], v38 offset:256
    buffer_store_dwordx4 v[120:123], v12, s[12:15], s28 offen offset:1024 sc1
    ds_write2st64_b64 v35, v[136:137], v[138:139] offset0:29 offset1:21
    v_pk_fma_f32 v[156:157], v[244:245], v[180:181], v[156:157] op_sel:[1,1,0] op_sel_hi:[0,1,1] neg_lo:[1,0,0]
    v_pk_fma_f32 v[158:159], v[246:247], v[182:183], v[158:159] op_sel:[1,1,0] op_sel_hi:[0,1,1] neg_lo:[1,0,0]
    v_cvt_pk_bf16_f32 v142, v244, v245
    s_add_u32 s28, s28, 2048
    v_cvt_pk_bf16_f32 v143, v246, v247
    ds_read_b128 a[24:27], v43 offset:256
    v_pk_mul_f32 v[240:241], v[252:253], v[180:181] op_sel:[0,0] op_sel_hi:[1,0]
    buffer_store_dwordx4 a[144:147], v23, s[16:19], s31 offen sc1
    v_pk_mul_f32 v[242:243], v[254:255], v[182:183] op_sel:[0,0] op_sel_hi:[1,0]
    v_cvt_pk_bf16_f32 v140, v156, v157
    v_cvt_pk_bf16_f32 v141, v158, v159
    ds_read_b128 a[28:31], v59 offset:256
    s_add_u32 s31, s31, 32768
    v_pk_mul_f32 v[168:169], v[212:213], v[204:205] op_sel:[0,0] op_sel_hi:[1,0]
    v_pk_mul_f32 v[170:171], v[214:215], v[206:207] op_sel:[0,0] op_sel_hi:[1,0]
    ds_write2st64_b64 v36, v[140:141], v[142:143] offset0:30 offset1:22
    buffer_store_dwordx4 a[148:151], v23, s[16:19], s31 offen sc1
    v_pk_fma_f32 v[240:241], v[252:253], v[180:181], v[240:241] op_sel:[1,1,0] op_sel_hi:[0,1,1] neg_lo:[1,0,0]
    v_pk_fma_f32 v[242:243], v[254:255], v[182:183], v[242:243] op_sel:[1,1,0] op_sel_hi:[0,1,1] neg_lo:[1,0,0]
    v_cvt_pk_bf16_f32 v150, v252, v253
    v_cvt_pk_bf16_f32 v151, v254, v255
    s_add_u32 s31, s31, 32768
    v_cvt_pk_bf16_f32 v144, v180, v181
    v_cvt_pk_bf16_f32 v145, v182, v183
    v_pk_mul_f32 v[160:161], v[212:213], v[212:213] op_sel:[0,0] op_sel_hi:[1,0]
    v_pk_mul_f32 v[162:163], v[214:215], v[214:215] op_sel:[0,0] op_sel_hi:[1,0]
    buffer_store_dwordx4 a[152:155], v23, s[16:19], s31 offen sc1
    ds_write_b64 v30, v[144:145] offset:12288
    v_pk_fma_f32 v[168:169], v[212:213], v[204:205], v[168:169] op_sel:[1,1,0] op_sel_hi:[0,1,1] neg_lo:[1,0,0]
    v_pk_fma_f32 v[170:171], v[214:215], v[206:207], v[170:171] op_sel:[1,1,0] op_sel_hi:[0,1,1] neg_lo:[1,0,0]
    s_add_u32 s31, s31, 32768
    v_cvt_pk_bf16_f32 v148, v240, v241
    v_cvt_pk_bf16_f32 v149, v242, v243
    v_pk_mul_f32 v[208:209], v[188:189], v[188:189] op_sel:[0,0] op_sel_hi:[1,0]
    v_pk_mul_f32 v[210:211], v[190:191], v[190:191] op_sel:[0,0] op_sel_hi:[1,0]
    buffer_store_dwordx4 a[156:159], v23, s[16:19], s31 offen sc1
    ds_write2st64_b64 v37, v[148:149], v[150:151] offset0:31 offset1:23
    v_pk_fma_f32 v[160:161], v[212:213], v[212:213], v[160:161] op_sel:[1,1,0] op_sel_hi:[0,1,1] neg_lo:[1,0,0]
    v_pk_fma_f32 v[162:163], v[214:215], v[214:215], v[162:163] op_sel:[1,1,0] op_sel_hi:[0,1,1] neg_lo:[1,0,0]
    s_add_u32 s31, s31, 32768
    v_cvt_pk_bf16_f32 v138, v212, v213
    v_cvt_pk_bf16_f32 v139, v214, v215
    ds_read_b128 a[32:35], v14 offset:8192
    v_pk_mul_f32 v[152:153], v[160:161], v[232:233] op_sel:[0,0] op_sel_hi:[1,0]
    s_cmp_lg_u32 s27, 6
    s_cbranch_scc1 fused_kernel_npf
    global_load_dword v25, v[104:105], off
    global_load_dword v57, v58, s[98:99] sc1
    fused_kernel_npf:
    v_pk_mul_f32 v[154:155], v[162:163], v[234:235] op_sel:[0,0] op_sel_hi:[1,0]
    v_pk_fma_f32 v[208:209], v[188:189], v[188:189], v[208:209] op_sel:[1,1,0] op_sel_hi:[0,1,1] neg_lo:[1,0,0]
    v_pk_fma_f32 v[210:211], v[190:191], v[190:191], v[210:211] op_sel:[1,1,0] op_sel_hi:[0,1,1] neg_lo:[1,0,0]
    v_cvt_pk_bf16_f32 v136, v160, v161
    v_cvt_pk_bf16_f32 v137, v162, v163
    ds_read_b128 a[36:39], v38 offset:8192
    v_pk_mul_f32 v[184:185], v[160:161], v[180:181] op_sel:[0,0] op_sel_hi:[1,0]
    v_pk_mul_f32 v[186:187], v[162:163], v[182:183] op_sel:[0,0] op_sel_hi:[1,0]
    ds_write2st64_b64 v30, v[136:137], v[138:139] offset0:40 offset1:32
    v_pk_fma_f32 v[152:153], v[160:161], v[232:233], v[152:153] op_sel:[1,1,0] op_sel_hi:[0,1,1] neg_lo:[1,0,0]
    v_pk_fma_f32 v[154:155], v[162:163], v[234:235], v[154:155] op_sel:[1,1,0] op_sel_hi:[0,1,1] neg_lo:[1,0,0]
    v_cvt_pk_bf16_f32 v146, v168, v169
    v_cvt_pk_bf16_f32 v147, v170, v171
    v_cvt_pk_bf16_f32 v140, v208, v209
    v_cvt_pk_bf16_f32 v141, v210, v211
    ds_read_b128 a[40:43], v43 offset:8192
    v_pk_mul_f32 v[176:177], v[160:161], v[212:213] op_sel:[0,0] op_sel_hi:[1,0]
    v_pk_mul_f32 v[178:179], v[162:163], v[214:215] op_sel:[0,0] op_sel_hi:[1,0]
    ds_write_b64 v34, v[140:141] offset:26624
    v_pk_fma_f32 v[184:185], v[160:161], v[180:181], v[184:185] op_sel:[1,1,0] op_sel_hi:[0,1,1] neg_lo:[1,0,0]
    v_pk_fma_f32 v[186:187], v[162:163], v[182:183], v[186:187] op_sel:[1,1,0] op_sel_hi:[0,1,1] neg_lo:[1,0,0]
    v_cvt_pk_bf16_f32 v144, v152, v153
    v_cvt_pk_bf16_f32 v145, v154, v155
    ds_read_b128 a[44:47], v59 offset:8192
    v_pk_mul_f32 v[164:165], v[212:213], v[232:233] op_sel:[0,0] op_sel_hi:[1,0]
    v_pk_mul_f32 v[166:167], v[214:215], v[234:235] op_sel:[0,0] op_sel_hi:[1,0]
    ds_write2st64_b64 v31, v[144:145], v[146:147] offset0:41 offset1:33
    v_pk_fma_f32 v[176:177], v[160:161], v[212:213], v[176:177] op_sel:[1,1,0] op_sel_hi:[0,1,1] neg_lo:[1,0,0]
    v_pk_fma_f32 v[178:179], v[162:163], v[214:215], v[178:179] op_sel:[1,1,0] op_sel_hi:[0,1,1] neg_lo:[1,0,0]
    v_cvt_pk_bf16_f32 v150, v224, v225
    v_cvt_pk_bf16_f32 v151, v226, v227
    ds_read_b128 a[48:51], v14 offset:8448
    v_pk_mul_f32 v[216:217], v[184:185], v[232:233] op_sel:[0,0] op_sel_hi:[1,0]
    v_pk_mul_f32 v[218:219], v[186:187], v[234:235] op_sel:[0,0] op_sel_hi:[1,0]
    v_pk_fma_f32 v[164:165], v[212:213], v[232:233], v[164:165] op_sel:[1,1,0] op_sel_hi:[0,1,1] neg_lo:[1,0,0]
    v_pk_fma_f32 v[166:167], v[214:215], v[234:235], v[166:167] op_sel:[1,1,0] op_sel_hi:[0,1,1] neg_lo:[1,0,0]
    v_cvt_pk_bf16_f32 v138, v184, v185
    v_cvt_pk_bf16_f32 v139, v186, v187
    v_cvt_pk_bf16_f32 v148, v176, v177
    v_cvt_pk_bf16_f32 v149, v178, v179
    ds_read_b128 a[52:55], v38 offset:8448
    v_pk_mul_f32 v[192:193], v[212:213], v[244:245] op_sel:[0,0] op_sel_hi:[1,0]
    v_pk_mul_f32 v[194:195], v[214:215], v[246:247] op_sel:[0,0] op_sel_hi:[1,0]
    ds_write2st64_b64 v34, v[148:149], v[150:151] offset0:44 offset1:36
    v_pk_fma_f32 v[216:217], v[184:185], v[232:233], v[216:217] op_sel:[1,1,0] op_sel_hi:[0,1,1] neg_lo:[1,0,0]
    v_pk_fma_f32 v[218:219], v[186:187], v[234:235], v[218:219] op_sel:[1,1,0] op_sel_hi:[0,1,1] neg_lo:[1,0,0]
    v_cvt_pk_bf16_f32 v136, v164, v165
    v_cvt_pk_bf16_f32 v137, v166, v167
    ds_read_b128 a[56:59], v43 offset:8448
    v_pk_mul_f32 v[172:173], v[224:225], v[204:205] op_sel:[0,0] op_sel_hi:[1,0]
    v_pk_mul_f32 v[174:175], v[226:227], v[206:207] op_sel:[0,0] op_sel_hi:[1,0]
    ds_write2st64_b64 v32, v[136:137], v[138:139] offset0:34 offset1:42
    v_pk_fma_f32 v[192:193], v[212:213], v[244:245], v[192:193] op_sel:[1,1,0] op_sel_hi:[0,1,1] neg_lo:[1,0,0]
    v_pk_fma_f32 v[194:195], v[214:215], v[246:247], v[194:195] op_sel:[1,1,0] op_sel_hi:[0,1,1] neg_lo:[1,0,0]
    v_cvt_pk_bf16_f32 v142, v216, v217
    v_cvt_pk_bf16_f32 v143, v218, v219
    ds_read_b128 a[60:63], v59 offset:8448
    v_pk_mul_f32 v[228:229], v[176:177], v[232:233] op_sel:[0,0] op_sel_hi:[1,0]
    v_pk_mul_f32 v[230:231], v[178:179], v[234:235] op_sel:[0,0] op_sel_hi:[1,0]
    v_pk_fma_f32 v[172:173], v[224:225], v[204:205], v[172:173] op_sel:[1,1,0] op_sel_hi:[0,1,1] neg_lo:[1,0,0]
    v_pk_fma_f32 v[174:175], v[226:227], v[206:207], v[174:175] op_sel:[1,1,0] op_sel_hi:[0,1,1] neg_lo:[1,0,0]
    v_cvt_pk_bf16_f32 v140, v192, v193
    v_cvt_pk_bf16_f32 v141, v194, v195
    v_pk_mul_f32 v[196:197], v[160:161], v[224:225] op_sel:[0,0] op_sel_hi:[1,0]
    v_pk_mul_f32 v[198:199], v[162:163], v[226:227] op_sel:[0,0] op_sel_hi:[1,0]
    ds_write2st64_b64 v33, v[140:141], v[142:143] offset0:35 offset1:43
    v_pk_fma_f32 v[228:229], v[176:177], v[232:233], v[228:229] op_sel:[1,1,0] op_sel_hi:[0,1,1] neg_lo:[1,0,0]
    v_pk_fma_f32 v[230:231], v[178:179], v[234:235], v[230:231] op_sel:[1,1,0] op_sel_hi:[0,1,1] neg_lo:[1,0,0]
    v_cvt_pk_bf16_f32 v146, v172, v173
    v_cvt_pk_bf16_f32 v147, v174, v175
    v_pk_mul_f32 v[220:221], v[224:225], v[232:233] op_sel:[0,0] op_sel_hi:[1,0]
    v_pk_mul_f32 v[222:223], v[226:227], v[234:235] op_sel:[0,0] op_sel_hi:[1,0]
    v_pk_fma_f32 v[196:197], v[160:161], v[224:225], v[196:197] op_sel:[1,1,0] op_sel_hi:[0,1,1] neg_lo:[1,0,0]
    v_pk_fma_f32 v[198:199], v[162:163], v[226:227], v[198:199] op_sel:[1,1,0] op_sel_hi:[0,1,1] neg_lo:[1,0,0]
    v_cvt_pk_bf16_f32 v144, v228, v229
    v_cvt_pk_bf16_f32 v145, v230, v231
    v_pk_mul_f32 v[200:201], v[196:197], v[232:233] op_sel:[0,0] op_sel_hi:[1,0]
    v_pk_mul_f32 v[202:203], v[198:199], v[234:235] op_sel:[0,0] op_sel_hi:[1,0]
    ds_write2st64_b64 v35, v[144:145], v[146:147] offset0:45 offset1:37
    v_pk_fma_f32 v[220:221], v[224:225], v[232:233], v[220:221] op_sel:[1,1,0] op_sel_hi:[0,1,1] neg_lo:[1,0,0]
    v_pk_fma_f32 v[222:223], v[226:227], v[234:235], v[222:223] op_sel:[1,1,0] op_sel_hi:[0,1,1] neg_lo:[1,0,0]
    v_cvt_pk_bf16_f32 v150, v196, v197
    v_cvt_pk_bf16_f32 v151, v198, v199
    v_pk_mul_f32 v[236:237], v[224:225], v[244:245] op_sel:[0,0] op_sel_hi:[1,0]
    v_pk_mul_f32 v[238:239], v[226:227], v[246:247] op_sel:[0,0] op_sel_hi:[1,0]
    v_pk_fma_f32 v[200:201], v[196:197], v[232:233], v[200:201] op_sel:[1,1,0] op_sel_hi:[0,1,1] neg_lo:[1,0,0]
    v_pk_fma_f32 v[202:203], v[198:199], v[234:235], v[202:203] op_sel:[1,1,0] op_sel_hi:[0,1,1] neg_lo:[1,0,0]
    v_cvt_pk_bf16_f32 v148, v220, v221
    v_cvt_pk_bf16_f32 v149, v222, v223
    v_pk_mul_f32 v[248:249], v[188:189], v[212:213] op_sel:[0,0] op_sel_hi:[1,0]
    v_pk_mul_f32 v[250:251], v[190:191], v[214:215] op_sel:[0,0] op_sel_hi:[1,0]
    ds_write2st64_b64 v36, v[148:149], v[150:151] offset0:38 offset1:46
    v_pk_fma_f32 v[236:237], v[224:225], v[244:245], v[236:237] op_sel:[1,1,0] op_sel_hi:[0,1,1] neg_lo:[1,0,0]
    v_pk_fma_f32 v[238:239], v[226:227], v[246:247], v[238:239] op_sel:[1,1,0] op_sel_hi:[0,1,1] neg_lo:[1,0,0]
    v_cvt_pk_bf16_f32 v138, v200, v201
    v_cvt_pk_bf16_f32 v139, v202, v203
    v_pk_mul_f32 v[156:157], v[188:189], v[180:181] op_sel:[0,0] op_sel_hi:[1,0]
    v_pk_mul_f32 v[158:159], v[190:191], v[182:183] op_sel:[0,0] op_sel_hi:[1,0]
    v_pk_fma_f32 v[248:249], v[188:189], v[212:213], v[248:249] op_sel:[1,1,0] op_sel_hi:[0,1,1] neg_lo:[1,0,0]
    v_pk_fma_f32 v[250:251], v[190:191], v[214:215], v[250:251] op_sel:[1,1,0] op_sel_hi:[0,1,1] neg_lo:[1,0,0]
    v_cvt_pk_bf16_f32 v136, v236, v237
    v_cvt_pk_bf16_f32 v137, v238, v239
    v_pk_mul_f32 v[252:253], v[188:189], v[224:225] op_sel:[0,0] op_sel_hi:[1,0]
    v_pk_mul_f32 v[254:255], v[190:191], v[226:227] op_sel:[0,0] op_sel_hi:[1,0]
    ds_write2st64_b64 v37, v[136:137], v[138:139] offset0:39 offset1:47
    v_pk_fma_f32 v[156:157], v[188:189], v[180:181], v[156:157] op_sel:[1,1,0] op_sel_hi:[0,1,1] neg_lo:[1,0,0]
    v_pk_fma_f32 v[158:159], v[190:191], v[182:183], v[158:159] op_sel:[1,1,0] op_sel_hi:[0,1,1] neg_lo:[1,0,0]
    v_cvt_pk_bf16_f32 v142, v188, v189
    v_cvt_pk_bf16_f32 v143, v190, v191
    s_cmp_lg_u32 s27, 7
    s_cbranch_scc1 fused_kernel_nsig
    s_add_u32 s56, s6, 22020096
    s_addc_u32 s57, s7, 0
    s_waitcnt vmcnt(0)
    v_readfirstlane_b32 s36, v57
    s_mov_b32 s37, 0
    s_cmp_ge_u32 s36, 128
    s_cbranch_scc1 fused_kernel_sy_go
    fused_kernel_sy:
    s_sleep 4
    global_load_dword v57, v58, s[98:99] sc1
    s_add_u32 s37, s37, 1
    s_waitcnt vmcnt(0)
    v_readfirstlane_b32 s36, v57
    s_cmp_ge_u32 s37, 0x40000
    s_cbranch_scc1 fused_kernel_sy_go
    s_cmp_lt_u32 s36, 128
    s_cbranch_scc1 fused_kernel_sy
    fused_kernel_sy_go:
    v_lshlrev_b32 v58, 7, v0
    v_add_u32 v58, 65536, v58
    v_mov_b32 v57, 1
    s_barrier
    s_cmp_lg_u32 s24, 0
    s_cbranch_scc1 fused_kernel_ns2
    global_atomic_add v58, v57, s[56:57] sc1
    fused_kernel_ns2:
    fused_kernel_nsig:
    ds_read_b128 a[64:67], v14 offset:16384
    ds_read_b128 a[68:71], v38 offset:16384
    v_pk_mul_f32 v[240:241], v[188:189], v[160:161] op_sel:[0,0] op_sel_hi:[1,0]
    v_pk_mul_f32 v[242:243], v[190:191], v[162:163] op_sel:[0,0] op_sel_hi:[1,0]
    v_pk_fma_f32 v[252:253], v[188:189], v[224:225], v[252:253] op_sel:[1,1,0] op_sel_hi:[0,1,1] neg_lo:[1,0,0]
    v_pk_fma_f32 v[254:255], v[190:191], v[226:227], v[254:255] op_sel:[1,1,0] op_sel_hi:[0,1,1] neg_lo:[1,0,0]
    v_cvt_pk_bf16_f32 v146, v248, v249
    v_cvt_pk_bf16_f32 v147, v250, v251
    v_cvt_pk_bf16_f32 v140, v156, v157
    v_cvt_pk_bf16_f32 v141, v158, v159
    ds_read_b128 a[72:75], v43 offset:16384
    ds_read_b128 a[76:79], v59 offset:16384
    v_pk_mul_f32 v[168:169], v[188:189], v[184:185] op_sel:[0,0] op_sel_hi:[1,0]
    v_pk_mul_f32 v[170:171], v[190:191], v[186:187] op_sel:[0,0] op_sel_hi:[1,0]
    ds_write2st64_b64 v30, v[140:141], v[142:143] offset0:56 offset1:48
    v_pk_fma_f32 v[240:241], v[188:189], v[160:161], v[240:241] op_sel:[1,1,0] op_sel_hi:[0,1,1] neg_lo:[1,0,0]
    v_pk_fma_f32 v[242:243], v[190:191], v[162:163], v[242:243] op_sel:[1,1,0] op_sel_hi:[0,1,1] neg_lo:[1,0,0]
    v_cvt_pk_bf16_f32 v144, v252, v253
    v_cvt_pk_bf16_f32 v145, v254, v255
    ds_read_b128 a[80:83], v14 offset:16640
    ds_read_b128 a[84:87], v38 offset:16640
    v_pk_mul_f32 v[208:209], v[188:189], v[176:177] op_sel:[0,0] op_sel_hi:[1,0]
    v_pk_mul_f32 v[210:211], v[190:191], v[178:179] op_sel:[0,0] op_sel_hi:[1,0]
    ds_write2st64_b64 v31, v[144:145], v[146:147] offset0:57 offset1:49
    v_pk_fma_f32 v[168:169], v[188:189], v[184:185], v[168:169] op_sel:[1,1,0] op_sel_hi:[0,1,1] neg_lo:[1,0,0]
    v_pk_fma_f32 v[170:171], v[190:191], v[186:187], v[170:171] op_sel:[1,1,0] op_sel_hi:[0,1,1] neg_lo:[1,0,0]
    v_cvt_pk_bf16_f32 v150, v240, v241
    v_cvt_pk_bf16_f32 v151, v242, v243
    ds_read_b128 a[88:91], v43 offset:16640
    ds_read_b128 a[92:95], v59 offset:16640
    v_pk_mul_f32 v[152:153], v[188:189], v[196:197] op_sel:[0,0] op_sel_hi:[1,0]
    v_pk_mul_f32 v[154:155], v[190:191], v[198:199] op_sel:[0,0] op_sel_hi:[1,0]
    v_pk_fma_f32 v[208:209], v[188:189], v[176:177], v[208:209] op_sel:[1,1,0] op_sel_hi:[0,1,1] neg_lo:[1,0,0]
    v_pk_fma_f32 v[210:211], v[190:191], v[178:179], v[210:211] op_sel:[1,1,0] op_sel_hi:[0,1,1] neg_lo:[1,0,0]
    v_cvt_pk_bf16_f32 v148, v168, v169
    v_cvt_pk_bf16_f32 v149, v170, v171
    ds_write2st64_b64 v32, v[148:149], v[150:151] offset0:58 offset1:50
    v_pk_fma_f32 v[152:153], v[188:189], v[196:197], v[152:153] op_sel:[1,1,0] op_sel_hi:[0,1,1] neg_lo:[1,0,0]
    v_pk_fma_f32 v[154:155], v[190:191], v[198:199], v[154:155] op_sel:[1,1,0] op_sel_hi:[0,1,1] neg_lo:[1,0,0]
    v_cvt_pk_bf16_f32 v138, v208, v209
    v_cvt_pk_bf16_f32 v139, v210, v211
    v_cvt_pk_bf16_f32 v136, v152, v153
    v_cvt_pk_bf16_f32 v137, v154, v155
    ds_write2st64_b64 v33, v[136:137], v[138:139] offset0:59 offset1:51
    ds_read_b128 a[96:99], v14 offset:24576
    ds_read_b128 a[100:103], v38 offset:24576
    ds_read_b128 a[104:107], v43 offset:24576
    ds_read_b128 a[108:111], v59 offset:24576
    ds_read_b128 a[112:115], v14 offset:24832
    ds_read_b128 a[116:119], v38 offset:24832
    ds_read_b128 a[120:123], v43 offset:24832
    ds_read_b128 a[124:127], v59 offset:24832
    v_mov_b32 v92, v1
    v_mov_b32 v93, 0
    v_mov_b32 v94, 0
    v_mov_b32 v95, 0
    s_add_u32 s27, s27, 1
    s_cmp_lt_u32 s27, 8
    s_cbranch_scc1 fused_kernel_aloop
    s_lshl_b32 s36, s29, 3
    s_add_u32 s28, s28, s36
    s_sub_u32 s28, s28, 2048
    s_waitcnt lgkmcnt(8)
    v_mfma_f32_16x16x32_bf16 v[92:95], a[32:35], a[0:3], v[92:95]
    v_mfma_f32_16x16x32_bf16 v[96:99], a[64:67], a[0:3], 0
    v_mfma_f32_16x16x32_bf16 v[92:95], a[36:39], a[4:7], v[92:95]
    v_mfma_f32_16x16x32_bf16 v[96:99], a[68:71], a[4:7], v[96:99]
    v_mfma_f32_16x16x32_bf16 v[92:95], a[40:43], a[8:11], v[92:95]
    v_mfma_f32_16x16x32_bf16 v[96:99], a[72:75], a[8:11], v[96:99]
    v_mfma_f32_16x16x32_bf16 v[92:95], a[44:47], a[12:15], v[92:95]
    v_mfma_f32_16x16x32_bf16 v[96:99], a[76:79], a[12:15], v[96:99]
    s_waitcnt lgkmcnt(0)
    v_mfma_f32_16x16x32_bf16 v[100:103], a[96:99], a[0:3], 0
    v_mfma_f32_16x16x32_bf16 v[92:95], a[48:51], a[16:19], v[92:95]
    v_mfma_f32_16x16x32_bf16 v[100:103], a[100:103], a[4:7], v[100:103]
    v_mfma_f32_16x16x32_bf16 v[96:99], a[80:83], a[16:19], v[96:99]
    v_mfma_f32_16x16x32_bf16 v[100:103], a[104:107], a[8:11], v[100:103]
    v_mfma_f32_16x16x32_bf16 v[92:95], a[52:55], a[20:23], v[92:95]
    v_mfma_f32_16x16x32_bf16 v[100:103], a[108:111], a[12:15], v[100:103]
    v_mfma_f32_16x16x32_bf16 v[96:99], a[84:87], a[20:23], v[96:99]
    v_mfma_f32_16x16x32_bf16 v[100:103], a[112:115], a[16:19], v[100:103]
    v_mfma_f32_16x16x32_bf16 v[92:95], a[56:59], a[24:27], v[92:95]
    v_mfma_f32_16x16x32_bf16 v[100:103], a[116:119], a[20:23], v[100:103]
    v_mfma_f32_16x16x32_bf16 v[96:99], a[88:91], a[24:27], v[96:99]
    v_mfma_f32_16x16x32_bf16 v[100:103], a[120:123], a[24:27], v[100:103]
    v_mfma_f32_16x16x32_bf16 v[92:95], a[60:63], a[28:31], v[92:95]
    v_mfma_f32_16x16x32_bf16 v[100:103], a[124:127], a[28:31], v[100:103]
    v_mfma_f32_16x16x32_bf16 v[96:99], a[92:95], a[28:31], v[96:99]
    s_nop 7
    v_cvt_pk_bf16_f32 v96, v96, v97
    v_cvt_pk_bf16_f32 v98, v98, v99
    v_cvt_pk_bf16_f32 v100, v100, v101
    v_cvt_pk_bf16_f32 v102, v102, v103
    v_cvt_pk_bf16_f32 v92, v92, v93
    v_cvt_pk_bf16_f32 v93, v94, v95
    ds_write_b32 v16, v96
    ds_write_b32 v17, v98
    ds_write_b16 v18, v100
    ds_write_b16_d16_hi v18, v100 offset:64
    ds_write_b16 v18, v102 offset:128
    ds_write_b16_d16_hi v18, v102 offset:192
    ds_write_b64 v15, v[92:93]
    ds_read_b128 v[116:119], v39 offset:30720
    ds_read_b128 v[120:123], v39 offset:31744
    s_waitcnt lgkmcnt(0)
    buffer_store_dwordx4 v[116:119], v12, s[12:15], s28 offen offset:0 sc1
    buffer_store_dwordx4 v[120:123], v12, s[12:15], s28 offen offset:1024 sc1
    s_add_u32 s28, s28, 2048
    s_lshl_b32 s36, s2, 2
    s_add_u32 s36, s36, s24
    s_and_b32 s36, s36, 63
    s_lshl_b32 s36, s36, 7
    s_add_u32 s36, s36, 65536
    v_mov_b32 v23, s36
    s_add_u32 s56, s6, 22020096
    s_addc_u32 s57, s7, 0
    global_load_dword v22, v23, s[56:57] sc1

    s_nop 7
    s_lshl_b32 s36, s24, 8
    s_add_u32 s36, s36, 147456
    v_add_u32 v28, s36, v24

    ds_write_b128 v28, a[128:131] offset:0
    ds_write_b128 v28, a[132:135] offset:64
    ds_write_b128 v28, a[136:139] offset:128
    ds_write_b128 v28, a[140:143] offset:192
    v_lshlrev_b32 v29, 2, v0
    v_add_u32 v28, 147456, v29
    s_waitcnt lgkmcnt(0)
    s_barrier
    ds_read_b32 v88, v28
    ds_read_b32 v89, v28 offset:256
    ds_read_b32 v90, v28 offset:512
    ds_read_b32 v91, v28 offset:768
    s_mov_b32 s38, 0xbfb8aa3b
    s_lshl_b32 s36, s3, 8
    s_waitcnt lgkmcnt(0)
    v_add_f32 v88, v88, v89
    v_add_f32 v90, v90, v91
    v_add_f32 v88, v88, v90
    v_cvt_pk_bf16_f32 v88, v88, v88
    v_lshlrev_b32 v88, 16, v88
    v_mul_f32 v88, s38, v88
    v_exp_f32 v88, v88
    s_nop 0
    v_add_f32 v88, 1.0, v88
    v_rcp_f32 v88, v88
    s_nop 0
    v_cvt_pk_bf16_f32 v88, v88, v88
    v_lshlrev_b32 v88, 16, v88
    buffer_store_dword v88, v29, s[84:87], s36 offen sc1

    v_lshlrev_b32 v1, 4, v0
    s_mov_b32 s51, 49152

    s_and_b32 s3, s2, 7
    s_lshr_b32 s48, s2, 3
    s_and_b32 s49, s3, 1
    s_lshl_b32 s49, s49, 3
    s_and_b32 s50, s48, 7
    s_add_u32 s27, s49, s50
    s_bfe_u32 s35, s3, 0x10001
    s_lshl_b32 s49, s35, 2
    s_lshr_b32 s50, s48, 3
    s_add_u32 s28, s49, s50
    s_lshr_b32 s29, s3, 2
    s_lshl_b32 s30, s2, 2
    s_add_u32 s30, s30, s24
    s_mul_i32 s31, s24, 17728
    s_add_u32 s31, s31, 92928
    s_lshl_b32 s32, s24, 12
    s_add_u32 s48, s27, s28
    s_and_b32 s48, s48, 1
    s_and_b32 s35, s35, 1
    s_lshl_b32 s49, s48, 1
    s_sub_u32 s46, 1, s49
    s_add_u32 s47, 1, s49
    s_sub_u32 s49, 27, s48
    s_cmp_eq_u32 s35, 1
    s_cselect_b32 s34, s49, s48
    s_cselect_b32 s49, -1, 1
    s_mul_i32 s46, s46, s49
    s_mul_i32 s47, s47, s49
    s_lshl_b32 s33, s34, 17
    s_lshl_b32 s34, s34, 11
    s_lshl_b32 s44, s46, 17
    s_lshl_b32 s45, s47, 17
    s_lshl_b32 s46, s46, 11
    s_lshl_b32 s47, s47, 11
    v_lshrrev_b32 v19, 4, v0
    v_lshlrev_b32 v18, 11, v19
    v_bfe_u32 v20, v0, 1, 3
    v_xor_b32 v20, v20, v19
    v_lshlrev_b32 v20, 5, v20
    v_and_b32 v21, 1, v0
    v_lshl_add_u32 v20, v21, 4, v20
    v_add_u32 v18, v18, v20
    s_lshl_b32 s48, s24, 15
    s_lshl_b32 s49, s28, 8
    s_add_u32 s48, s48, s49
    s_mul_i32 s49, s29, 3670016
    s_add_u32 s48, s48, s49
    v_add_u32 v18, s48, v18
    v_xor_b32 v21, 128, v18
    v_add_u32 v19, 7168, v21
    v_add_u32 v20, 14336, v18
    v_add_u32 v21, 21504, v21
    s_add_u32 s56, s6, 22020096
    s_addc_u32 s57, s7, 0
    s_mov_b32 s8, s92
    s_and_b32 s9, s93, 0xffff
    s_mov_b32 s10, 0x700000
    s_mov_b32 s11, 0x20000
    s_add_u32 s4, s6, 25165808
    s_addc_u32 s5, s7, 0
    s_mov_b32 s16, s4
    s_and_b32 s17, s5, 0xffff
    s_mov_b32 s18, 0x400010
    s_mov_b32 s19, 0x20000
    s_add_u32 s4, s6, 58720256
    s_addc_u32 s5, s7, 0
    s_mov_b32 s12, s4
    s_and_b32 s13, s5, 0xffff
    s_mov_b32 s14, 0x800000
    s_mov_b32 s15, 0x20000
    s_add_u32 s4, s6, 16777216
    s_addc_u32 s5, s7, 0
    s_mov_b32 s84, s4
    s_and_b32 s85, s5, 0xffff
    s_mov_b32 s86, 0x400000
    s_mov_b32 s87, 0x20000
    s_lshl_b32 s50, s30, 11
    s_add_u32 s50, s50, 16
    v_sub_u32 v66, 575, v0
    v_lshrrev_b32 v66, 1, v66
    v_lshl_add_u32 v40, v66, 2, s50
    v_lshlrev_b32 v66, 2, v0
    v_sub_u32 v66, 1020, v66
    v_add_u32 v41, s50, v66
    v_cmp_gt_u32 vcc, 32, v0
    v_lshlrev_b32 v66, 3, v0
    v_lshlrev_b32 v67, 4, v0
    v_sub_u32 v66, 764, v66
    v_sub_u32 v67, 1016, v67
    v_cndmask_b32 v66, v67, v66, vcc
    v_add_u32 v42, s50, v66
    v_cndmask_b32 v67, 12, 8, vcc
    v_sub_u32 v43, v42, v67
    v_cndmask_b32 v66, 0, -1, vcc
    v_cmp_gt_u32 vcc, 31, v0
    v_bfe_i32 v67, v0, 0, 1
    v_and_b32 v60, 33687046, v66
    v_xor_b32 v60, 50464004, v60
    v_and_b32 v61, 33686532, v66
    v_xor_b32 v61, 50464004, v61
    v_and_b32 v63, 101057026, v66
    v_xor_b32 v63, 84150022, v63
    v_and_b32 v64, 67372550, v66
    v_xor_b32 v64, 84150022, v64
    v_and_b32 v65, 514, v66
    v_xor_b32 v65, 84150022, v65
    v_cndmask_b32 v66, 0, -1, vcc
    v_and_b32 v56, 101058054, v67
    v_xor_b32 v56, 84149508, v56
    v_and_b32 v57, 33686018, v67
    v_xor_b32 v57, 50463490, v57
    v_and_b32 v58, 33686532, v67
    v_xor_b32 v58, 50464004, v58
    v_and_b32 v59, 67372550, v67
    v_xor_b32 v59, 84149508, v59
    v_and_b32 v62, 101056512, v66
    v_xor_b32 v62, 50464004, v62
    s_mov_b32 s25, 50464004
    s_mov_b32 s26, 50463490
    s_mov_b32 s37, 16777472
    s_mov_b32 s58, 84149508
    s_mov_b32 s59, 16777986
    s_waitcnt vmcnt(0)
    s_barrier
    s_nop 0
    v_readfirstlane_b32 s48, v22
    s_mov_b32 s49, 0
    s_cmp_ge_u32 s48, 32
    s_cbranch_scc1 fused_kernel_sx_go
    fused_kernel_sx:
    s_sleep 4
    global_load_dword v22, v23, s[56:57] sc1
    s_add_u32 s49, s49, 1
    s_waitcnt vmcnt(0)
    v_readfirstlane_b32 s48, v22
    s_cmp_ge_u32 s49, 0x40000
    s_cbranch_scc1 fused_kernel_sx_go
    s_cmp_lt_u32 s48, 32
    s_cbranch_scc1 fused_kernel_sx
    fused_kernel_sx_go:
    s_lshl_b32 s50, s30, 12
    buffer_load_dwordx2 v[44:45], v40, s[12:15], 0 offen offset:128 sc1
    buffer_load_dwordx2 v[46:47], v40, s[12:15], 0 offen sc1
    buffer_load_dwordx2 v[48:49], v41, s[12:15], 0 offen sc1
    buffer_load_dwordx2 v[50:51], v42, s[12:15], 0 offen sc1
    buffer_load_dwordx4 v[52:55], v43, s[12:15], 0 offen sc1
    buffer_load_dwordx4 a[224:227], v1, s[16:19], s50 offen offset:16 sc1
    buffer_load_dwordx4 a[228:231], v1, s[16:19], s50 offen offset:1040 sc1
    buffer_load_dwordx4 a[232:235], v1, s[16:19], s50 offen offset:2064 sc1
    buffer_load_dwordx4 a[236:239], v1, s[16:19], s50 offen offset:3088 sc1
    buffer_load_dwordx4 a[240:243], v1, s[16:19], s50 offen offset:12 sc1
    buffer_load_dwordx4 a[244:247], v1, s[16:19], s50 offen offset:1036 sc1
    buffer_load_dwordx4 a[248:251], v1, s[16:19], s50 offen offset:2060 sc1
    buffer_load_dwordx4 a[252:255], v1, s[16:19], s50 offen offset:3084 sc1
    s_mov_b32 s20, s6
    s_and_b32 s21, s7, 0xffff
    s_mov_b32 s22, 0xe00000
    s_mov_b32 s23, 0x20000
    s_add_u32 m0, s32, 0
    s_nop 0
    buffer_load_dwordx4 v18, s[8:11], s33 offen offset:0 lds
    buffer_load_dwordx4 v19, s[8:11], s33 offen offset:1024 lds
    buffer_load_dwordx4 v20, s[8:11], s33 offen offset:2048 lds
    buffer_load_dwordx4 v21, s[8:11], s33 offen offset:3072 lds
    s_add_u32 s33, s33, s44
    s_add_u32 m0, s32, 16384
    s_nop 0
    buffer_load_dwordx4 v18, s[8:11], s33 offen offset:0 lds
    buffer_load_dwordx4 v19, s[8:11], s33 offen offset:1024 lds
    buffer_load_dwordx4 v20, s[8:11], s33 offen offset:2048 lds
    buffer_load_dwordx4 v21, s[8:11], s33 offen offset:3072 lds
    s_add_u32 s33, s33, s45
    s_add_u32 m0, s32, 32768
    s_nop 0
    buffer_load_dwordx4 v18, s[8:11], s33 offen offset:0 lds
    buffer_load_dwordx4 v19, s[8:11], s33 offen offset:1024 lds
    buffer_load_dwordx4 v20, s[8:11], s33 offen offset:2048 lds
    buffer_load_dwordx4 v21, s[8:11], s33 offen offset:3072 lds
    s_add_u32 s33, s33, s44
    s_add_u32 m0, s32, 49152
    s_nop 0
    buffer_load_dwordx4 v18, s[8:11], s33 offen offset:0 lds
    buffer_load_dwordx4 v19, s[8:11], s33 offen offset:1024 lds
    buffer_load_dwordx4 v20, s[8:11], s33 offen offset:2048 lds
    buffer_load_dwordx4 v21, s[8:11], s33 offen offset:3072 lds
    s_add_u32 s33, s33, s45
    s_add_u32 m0, s32, 65536
    s_nop 0
    buffer_load_dwordx4 v18, s[8:11], s33 offen offset:0 lds
    buffer_load_dwordx4 v19, s[8:11], s33 offen offset:1024 lds
    buffer_load_dwordx4 v20, s[8:11], s33 offen offset:2048 lds
    buffer_load_dwordx4 v21, s[8:11], s33 offen offset:3072 lds
    s_add_u32 s33, s33, s44
    s_waitcnt vmcnt(20)
    s_branch fused_kernel_p2
fused_kernel_end2:
    s_endpgm
.section .rodata,"a"
.p2align 6
.amdhsa_kernel fused_kernel
  .amdhsa_next_free_vgpr 512
  .amdhsa_next_free_sgpr 102
  .amdhsa_accum_offset 256
  .amdhsa_group_segment_fixed_size 0
  .amdhsa_kernarg_size 136
  .amdhsa_user_sgpr_count 2
  .amdhsa_user_sgpr_kernarg_segment_ptr 1
  .amdhsa_system_sgpr_workgroup_id_x 1
  .amdhsa_float_denorm_mode_32 3
.end_amdhsa_kernel
```
